```python
import torch

def _softmax(x, axis=-1):
    return torch.softmax(x, dim=axis)
def _gelu(x):
    return torch.nn.functional.gelu(x, approximate="tanh")
def _silu(x):
    return torch.nn.functional.silu(x)
def _sigmoid(x):
    return torch.sigmoid(x)
def _layernorm(x, axis=-1, eps=1e-5):
    m = x.mean(dim=axis, keepdim=True)
    v = x.var(dim=axis, keepdim=True, unbiased=False)
    return (x - m) / torch.sqrt(v + eps)
def _scatter_add(tgt, idx, src, axis=0):
    return tgt.clone().index_add_(axis, idx, src)
def _segment_sum(src, seg, n):
    out = torch.zeros((n,) + src.shape[1:], dtype=src.dtype)
    return out.index_add_(0, seg, src)
def _pad(x, pw):
    flat = tuple(v for pair in reversed(pw) for v in pair)
    return torch.nn.functional.pad(x, flat)

kernel_name = 'standalone__mha_block_cached__near_ridge'

def setup_inputs():

    _w = (lambda a: (lambda t: t.to(torch.bfloat16) if t.is_floating_point() else t)(torch.as_tensor(a)))
    B, Sq, D = 16, 192, 512
    H, Sk, Dh = 32, 512, 128
    return {
        "x": _w((lambda *s: torch.randn(*s, dtype=torch.bfloat16) * 0.8)(B, Sq, D)),
        "k_cache": _w((lambda *s: torch.randn(*s, dtype=torch.bfloat16) * 0.8)(B, H, Sk, Dh)),
        "v_cache": _w((lambda *s: torch.randn(*s, dtype=torch.bfloat16) * 0.05)(B, H, Sk, Dh)),
        "wq": _w((lambda *s: torch.randn(*s, dtype=torch.bfloat16) * 0.8)(D, H * Dh) * (D ** -0.5)),
        "wo": _w((lambda *s: torch.randn(*s, dtype=torch.bfloat16) * 0.05)(H * Dh, D) * ((H * Dh) ** -0.5)),
    }

def reference(x, k_cache, v_cache, wq, wo):
    B, Sq, D = x.shape
    H, Dh = 32, 128
    q = (lambda x, *d: x.permute(*d))((x @ wq).reshape(B, Sq, H, Dh), 0, 2, 1, 3)
    scores = torch.einsum("bhqd,bhkd->bhqk", q, k_cache) * (Dh ** -0.5)
    p = _softmax(scores, axis=-1)
    o = torch.einsum("bhqk,bhkd->bhqd", p, v_cache)
    return (lambda x, *d: x.permute(*d))(o, 0, 2, 1, 3).reshape(B, Sq, H * Dh) @ wo
```

```asm
; @launch grid=(256,1,1) block=(256,1,1) lds=163840
.amdgcn_target "amdgcn-amd-amdhsa--gfx950"
.text
.globl standalone__mha_block_cached__near_ridge_kernel
.p2align 8
.type standalone__mha_block_cached__near_ridge_kernel,@function
standalone__mha_block_cached__near_ridge_kernel:
  s_cmp_ge_u32 s2, 256
  s_cbranch_scc1 L1_end
  s_load_dwordx16 s[4:19], s[0:1], 0
  v_lshrrev_b32 v1, 6, v0
  v_min_u32 v255, 1, v0
  v_lshlrev_b32 v255, 31, v255
  v_lshrrev_b32 v230, 4, v0
  v_min_u32 v230, 1, v230
  v_lshlrev_b32 v230, 31, v230
  v_lshl_add_u32 v230, v0, 2, v230
  v_and_b32 v0, 63, v0
  v_readfirstlane_b32 s3, v1
  s_and_b32 s66, s2, 7
  s_lshr_b32 s67, s2, 3
  s_and_b32 s48, s66, 1
  s_lshl_b32 s48, s48, 3
  s_lshr_b32 s68, s67, 2
  s_add_u32 s48, s48, s68
  s_lshr_b32 s49, s66, 1
  s_lshl_b32 s49, s49, 2
  s_and_b32 s69, s67, 3
  s_add_u32 s49, s49, s69
  s_lshl_b32 s65, s66, 3
  s_add_u32 s65, s65, s68
  s_mul_i32 s52, s69, 2
  s_mul_i32 s68, s68, 1
  s_add_u32 s52, s52, s68
  s_and_b32 s52, s52, 7
  v_lshrrev_b32 v2, 3, v0
  v_and_b32 v3, 7, v0
  v_bfe_u32 v4, v0, 4, 1
  v_xor_b32 v5, v3, v4
  v_lshlrev_b32 v5, 4, v5
  v_lshlrev_b32 v6, 2, v4
  v_xor_b32 v6, v3, v6
  v_lshlrev_b32 v6, 4, v6
  v_lshl_add_u32 v253, v2, 10, v5
  v_lshl_add_u32 v254, v2, 13, v6
  s_mul_i32 s50, s48, 196608
  s_mul_i32 s66, s3, 49152
  s_add_u32 s50, s50, s66
  s_lshl_b32 s51, s49, 9
  s_lshl_b32 s66, s3, 7
  s_add_u32 s51, s51, s66
  s_mul_i32 s57, s3, 6336
  s_lshl_b32 s58, s3, 10
  s_waitcnt lgkmcnt(0)
  s_mov_b32 s20, s4
  s_and_b32 s21, s5, 0xffff
  s_mov_b32 s22, 3145728
  s_mov_b32 s23, 0x00020000
  s_mov_b32 s24, s10
  s_and_b32 s25, s11, 0xffff
  s_mov_b32 s26, 4194304
  s_mov_b32 s27, 0x00020000
  s_lshl_b32 s54, s52, 7
  s_add_u32 s54, s54, s50
  s_lshl_b32 s55, s52, 19
  s_add_u32 s55, s55, s51
  s_add_u32 s52, s52, 1
  s_and_b32 s52, s52, 7
  s_add_u32 m0, s57, 47616
  s_add_u32 s56, s54, 0
  buffer_load_dwordx4 v253, s[20:23], s56 offen lds
  s_add_u32 m0, s57, 48672
  s_add_u32 s56, s54, 8192
  buffer_load_dwordx4 v253, s[20:23], s56 offen lds
  s_add_u32 m0, s57, 49728
  s_add_u32 s56, s54, 16384
  buffer_load_dwordx4 v253, s[20:23], s56 offen lds
  s_add_u32 m0, s57, 50784
  s_add_u32 s56, s54, 24576
  buffer_load_dwordx4 v253, s[20:23], s56 offen lds
  s_add_u32 m0, s57, 51840
  s_add_u32 s56, s54, 32768
  buffer_load_dwordx4 v253, s[20:23], s56 offen lds
  s_add_u32 m0, s57, 52896
  s_add_u32 s56, s54, 40960
  buffer_load_dwordx4 v253, s[20:23], s56 offen lds
  s_add_u32 m0, s58, 72960
  s_add_u32 s56, s55, 0
  buffer_load_dwordx4 v254, s[24:27], s56 offen lds
  s_add_u32 m0, s58, 77056
  s_add_u32 s56, s55, 65536
  buffer_load_dwordx4 v254, s[24:27], s56 offen lds
  s_add_u32 m0, s58, 81152
  s_add_u32 s56, s55, 131072
  buffer_load_dwordx4 v254, s[24:27], s56 offen lds
  s_add_u32 m0, s58, 85248
  s_add_u32 s56, s55, 196608
  buffer_load_dwordx4 v254, s[24:27], s56 offen lds
  s_add_u32 m0, s58, 89344
  s_add_u32 s56, s55, 262144
  buffer_load_dwordx4 v254, s[24:27], s56 offen lds
  s_add_u32 m0, s58, 93440
  s_add_u32 s56, s55, 327680
  buffer_load_dwordx4 v254, s[24:27], s56 offen lds
  s_add_u32 m0, s58, 97536
  s_add_u32 s56, s55, 393216
  buffer_load_dwordx4 v254, s[24:27], s56 offen lds
  s_add_u32 m0, s58, 101632
  s_add_u32 s56, s55, 458752
  buffer_load_dwordx4 v254, s[24:27], s56 offen lds
  s_getpc_b64 s[68:69]
L1_pc:
  s_lshr_b32 s66, s2, 3
  s_lshl_b32 s66, s66, 2
  s_add_u32 s66, s66, s3
  s_lshl_b32 s66, s66, 9
  s_min_u32 s66, s66, L1_code_end-L1_pc-512
  s_add_u32 s68, s68, s66
  s_addc_u32 s69, s69, 0
  v_lshlrev_b32 v7, 3, v0
  global_load_dword a255, v7, s[68:69]
  v_lshrrev_b32 v2, 3, v0
  v_and_b32 v3, 7, v0
  v_bfe_u32 v4, v0, 4, 1
  v_xor_b32 v5, v3, v4
  v_lshlrev_b32 v5, 4, v5
  v_lshlrev_b32 v6, 2, v4
  v_xor_b32 v6, v3, v6
  v_lshlrev_b32 v6, 4, v6
  v_lshl_add_u32 v5, v2, 8, v5
  v_lshl_add_u32 v6, v2, 8, v6
  s_lshl_b32 s66, s3, 11
  s_add_u32 s67, s66, 128
  s_add_u32 s66, s66, 1024
  v_add_u32 v243, s66, v5
  v_add_u32 v244, s67, v5
  v_add_u32 v245, s66, v6
  v_add_u32 v246, s67, v6
  s_lshr_b32 s66, s3, 1
  s_lshl_b32 s66, s66, 11
  v_bfe_u32 v2, v0, 3, 2
  v_mul_u32_u24 v2, 4128, v2
  v_lshl_add_u32 v2, v3, 7, v2
  v_lshrrev_b32 v4, 5, v0
  v_bfe_u32 v5, v0, 1, 1
  v_xor_b32 v5, v4, v5
  v_lshl_add_u32 v2, v5, 4, v2
  v_add_u32 v240, s66, v2
  v_bfe_u32 v2, v0, 2, 2
  v_lshlrev_b32 v2, 7, v2
  v_lshl_add_u32 v2, v4, 9, v2
  v_bfe_u32 v5, v0, 3, 1
  v_lshl_add_u32 v2, v5, 6, v2
  v_bfe_u32 v5, v0, 4, 1
  v_lshl_add_u32 v2, v5, 5, v2
  v_and_b32 v5, 3, v0
  v_lshl_add_u32 v2, v5, 3, v2
  v_add_u32 v241, s66, v2
  v_xor_b32 v242, 64, v241
  s_mul_i32 s61, s3, 4128
  s_lshl_b32 s62, s3, 12
  s_lshl_b32 s66, s48, 5
  s_lshl_b32 s67, s49, 1
  s_add_u32 s66, s66, s67
  s_lshl_b32 s66, s66, 17
  s_add_u32 s28, s6, s66
  s_addc_u32 s29, s7, 0
  s_sub_u32 s28, s28, 1024
  s_subb_u32 s29, s29, 0
  s_and_b32 s29, s29, 0xffff
  s_add_u32 s32, s28, 129024
  s_addc_u32 s33, s29, 0
  s_add_u32 s36, s8, s66
  s_addc_u32 s37, s9, 0
  s_sub_u32 s36, s36, 1024
  s_subb_u32 s37, s37, 0
  s_and_b32 s37, s37, 0xffff
  s_add_u32 s40, s36, 129024
  s_addc_u32 s41, s37, 0
  s_mov_b32 s30, 132096
  s_mov_b32 s34, 134144
  s_mov_b32 s38, 132096
  s_mov_b32 s42, 134144
  s_mov_b32 s31, 0x00020000
  s_mov_b32 s35, 0x00020000
  s_mov_b32 s39, 0x00020000
  s_mov_b32 s43, 0x00020000
  s_add_u32 s44, s18, 16777216
  s_addc_u32 s45, s19, 0
  s_and_b32 s45, s45, 0xffff
  s_mov_b32 s46, 62914560
  s_mov_b32 s47, 0x00020000
  s_mov_b32 s72, s16
  s_and_b32 s73, s17, 0xffff
  s_mov_b32 s74, 256
  s_mov_b32 s75, 0x00020000
  s_mov_b32 s64, 0x3e0293ee
  s_add_u32 s4, s18, 8388608
  s_addc_u32 s5, s19, 0
  s_and_b32 s5, s5, 0xffff
  s_mov_b32 s6, 8192
  s_mov_b32 s7, 0x00020000
  s_lshl_b32 s53, s48, 7
  s_lshl_b32 s65, s48, 2
  s_add_u32 s65, s65, 64
  s_sub_u32 s8, s12, 1024
  s_subb_u32 s9, s13, 0
  s_and_b32 s9, s9, 0xffff
  s_mov_b32 s10, 4195328
  s_mov_b32 s11, 0x00020000
  s_lshr_b32 s63, s49, 2
  s_lshl_b32 s63, s63, 5
  s_lshr_b32 s66, s2, 3
  s_add_u32 s63, s63, s66
  s_lshl_b32 s63, s63, 2
  s_add_u32 s63, s63, s3
  s_lshl_b32 s63, s63, 13
  s_lshr_b32 s66, s3, 1
  s_and_b32 s67, s3, 1
  v_bfe_u32 v3, v0, 3, 2
  v_mul_u32_u24 v3, 1056, v3
  v_and_b32 v4, 7, v0
  v_lshl_add_u32 v3, v4, 7, v3
  v_lshrrev_b32 v4, 5, v0
  v_bfe_u32 v5, v0, 1, 1
  v_xor_b32 v5, v4, v5
  v_lshl_add_u32 v3, v5, 4, v3
  s_mul_i32 s68, s67, 12672
  s_add_u32 s68, s68, 47616
  v_add_u32 v250, s68, v3
  v_bfe_u32 v2, v0, 2, 2
  v_lshlrev_b32 v2, 7, v2
  v_bfe_u32 v3, v0, 3, 1
  v_lshl_add_u32 v2, v3, 6, v2
  v_bfe_u32 v3, v0, 4, 1
  v_lshl_add_u32 v2, v3, 5, v2
  v_and_b32 v3, 1, v0
  v_lshl_add_u32 v2, v3, 4, v2
  v_bfe_u32 v3, v0, 1, 1
  v_lshl_add_u32 v2, v3, 3, v2
  v_lshl_add_u32 v2, v4, 12, v2
  s_lshl_b32 s68, s66, 11
  s_add_u32 s68, s68, 72960
  v_add_u32 v251, s68, v2
  v_xor_b32 v252, 64, v251
  v_mov_b32 v247, 0
  v_mov_b32 v248, 0
  v_mov_b32 v249, 0
  s_lshl_b32 s54, s52, 7
  s_add_u32 s54, s54, s50
  s_lshl_b32 s55, s52, 19
  s_add_u32 s55, s55, s51
  s_add_u32 s52, s52, 1
  s_and_b32 s52, s52, 7
  s_add_u32 m0, s57, 105728
  s_add_u32 s56, s54, 0
  buffer_load_dwordx4 v253, s[20:23], s56 offen lds
  s_add_u32 m0, s57, 106784
  s_add_u32 s56, s54, 8192
  buffer_load_dwordx4 v253, s[20:23], s56 offen lds
  s_add_u32 m0, s57, 107840
  s_add_u32 s56, s54, 16384
  buffer_load_dwordx4 v253, s[20:23], s56 offen lds
  s_add_u32 m0, s57, 108896
  s_add_u32 s56, s54, 24576
  buffer_load_dwordx4 v253, s[20:23], s56 offen lds
  s_add_u32 m0, s57, 109952
  s_add_u32 s56, s54, 32768
  buffer_load_dwordx4 v253, s[20:23], s56 offen lds
  s_add_u32 m0, s57, 111008
  s_add_u32 s56, s54, 40960
  buffer_load_dwordx4 v253, s[20:23], s56 offen lds
  s_add_u32 m0, s58, 131072
  s_add_u32 s56, s55, 0
  buffer_load_dwordx4 v254, s[24:27], s56 offen lds
  s_add_u32 m0, s58, 135168
  s_add_u32 s56, s55, 65536
  buffer_load_dwordx4 v254, s[24:27], s56 offen lds
  s_waitcnt vmcnt(9)
  s_barrier
  ds_read_b64_tr_b16 a[112:113], v251 offset:0
  ds_read_b64_tr_b16 a[114:115], v251 offset:512
  ds_read_b128 a[144:147], v250 offset:0
  ds_read_b128 a[148:151], v250 offset:4224
  ds_read_b128 a[152:155], v250 offset:8448
  ds_read_b64_tr_b16 a[116:117], v252 offset:0
  ds_read_b64_tr_b16 a[118:119], v252 offset:512
  ds_read_b64_tr_b16 a[120:121], v251 offset:1024
  ds_read_b64_tr_b16 a[122:123], v251 offset:1536
  ds_read_b64_tr_b16 a[124:125], v252 offset:1024
  ds_read_b64_tr_b16 a[126:127], v252 offset:1536
  s_waitcnt lgkmcnt(8)
  v_mfma_f32_32x32x16_bf16 v[0:15], a[112:115], a[144:147], 0
  ds_read_b64_tr_b16 a[128:129], v251 offset:8192
  ds_read_b64_tr_b16 a[130:131], v251 offset:8704
  s_add_u32 m0, s58, 139264
  s_add_u32 s56, s55, 131072
  s_waitcnt lgkmcnt(9)
  v_mfma_f32_32x32x16_bf16 v[64:79], a[112:115], a[148:151], 0
  buffer_load_dwordx4 v254, s[24:27], s56 offen lds
  s_waitcnt lgkmcnt(8)
  v_mfma_f32_32x32x16_bf16 v[128:143], a[112:115], a[152:155], 0
  ds_read_b128 a[156:159], v250 offset:32
  ds_read_b128 a[160:163], v250 offset:4256
  s_add_u32 m0, s58, 143360
  s_add_u32 s56, s55, 196608
  s_waitcnt lgkmcnt(8)
  v_mfma_f32_32x32x16_bf16 v[16:31], a[116:119], a[144:147], 0
  buffer_load_dwordx4 v254, s[24:27], s56 offen lds
  v_mfma_f32_32x32x16_bf16 v[80:95], a[116:119], a[148:151], 0
  ds_read_b128 a[164:167], v250 offset:8480
  ds_read_b64_tr_b16 a[132:133], v252 offset:8192
  s_add_u32 m0, s58, 147456
  s_add_u32 s56, s55, 262144
  v_mfma_f32_32x32x16_bf16 v[144:159], a[116:119], a[152:155], 0
  buffer_load_dwordx4 v254, s[24:27], s56 offen lds
  s_waitcnt lgkmcnt(8)
  v_mfma_f32_32x32x16_bf16 v[32:47], a[120:123], a[144:147], 0
  ds_read_b64_tr_b16 a[134:135], v252 offset:8704
  ds_read_b64_tr_b16 a[136:137], v251 offset:9216
  s_add_u32 m0, s58, 151552
  s_add_u32 s56, s55, 327680
  v_mfma_f32_32x32x16_bf16 v[96:111], a[120:123], a[148:151], 0
  buffer_load_dwordx4 v254, s[24:27], s56 offen lds
  v_mfma_f32_32x32x16_bf16 v[160:175], a[120:123], a[152:155], 0
  ds_read_b64_tr_b16 a[138:139], v251 offset:9728
  ds_read_b64_tr_b16 a[140:141], v252 offset:9216
  s_add_u32 m0, s58, 155648
  s_add_u32 s56, s55, 393216
  s_waitcnt lgkmcnt(10)
  v_mfma_f32_32x32x16_bf16 v[48:63], a[124:127], a[144:147], 0
  buffer_load_dwordx4 v254, s[24:27], s56 offen lds
  v_mfma_f32_32x32x16_bf16 v[112:127], a[124:127], a[148:151], 0
  ds_read_b64_tr_b16 a[142:143], v252 offset:9728
  s_add_u32 m0, s58, 159744
  s_add_u32 s56, s55, 458752
  v_mfma_f32_32x32x16_bf16 v[176:191], a[124:127], a[152:155], 0
  buffer_load_dwordx4 v254, s[24:27], s56 offen lds
  s_waitcnt lgkmcnt(8)
  v_mfma_f32_32x32x16_bf16 v[0:15], a[128:131], a[156:159], v[0:15]
  ds_read_b64_tr_b16 a[112:113], v251 offset:16384
  ds_read_b64_tr_b16 a[114:115], v251 offset:16896
  s_add_u32 m0, s61, 0
  s_mov_b32 s59, 0
  s_waitcnt lgkmcnt(9)
  v_mfma_f32_32x32x16_bf16 v[64:79], a[128:131], a[160:163], v[64:79]
  buffer_load_dwordx4 v243, s[28:31], s59 offen offset:0 nt lds
  s_waitcnt lgkmcnt(8)
  v_mfma_f32_32x32x16_bf16 v[128:143], a[128:131], a[164:167], v[128:143]
  ds_read_b128 a[144:147], v250 offset:64
  ds_read_b128 a[148:151], v250 offset:4288
  s_waitcnt lgkmcnt(8)
  v_mfma_f32_32x32x16_bf16 v[16:31], a[132:135], a[156:159], v[16:31]
  buffer_load_dwordx4 v244, s[28:31], s59 offen offset:1024 nt lds
  v_mfma_f32_32x32x16_bf16 v[80:95], a[132:135], a[160:163], v[80:95]
  ds_read_b128 a[152:155], v250 offset:8512
  ds_read_b64_tr_b16 a[116:117], v252 offset:16384
  v_mfma_f32_32x32x16_bf16 v[144:159], a[132:135], a[164:167], v[144:159]
  buffer_load_dwordx4 v243, s[32:35], s59 offen offset:2048 nt lds
  s_waitcnt lgkmcnt(8)
  v_mfma_f32_32x32x16_bf16 v[32:47], a[136:139], a[156:159], v[32:47]
  ds_read_b64_tr_b16 a[118:119], v252 offset:16896
  ds_read_b64_tr_b16 a[120:121], v251 offset:17408
  v_mfma_f32_32x32x16_bf16 v[96:111], a[136:139], a[160:163], v[96:111]
  buffer_load_dwordx4 v244, s[32:35], s59 offen offset:3072 nt lds
  v_mfma_f32_32x32x16_bf16 v[160:175], a[136:139], a[164:167], v[160:175]
  ds_read_b64_tr_b16 a[122:123], v251 offset:17920
  ds_read_b64_tr_b16 a[124:125], v252 offset:17408
  s_add_u32 m0, s62, 16512
  s_mov_b32 s59, 0
  s_waitcnt lgkmcnt(10)
  v_mfma_f32_32x32x16_bf16 v[48:63], a[140:143], a[156:159], v[48:63]
  buffer_load_dwordx4 v245, s[36:39], s59 offen offset:0 nt lds
  v_mfma_f32_32x32x16_bf16 v[112:127], a[140:143], a[160:163], v[112:127]
  ds_read_b64_tr_b16 a[126:127], v252 offset:17920
  v_mfma_f32_32x32x16_bf16 v[176:191], a[140:143], a[164:167], v[176:191]
  buffer_load_dwordx4 v246, s[36:39], s59 offen offset:1024 nt lds
  s_waitcnt lgkmcnt(8)
  v_mfma_f32_32x32x16_bf16 v[0:15], a[112:115], a[144:147], v[0:15]
  ds_read_b64_tr_b16 a[128:129], v251 offset:24576
  ds_read_b64_tr_b16 a[130:131], v251 offset:25088
  s_waitcnt lgkmcnt(9)
  v_mfma_f32_32x32x16_bf16 v[64:79], a[112:115], a[148:151], v[64:79]
  buffer_load_dwordx4 v245, s[40:43], s59 offen offset:2048 nt lds
  s_waitcnt lgkmcnt(8)
  v_mfma_f32_32x32x16_bf16 v[128:143], a[112:115], a[152:155], v[128:143]
  ds_read_b128 a[156:159], v250 offset:96
  ds_read_b128 a[160:163], v250 offset:4320
  s_waitcnt lgkmcnt(8)
  v_mfma_f32_32x32x16_bf16 v[16:31], a[116:119], a[144:147], v[16:31]
  buffer_load_dwordx4 v246, s[40:43], s59 offen offset:3072 nt lds
  v_mfma_f32_32x32x16_bf16 v[80:95], a[116:119], a[148:151], v[80:95]
  ds_read_b128 a[164:167], v250 offset:8544
  ds_read_b64_tr_b16 a[132:133], v252 offset:24576
  v_mfma_f32_32x32x16_bf16 v[144:159], a[116:119], a[152:155], v[144:159]
  s_waitcnt lgkmcnt(8)
  v_mfma_f32_32x32x16_bf16 v[32:47], a[120:123], a[144:147], v[32:47]
  ds_read_b64_tr_b16 a[134:135], v252 offset:25088
  ds_read_b64_tr_b16 a[136:137], v251 offset:25600
  v_mfma_f32_32x32x16_bf16 v[96:111], a[120:123], a[148:151], v[96:111]
  v_mfma_f32_32x32x16_bf16 v[160:175], a[120:123], a[152:155], v[160:175]
  ds_read_b64_tr_b16 a[138:139], v251 offset:26112
  ds_read_b64_tr_b16 a[140:141], v252 offset:25600
  s_waitcnt lgkmcnt(10)
  v_mfma_f32_32x32x16_bf16 v[48:63], a[124:127], a[144:147], v[48:63]
  v_mfma_f32_32x32x16_bf16 v[112:127], a[124:127], a[148:151], v[112:127]
  ds_read_b64_tr_b16 a[142:143], v252 offset:26112
  v_mfma_f32_32x32x16_bf16 v[176:191], a[124:127], a[152:155], v[176:191]
  v_add_u32 v250, 58112, v250
  v_add_u32 v251, 58112, v251
  v_add_u32 v252, 58112, v252
  s_waitcnt lgkmcnt(0)
  s_waitcnt vmcnt(8)
  s_barrier
  v_mfma_f32_32x32x16_bf16 v[0:15], a[128:131], a[156:159], v[0:15]
  ds_read_b64_tr_b16 a[112:113], v251 offset:0
  ds_read_b64_tr_b16 a[114:115], v251 offset:512
  s_lshl_b32 s54, s52, 7
  s_add_u32 s54, s54, s50
  s_lshl_b32 s55, s52, 19
  s_add_u32 s55, s55, s51
  s_add_u32 s52, s52, 1
  s_and_b32 s52, s52, 7
  s_add_u32 m0, s57, 47616
  s_add_u32 s56, s54, 0
  v_mfma_f32_32x32x16_bf16 v[64:79], a[128:131], a[160:163], v[64:79]
  buffer_load_dwordx4 v253, s[20:23], s56 offen lds
  v_mfma_f32_32x32x16_bf16 v[128:143], a[128:131], a[164:167], v[128:143]
  ds_read_b128 a[144:147], v250 offset:0
  ds_read_b128 a[148:151], v250 offset:4224
  s_add_u32 m0, s57, 48672
  s_add_u32 s56, s54, 8192
  v_mfma_f32_32x32x16_bf16 v[16:31], a[132:135], a[156:159], v[16:31]
  buffer_load_dwordx4 v253, s[20:23], s56 offen lds
  v_mfma_f32_32x32x16_bf16 v[80:95], a[132:135], a[160:163], v[80:95]
  ds_read_b128 a[152:155], v250 offset:8448
  ds_read_b64_tr_b16 a[116:117], v252 offset:0
  s_add_u32 m0, s57, 49728
  s_add_u32 s56, s54, 16384
  v_mfma_f32_32x32x16_bf16 v[144:159], a[132:135], a[164:167], v[144:159]
  buffer_load_dwordx4 v253, s[20:23], s56 offen lds
  v_mfma_f32_32x32x16_bf16 v[32:47], a[136:139], a[156:159], v[32:47]
  ds_read_b64_tr_b16 a[118:119], v252 offset:512
  ds_read_b64_tr_b16 a[120:121], v251 offset:1024
  s_add_u32 m0, s57, 50784
  s_add_u32 s56, s54, 24576
  v_mfma_f32_32x32x16_bf16 v[96:111], a[136:139], a[160:163], v[96:111]
  buffer_load_dwordx4 v253, s[20:23], s56 offen lds
  v_mfma_f32_32x32x16_bf16 v[160:175], a[136:139], a[164:167], v[160:175]
  ds_read_b64_tr_b16 a[122:123], v251 offset:1536
  ds_read_b64_tr_b16 a[124:125], v252 offset:1024
  s_add_u32 m0, s57, 51840
  s_add_u32 s56, s54, 32768
  v_mfma_f32_32x32x16_bf16 v[48:63], a[140:143], a[156:159], v[48:63]
  buffer_load_dwordx4 v253, s[20:23], s56 offen lds
  v_mfma_f32_32x32x16_bf16 v[112:127], a[140:143], a[160:163], v[112:127]
  ds_read_b64_tr_b16 a[126:127], v252 offset:1536
  s_add_u32 m0, s57, 52896
  s_add_u32 s56, s54, 40960
  v_mfma_f32_32x32x16_bf16 v[176:191], a[140:143], a[164:167], v[176:191]
  buffer_load_dwordx4 v253, s[20:23], s56 offen lds
  s_waitcnt lgkmcnt(8)
  v_mfma_f32_32x32x16_bf16 v[0:15], a[112:115], a[144:147], v[0:15]
  ds_read_b64_tr_b16 a[128:129], v251 offset:8192
  ds_read_b64_tr_b16 a[130:131], v251 offset:8704
  s_add_u32 m0, s58, 72960
  s_add_u32 s56, s55, 0
  s_waitcnt lgkmcnt(9)
  v_mfma_f32_32x32x16_bf16 v[64:79], a[112:115], a[148:151], v[64:79]
  buffer_load_dwordx4 v254, s[24:27], s56 offen lds
  s_waitcnt lgkmcnt(8)
  v_mfma_f32_32x32x16_bf16 v[128:143], a[112:115], a[152:155], v[128:143]
  ds_read_b128 a[156:159], v250 offset:32
  ds_read_b128 a[160:163], v250 offset:4256
  s_add_u32 m0, s58, 77056
  s_add_u32 s56, s55, 65536
  s_waitcnt lgkmcnt(8)
  v_mfma_f32_32x32x16_bf16 v[16:31], a[116:119], a[144:147], v[16:31]
  buffer_load_dwordx4 v254, s[24:27], s56 offen lds
  v_mfma_f32_32x32x16_bf16 v[80:95], a[116:119], a[148:151], v[80:95]
  ds_read_b128 a[164:167], v250 offset:8480
  ds_read_b64_tr_b16 a[132:133], v252 offset:8192
  s_add_u32 m0, s58, 81152
  s_add_u32 s56, s55, 131072
  v_mfma_f32_32x32x16_bf16 v[144:159], a[116:119], a[152:155], v[144:159]
  buffer_load_dwordx4 v254, s[24:27], s56 offen lds
  s_waitcnt lgkmcnt(8)
  v_mfma_f32_32x32x16_bf16 v[32:47], a[120:123], a[144:147], v[32:47]
  ds_read_b64_tr_b16 a[134:135], v252 offset:8704
  ds_read_b64_tr_b16 a[136:137], v251 offset:9216
  s_add_u32 m0, s58, 85248
  s_add_u32 s56, s55, 196608
  v_mfma_f32_32x32x16_bf16 v[96:111], a[120:123], a[148:151], v[96:111]
  buffer_load_dwordx4 v254, s[24:27], s56 offen lds
  v_mfma_f32_32x32x16_bf16 v[160:175], a[120:123], a[152:155], v[160:175]
  ds_read_b64_tr_b16 a[138:139], v251 offset:9728
  ds_read_b64_tr_b16 a[140:141], v252 offset:9216
  s_add_u32 m0, s58, 89344
  s_add_u32 s56, s55, 262144
  s_waitcnt lgkmcnt(10)
  v_mfma_f32_32x32x16_bf16 v[48:63], a[124:127], a[144:147], v[48:63]
  buffer_load_dwordx4 v254, s[24:27], s56 offen lds
  v_mfma_f32_32x32x16_bf16 v[112:127], a[124:127], a[148:151], v[112:127]
  ds_read_b64_tr_b16 a[142:143], v252 offset:9728
  s_add_u32 m0, s58, 93440
  s_add_u32 s56, s55, 327680
  v_mfma_f32_32x32x16_bf16 v[176:191], a[124:127], a[152:155], v[176:191]
  buffer_load_dwordx4 v254, s[24:27], s56 offen lds
  s_waitcnt lgkmcnt(8)
  v_mfma_f32_32x32x16_bf16 v[0:15], a[128:131], a[156:159], v[0:15]
  ds_read_b64_tr_b16 a[112:113], v251 offset:16384
  ds_read_b64_tr_b16 a[114:115], v251 offset:16896
  s_add_u32 m0, s58, 97536
  s_add_u32 s56, s55, 393216
  s_waitcnt lgkmcnt(9)
  v_mfma_f32_32x32x16_bf16 v[64:79], a[128:131], a[160:163], v[64:79]
  buffer_load_dwordx4 v254, s[24:27], s56 offen lds
  s_waitcnt lgkmcnt(8)
  v_mfma_f32_32x32x16_bf16 v[128:143], a[128:131], a[164:167], v[128:143]
  ds_read_b128 a[144:147], v250 offset:64
  ds_read_b128 a[148:151], v250 offset:4288
  s_add_u32 m0, s58, 101632
  s_add_u32 s56, s55, 458752
  s_waitcnt lgkmcnt(8)
  v_mfma_f32_32x32x16_bf16 v[16:31], a[132:135], a[156:159], v[16:31]
  buffer_load_dwordx4 v254, s[24:27], s56 offen lds
  v_mfma_f32_32x32x16_bf16 v[80:95], a[132:135], a[160:163], v[80:95]
  ds_read_b128 a[152:155], v250 offset:8512
  ds_read_b64_tr_b16 a[116:117], v252 offset:16384
  s_mov_b32 s60, 8192
  v_mfma_f32_32x32x16_bf16 v[144:159], a[132:135], a[164:167], v[144:159]
  buffer_load_dwordx4 a[0:3], v243, s[28:31], s60 offen offset:0 nt
  s_waitcnt lgkmcnt(8)
  v_mfma_f32_32x32x16_bf16 v[32:47], a[136:139], a[156:159], v[32:47]
  ds_read_b64_tr_b16 a[118:119], v252 offset:16896
  ds_read_b64_tr_b16 a[120:121], v251 offset:17408
  v_mfma_f32_32x32x16_bf16 v[96:111], a[136:139], a[160:163], v[96:111]
  buffer_load_dwordx4 a[4:7], v244, s[28:31], s60 offen offset:1024 nt
  v_mfma_f32_32x32x16_bf16 v[160:175], a[136:139], a[164:167], v[160:175]
  ds_read_b64_tr_b16 a[122:123], v251 offset:17920
  ds_read_b64_tr_b16 a[124:125], v252 offset:17408
  s_waitcnt lgkmcnt(10)
  v_mfma_f32_32x32x16_bf16 v[48:63], a[140:143], a[156:159], v[48:63]
  buffer_load_dwordx4 a[8:11], v243, s[32:35], s60 offen offset:2048 nt
  v_mfma_f32_32x32x16_bf16 v[112:127], a[140:143], a[160:163], v[112:127]
  ds_read_b64_tr_b16 a[126:127], v252 offset:17920
  v_mfma_f32_32x32x16_bf16 v[176:191], a[140:143], a[164:167], v[176:191]
  buffer_load_dwordx4 a[12:15], v244, s[32:35], s60 offen offset:3072 nt
  s_waitcnt lgkmcnt(8)
  v_mfma_f32_32x32x16_bf16 v[0:15], a[112:115], a[144:147], v[0:15]
  ds_read_b64_tr_b16 a[128:129], v251 offset:24576
  ds_read_b64_tr_b16 a[130:131], v251 offset:25088
  s_waitcnt lgkmcnt(9)
  v_mfma_f32_32x32x16_bf16 v[64:79], a[112:115], a[148:151], v[64:79]
  s_waitcnt lgkmcnt(8)
  v_mfma_f32_32x32x16_bf16 v[128:143], a[112:115], a[152:155], v[128:143]
  ds_read_b128 a[156:159], v250 offset:96
  ds_read_b128 a[160:163], v250 offset:4320
  s_waitcnt lgkmcnt(8)
  v_mfma_f32_32x32x16_bf16 v[16:31], a[116:119], a[144:147], v[16:31]
  v_mfma_f32_32x32x16_bf16 v[80:95], a[116:119], a[148:151], v[80:95]
  ds_read_b128 a[164:167], v250 offset:8544
  ds_read_b64_tr_b16 a[132:133], v252 offset:24576
  v_mfma_f32_32x32x16_bf16 v[144:159], a[116:119], a[152:155], v[144:159]
  s_waitcnt lgkmcnt(8)
  v_mfma_f32_32x32x16_bf16 v[32:47], a[120:123], a[144:147], v[32:47]
  ds_read_b64_tr_b16 a[134:135], v252 offset:25088
  ds_read_b64_tr_b16 a[136:137], v251 offset:25600
  v_mfma_f32_32x32x16_bf16 v[96:111], a[120:123], a[148:151], v[96:111]
  v_mfma_f32_32x32x16_bf16 v[160:175], a[120:123], a[152:155], v[160:175]
  ds_read_b64_tr_b16 a[138:139], v251 offset:26112
  ds_read_b64_tr_b16 a[140:141], v252 offset:25600
  s_waitcnt lgkmcnt(10)
  v_mfma_f32_32x32x16_bf16 v[48:63], a[124:127], a[144:147], v[48:63]
  v_mfma_f32_32x32x16_bf16 v[112:127], a[124:127], a[148:151], v[112:127]
  ds_read_b64_tr_b16 a[142:143], v252 offset:26112
  v_mfma_f32_32x32x16_bf16 v[176:191], a[124:127], a[152:155], v[176:191]
  v_subrev_u32 v250, 58112, v250
  v_subrev_u32 v251, 58112, v251
  v_subrev_u32 v252, 58112, v252
  s_waitcnt lgkmcnt(0)
  s_waitcnt vmcnt(4)
  s_barrier
  v_mfma_f32_32x32x16_bf16 v[0:15], a[128:131], a[156:159], v[0:15]
  ds_read_b64_tr_b16 a[112:113], v251 offset:0
  ds_read_b64_tr_b16 a[114:115], v251 offset:512
  s_lshl_b32 s54, s52, 7
  s_add_u32 s54, s54, s50
  s_lshl_b32 s55, s52, 19
  s_add_u32 s55, s55, s51
  s_add_u32 s52, s52, 1
  s_and_b32 s52, s52, 7
  s_add_u32 m0, s57, 105728
  s_add_u32 s56, s54, 0
  v_mfma_f32_32x32x16_bf16 v[64:79], a[128:131], a[160:163], v[64:79]
  buffer_load_dwordx4 v253, s[20:23], s56 offen lds
  v_mfma_f32_32x32x16_bf16 v[128:143], a[128:131], a[164:167], v[128:143]
  ds_read_b128 a[144:147], v250 offset:0
  ds_read_b128 a[148:151], v250 offset:4224
  s_add_u32 m0, s57, 106784
  s_add_u32 s56, s54, 8192
  v_mfma_f32_32x32x16_bf16 v[16:31], a[132:135], a[156:159], v[16:31]
  buffer_load_dwordx4 v253, s[20:23], s56 offen lds
  v_mfma_f32_32x32x16_bf16 v[80:95], a[132:135], a[160:163], v[80:95]
  ds_read_b128 a[152:155], v250 offset:8448
  ds_read_b64_tr_b16 a[116:117], v252 offset:0
  s_add_u32 m0, s57, 107840
  s_add_u32 s56, s54, 16384
  v_mfma_f32_32x32x16_bf16 v[144:159], a[132:135], a[164:167], v[144:159]
  buffer_load_dwordx4 v253, s[20:23], s56 offen lds
  v_mfma_f32_32x32x16_bf16 v[32:47], a[136:139], a[156:159], v[32:47]
  ds_read_b64_tr_b16 a[118:119], v252 offset:512
  ds_read_b64_tr_b16 a[120:121], v251 offset:1024
  s_add_u32 m0, s57, 108896
  s_add_u32 s56, s54, 24576
  v_mfma_f32_32x32x16_bf16 v[96:111], a[136:139], a[160:163], v[96:111]
  buffer_load_dwordx4 v253, s[20:23], s56 offen lds
  v_mfma_f32_32x32x16_bf16 v[160:175], a[136:139], a[164:167], v[160:175]
  ds_read_b64_tr_b16 a[122:123], v251 offset:1536
  ds_read_b64_tr_b16 a[124:125], v252 offset:1024
  s_add_u32 m0, s57, 109952
  s_add_u32 s56, s54, 32768
  v_mfma_f32_32x32x16_bf16 v[48:63], a[140:143], a[156:159], v[48:63]
  buffer_load_dwordx4 v253, s[20:23], s56 offen lds
  v_mfma_f32_32x32x16_bf16 v[112:127], a[140:143], a[160:163], v[112:127]
  ds_read_b64_tr_b16 a[126:127], v252 offset:1536
  s_add_u32 m0, s57, 111008
  s_add_u32 s56, s54, 40960
  v_mfma_f32_32x32x16_bf16 v[176:191], a[140:143], a[164:167], v[176:191]
  buffer_load_dwordx4 v253, s[20:23], s56 offen lds
  s_waitcnt lgkmcnt(8)
  v_mfma_f32_32x32x16_bf16 v[0:15], a[112:115], a[144:147], v[0:15]
  ds_read_b64_tr_b16 a[128:129], v251 offset:8192
  ds_read_b64_tr_b16 a[130:131], v251 offset:8704
  s_add_u32 m0, s58, 131072
  s_add_u32 s56, s55, 0
  s_waitcnt lgkmcnt(9)
  v_mfma_f32_32x32x16_bf16 v[64:79], a[112:115], a[148:151], v[64:79]
  buffer_load_dwordx4 v254, s[24:27], s56 offen lds
  s_waitcnt lgkmcnt(8)
  v_mfma_f32_32x32x16_bf16 v[128:143], a[112:115], a[152:155], v[128:143]
  ds_read_b128 a[156:159], v250 offset:32
  ds_read_b128 a[160:163], v250 offset:4256
  s_add_u32 m0, s58, 135168
  s_add_u32 s56, s55, 65536
  s_waitcnt lgkmcnt(8)
  v_mfma_f32_32x32x16_bf16 v[16:31], a[116:119], a[144:147], v[16:31]
  buffer_load_dwordx4 v254, s[24:27], s56 offen lds
  v_mfma_f32_32x32x16_bf16 v[80:95], a[116:119], a[148:151], v[80:95]
  ds_read_b128 a[164:167], v250 offset:8480
  ds_read_b64_tr_b16 a[132:133], v252 offset:8192
  s_add_u32 m0, s58, 139264
  s_add_u32 s56, s55, 131072
  v_mfma_f32_32x32x16_bf16 v[144:159], a[116:119], a[152:155], v[144:159]
  buffer_load_dwordx4 v254, s[24:27], s56 offen lds
  s_waitcnt lgkmcnt(8)
  v_mfma_f32_32x32x16_bf16 v[32:47], a[120:123], a[144:147], v[32:47]
  ds_read_b64_tr_b16 a[134:135], v252 offset:8704
  ds_read_b64_tr_b16 a[136:137], v251 offset:9216
  s_add_u32 m0, s58, 143360
  s_add_u32 s56, s55, 196608
  v_mfma_f32_32x32x16_bf16 v[96:111], a[120:123], a[148:151], v[96:111]
  buffer_load_dwordx4 v254, s[24:27], s56 offen lds
  v_mfma_f32_32x32x16_bf16 v[160:175], a[120:123], a[152:155], v[160:175]
  ds_read_b64_tr_b16 a[138:139], v251 offset:9728
  ds_read_b64_tr_b16 a[140:141], v252 offset:9216
  s_add_u32 m0, s58, 147456
  s_add_u32 s56, s55, 262144
  s_waitcnt lgkmcnt(10)
  v_mfma_f32_32x32x16_bf16 v[48:63], a[124:127], a[144:147], v[48:63]
  buffer_load_dwordx4 v254, s[24:27], s56 offen lds
  v_mfma_f32_32x32x16_bf16 v[112:127], a[124:127], a[148:151], v[112:127]
  ds_read_b64_tr_b16 a[142:143], v252 offset:9728
  s_add_u32 m0, s58, 151552
  s_add_u32 s56, s55, 327680
  v_mfma_f32_32x32x16_bf16 v[176:191], a[124:127], a[152:155], v[176:191]
  buffer_load_dwordx4 v254, s[24:27], s56 offen lds
  s_waitcnt lgkmcnt(8)
  v_mfma_f32_32x32x16_bf16 v[0:15], a[128:131], a[156:159], v[0:15]
  ds_read_b64_tr_b16 a[112:113], v251 offset:16384
  ds_read_b64_tr_b16 a[114:115], v251 offset:16896
  s_add_u32 m0, s58, 155648
  s_add_u32 s56, s55, 393216
  s_waitcnt lgkmcnt(9)
  v_mfma_f32_32x32x16_bf16 v[64:79], a[128:131], a[160:163], v[64:79]
  buffer_load_dwordx4 v254, s[24:27], s56 offen lds
  s_waitcnt lgkmcnt(8)
  v_mfma_f32_32x32x16_bf16 v[128:143], a[128:131], a[164:167], v[128:143]
  ds_read_b128 a[144:147], v250 offset:64
  ds_read_b128 a[148:151], v250 offset:4288
  s_add_u32 m0, s58, 159744
  s_add_u32 s56, s55, 458752
  s_waitcnt lgkmcnt(8)
  v_mfma_f32_32x32x16_bf16 v[16:31], a[132:135], a[156:159], v[16:31]
  buffer_load_dwordx4 v254, s[24:27], s56 offen lds
  v_mfma_f32_32x32x16_bf16 v[80:95], a[132:135], a[160:163], v[80:95]
  ds_read_b128 a[152:155], v250 offset:8512
  ds_read_b64_tr_b16 a[116:117], v252 offset:16384
  s_mov_b32 s60, 8192
  v_mfma_f32_32x32x16_bf16 v[144:159], a[132:135], a[164:167], v[144:159]
  buffer_load_dwordx4 a[16:19], v245, s[36:39], s60 offen offset:0 nt
  s_waitcnt lgkmcnt(8)
  v_mfma_f32_32x32x16_bf16 v[32:47], a[136:139], a[156:159], v[32:47]
  ds_read_b64_tr_b16 a[118:119], v252 offset:16896
  ds_read_b64_tr_b16 a[120:121], v251 offset:17408
  v_mfma_f32_32x32x16_bf16 v[96:111], a[136:139], a[160:163], v[96:111]
  buffer_load_dwordx4 a[20:23], v246, s[36:39], s60 offen offset:1024 nt
  v_mfma_f32_32x32x16_bf16 v[160:175], a[136:139], a[164:167], v[160:175]
  ds_read_b64_tr_b16 a[122:123], v251 offset:17920
  ds_read_b64_tr_b16 a[124:125], v252 offset:17408
  s_waitcnt lgkmcnt(10)
  v_mfma_f32_32x32x16_bf16 v[48:63], a[140:143], a[156:159], v[48:63]
  buffer_load_dwordx4 a[24:27], v245, s[40:43], s60 offen offset:2048 nt
  v_mfma_f32_32x32x16_bf16 v[112:127], a[140:143], a[160:163], v[112:127]
  ds_read_b64_tr_b16 a[126:127], v252 offset:17920
  v_mfma_f32_32x32x16_bf16 v[176:191], a[140:143], a[164:167], v[176:191]
  buffer_load_dwordx4 a[28:31], v246, s[40:43], s60 offen offset:3072 nt
  s_waitcnt lgkmcnt(8)
  v_mfma_f32_32x32x16_bf16 v[0:15], a[112:115], a[144:147], v[0:15]
  ds_read_b64_tr_b16 a[128:129], v251 offset:24576
  ds_read_b64_tr_b16 a[130:131], v251 offset:25088
  s_waitcnt lgkmcnt(9)
  v_mfma_f32_32x32x16_bf16 v[64:79], a[112:115], a[148:151], v[64:79]
  s_waitcnt lgkmcnt(8)
  v_mfma_f32_32x32x16_bf16 v[128:143], a[112:115], a[152:155], v[128:143]
  ds_read_b128 a[156:159], v250 offset:96
  ds_read_b128 a[160:163], v250 offset:4320
  s_waitcnt lgkmcnt(8)
  v_mfma_f32_32x32x16_bf16 v[16:31], a[116:119], a[144:147], v[16:31]
  v_mfma_f32_32x32x16_bf16 v[80:95], a[116:119], a[148:151], v[80:95]
  ds_read_b128 a[164:167], v250 offset:8544
  ds_read_b64_tr_b16 a[132:133], v252 offset:24576
  v_mfma_f32_32x32x16_bf16 v[144:159], a[116:119], a[152:155], v[144:159]
  s_waitcnt lgkmcnt(8)
  v_mfma_f32_32x32x16_bf16 v[32:47], a[120:123], a[144:147], v[32:47]
  ds_read_b64_tr_b16 a[134:135], v252 offset:25088
  ds_read_b64_tr_b16 a[136:137], v251 offset:25600
  v_mfma_f32_32x32x16_bf16 v[96:111], a[120:123], a[148:151], v[96:111]
  v_mfma_f32_32x32x16_bf16 v[160:175], a[120:123], a[152:155], v[160:175]
  ds_read_b64_tr_b16 a[138:139], v251 offset:26112
  ds_read_b64_tr_b16 a[140:141], v252 offset:25600
  s_waitcnt lgkmcnt(10)
  v_mfma_f32_32x32x16_bf16 v[48:63], a[124:127], a[144:147], v[48:63]
  v_mfma_f32_32x32x16_bf16 v[112:127], a[124:127], a[148:151], v[112:127]
  ds_read_b64_tr_b16 a[142:143], v252 offset:26112
  v_mfma_f32_32x32x16_bf16 v[176:191], a[124:127], a[152:155], v[176:191]
  v_add_u32 v250, 58112, v250
  v_add_u32 v251, 58112, v251
  v_add_u32 v252, 58112, v252
  s_waitcnt lgkmcnt(0)
  s_waitcnt vmcnt(4)
  s_barrier
  v_mfma_f32_32x32x16_bf16 v[0:15], a[128:131], a[156:159], v[0:15]
  ds_read_b64_tr_b16 a[112:113], v251 offset:0
  ds_read_b64_tr_b16 a[114:115], v251 offset:512
  s_lshl_b32 s54, s52, 7
  s_add_u32 s54, s54, s50
  s_lshl_b32 s55, s52, 19
  s_add_u32 s55, s55, s51
  s_add_u32 s52, s52, 1
  s_and_b32 s52, s52, 7
  s_add_u32 m0, s57, 47616
  s_add_u32 s56, s54, 0
  v_mfma_f32_32x32x16_bf16 v[64:79], a[128:131], a[160:163], v[64:79]
  buffer_load_dwordx4 v253, s[20:23], s56 offen lds
  v_mfma_f32_32x32x16_bf16 v[128:143], a[128:131], a[164:167], v[128:143]
  ds_read_b128 a[144:147], v250 offset:0
  ds_read_b128 a[148:151], v250 offset:4224
  s_add_u32 m0, s57, 48672
  s_add_u32 s56, s54, 8192
  v_mfma_f32_32x32x16_bf16 v[16:31], a[132:135], a[156:159], v[16:31]
  buffer_load_dwordx4 v253, s[20:23], s56 offen lds
  v_mfma_f32_32x32x16_bf16 v[80:95], a[132:135], a[160:163], v[80:95]
  ds_read_b128 a[152:155], v250 offset:8448
  ds_read_b64_tr_b16 a[116:117], v252 offset:0
  s_add_u32 m0, s57, 49728
  s_add_u32 s56, s54, 16384
  v_mfma_f32_32x32x16_bf16 v[144:159], a[132:135], a[164:167], v[144:159]
  buffer_load_dwordx4 v253, s[20:23], s56 offen lds
  v_mfma_f32_32x32x16_bf16 v[32:47], a[136:139], a[156:159], v[32:47]
  ds_read_b64_tr_b16 a[118:119], v252 offset:512
  ds_read_b64_tr_b16 a[120:121], v251 offset:1024
  s_add_u32 m0, s57, 50784
  s_add_u32 s56, s54, 24576
  v_mfma_f32_32x32x16_bf16 v[96:111], a[136:139], a[160:163], v[96:111]
  buffer_load_dwordx4 v253, s[20:23], s56 offen lds
  v_mfma_f32_32x32x16_bf16 v[160:175], a[136:139], a[164:167], v[160:175]
  ds_read_b64_tr_b16 a[122:123], v251 offset:1536
  ds_read_b64_tr_b16 a[124:125], v252 offset:1024
  s_add_u32 m0, s57, 51840
  s_add_u32 s56, s54, 32768
  v_mfma_f32_32x32x16_bf16 v[48:63], a[140:143], a[156:159], v[48:63]
  buffer_load_dwordx4 v253, s[20:23], s56 offen lds
  v_mfma_f32_32x32x16_bf16 v[112:127], a[140:143], a[160:163], v[112:127]
  ds_read_b64_tr_b16 a[126:127], v252 offset:1536
  s_add_u32 m0, s57, 52896
  s_add_u32 s56, s54, 40960
  v_mfma_f32_32x32x16_bf16 v[176:191], a[140:143], a[164:167], v[176:191]
  buffer_load_dwordx4 v253, s[20:23], s56 offen lds
  s_waitcnt lgkmcnt(8)
  v_mfma_f32_32x32x16_bf16 v[0:15], a[112:115], a[144:147], v[0:15]
  ds_read_b64_tr_b16 a[128:129], v251 offset:8192
  ds_read_b64_tr_b16 a[130:131], v251 offset:8704
  s_add_u32 m0, s58, 72960
  s_add_u32 s56, s55, 0
  s_waitcnt lgkmcnt(9)
  v_mfma_f32_32x32x16_bf16 v[64:79], a[112:115], a[148:151], v[64:79]
  buffer_load_dwordx4 v254, s[24:27], s56 offen lds
  s_waitcnt lgkmcnt(8)
  v_mfma_f32_32x32x16_bf16 v[128:143], a[112:115], a[152:155], v[128:143]
  ds_read_b128 a[156:159], v250 offset:32
  ds_read_b128 a[160:163], v250 offset:4256
  s_add_u32 m0, s58, 77056
  s_add_u32 s56, s55, 65536
  s_waitcnt lgkmcnt(8)
  v_mfma_f32_32x32x16_bf16 v[16:31], a[116:119], a[144:147], v[16:31]
  buffer_load_dwordx4 v254, s[24:27], s56 offen lds
  v_mfma_f32_32x32x16_bf16 v[80:95], a[116:119], a[148:151], v[80:95]
  ds_read_b128 a[164:167], v250 offset:8480
  ds_read_b64_tr_b16 a[132:133], v252 offset:8192
  s_add_u32 m0, s58, 81152
  s_add_u32 s56, s55, 131072
  v_mfma_f32_32x32x16_bf16 v[144:159], a[116:119], a[152:155], v[144:159]
  buffer_load_dwordx4 v254, s[24:27], s56 offen lds
  s_waitcnt lgkmcnt(8)
  v_mfma_f32_32x32x16_bf16 v[32:47], a[120:123], a[144:147], v[32:47]
  ds_read_b64_tr_b16 a[134:135], v252 offset:8704
  ds_read_b64_tr_b16 a[136:137], v251 offset:9216
  s_add_u32 m0, s58, 85248
  s_add_u32 s56, s55, 196608
  v_mfma_f32_32x32x16_bf16 v[96:111], a[120:123], a[148:151], v[96:111]
  buffer_load_dwordx4 v254, s[24:27], s56 offen lds
  v_mfma_f32_32x32x16_bf16 v[160:175], a[120:123], a[152:155], v[160:175]
  ds_read_b64_tr_b16 a[138:139], v251 offset:9728
  ds_read_b64_tr_b16 a[140:141], v252 offset:9216
  s_add_u32 m0, s58, 89344
  s_add_u32 s56, s55, 262144
  s_waitcnt lgkmcnt(10)
  v_mfma_f32_32x32x16_bf16 v[48:63], a[124:127], a[144:147], v[48:63]
  buffer_load_dwordx4 v254, s[24:27], s56 offen lds
  v_mfma_f32_32x32x16_bf16 v[112:127], a[124:127], a[148:151], v[112:127]
  ds_read_b64_tr_b16 a[142:143], v252 offset:9728
  s_add_u32 m0, s58, 93440
  s_add_u32 s56, s55, 327680
  v_mfma_f32_32x32x16_bf16 v[176:191], a[124:127], a[152:155], v[176:191]
  buffer_load_dwordx4 v254, s[24:27], s56 offen lds
  s_waitcnt lgkmcnt(8)
  v_mfma_f32_32x32x16_bf16 v[0:15], a[128:131], a[156:159], v[0:15]
  ds_read_b64_tr_b16 a[112:113], v251 offset:16384
  ds_read_b64_tr_b16 a[114:115], v251 offset:16896
  s_add_u32 m0, s58, 97536
  s_add_u32 s56, s55, 393216
  s_waitcnt lgkmcnt(9)
  v_mfma_f32_32x32x16_bf16 v[64:79], a[128:131], a[160:163], v[64:79]
  buffer_load_dwordx4 v254, s[24:27], s56 offen lds
  s_waitcnt lgkmcnt(8)
  v_mfma_f32_32x32x16_bf16 v[128:143], a[128:131], a[164:167], v[128:143]
  ds_read_b128 a[144:147], v250 offset:64
  ds_read_b128 a[148:151], v250 offset:4288
  s_add_u32 m0, s58, 101632
  s_add_u32 s56, s55, 458752
  s_waitcnt lgkmcnt(8)
  v_mfma_f32_32x32x16_bf16 v[16:31], a[132:135], a[156:159], v[16:31]
  buffer_load_dwordx4 v254, s[24:27], s56 offen lds
  v_mfma_f32_32x32x16_bf16 v[80:95], a[132:135], a[160:163], v[80:95]
  ds_read_b128 a[152:155], v250 offset:8512
  ds_read_b64_tr_b16 a[116:117], v252 offset:16384
  s_mov_b32 s60, 16384
  v_mfma_f32_32x32x16_bf16 v[144:159], a[132:135], a[164:167], v[144:159]
  buffer_load_dwordx4 a[32:35], v243, s[28:31], s60 offen offset:0 nt
  s_waitcnt lgkmcnt(8)
  v_mfma_f32_32x32x16_bf16 v[32:47], a[136:139], a[156:159], v[32:47]
  ds_read_b64_tr_b16 a[118:119], v252 offset:16896
  ds_read_b64_tr_b16 a[120:121], v251 offset:17408
  v_mfma_f32_32x32x16_bf16 v[96:111], a[136:139], a[160:163], v[96:111]
  buffer_load_dwordx4 a[36:39], v244, s[28:31], s60 offen offset:1024 nt
  v_mfma_f32_32x32x16_bf16 v[160:175], a[136:139], a[164:167], v[160:175]
  ds_read_b64_tr_b16 a[122:123], v251 offset:17920
  ds_read_b64_tr_b16 a[124:125], v252 offset:17408
  s_waitcnt lgkmcnt(10)
  v_mfma_f32_32x32x16_bf16 v[48:63], a[140:143], a[156:159], v[48:63]
  buffer_load_dwordx4 a[40:43], v243, s[32:35], s60 offen offset:2048 nt
  v_mfma_f32_32x32x16_bf16 v[112:127], a[140:143], a[160:163], v[112:127]
  ds_read_b64_tr_b16 a[126:127], v252 offset:17920
  v_mfma_f32_32x32x16_bf16 v[176:191], a[140:143], a[164:167], v[176:191]
  buffer_load_dwordx4 a[44:47], v244, s[32:35], s60 offen offset:3072 nt
  s_waitcnt lgkmcnt(8)
  v_mfma_f32_32x32x16_bf16 v[0:15], a[112:115], a[144:147], v[0:15]
  ds_read_b64_tr_b16 a[128:129], v251 offset:24576
  ds_read_b64_tr_b16 a[130:131], v251 offset:25088
  s_waitcnt lgkmcnt(9)
  v_mfma_f32_32x32x16_bf16 v[64:79], a[112:115], a[148:151], v[64:79]
  s_waitcnt lgkmcnt(8)
  v_mfma_f32_32x32x16_bf16 v[128:143], a[112:115], a[152:155], v[128:143]
  ds_read_b128 a[156:159], v250 offset:96
  ds_read_b128 a[160:163], v250 offset:4320
  s_waitcnt lgkmcnt(8)
  v_mfma_f32_32x32x16_bf16 v[16:31], a[116:119], a[144:147], v[16:31]
  v_mfma_f32_32x32x16_bf16 v[80:95], a[116:119], a[148:151], v[80:95]
  ds_read_b128 a[164:167], v250 offset:8544
  ds_read_b64_tr_b16 a[132:133], v252 offset:24576
  v_mfma_f32_32x32x16_bf16 v[144:159], a[116:119], a[152:155], v[144:159]
  s_waitcnt lgkmcnt(8)
  v_mfma_f32_32x32x16_bf16 v[32:47], a[120:123], a[144:147], v[32:47]
  ds_read_b64_tr_b16 a[134:135], v252 offset:25088
  ds_read_b64_tr_b16 a[136:137], v251 offset:25600
  v_mfma_f32_32x32x16_bf16 v[96:111], a[120:123], a[148:151], v[96:111]
  v_mfma_f32_32x32x16_bf16 v[160:175], a[120:123], a[152:155], v[160:175]
  ds_read_b64_tr_b16 a[138:139], v251 offset:26112
  ds_read_b64_tr_b16 a[140:141], v252 offset:25600
  s_waitcnt lgkmcnt(10)
  v_mfma_f32_32x32x16_bf16 v[48:63], a[124:127], a[144:147], v[48:63]
  v_mfma_f32_32x32x16_bf16 v[112:127], a[124:127], a[148:151], v[112:127]
  ds_read_b64_tr_b16 a[142:143], v252 offset:26112
  v_mfma_f32_32x32x16_bf16 v[176:191], a[124:127], a[152:155], v[176:191]
  v_subrev_u32 v250, 58112, v250
  v_subrev_u32 v251, 58112, v251
  v_subrev_u32 v252, 58112, v252
  s_waitcnt lgkmcnt(0)
  s_waitcnt vmcnt(4)
  s_barrier
  v_mfma_f32_32x32x16_bf16 v[0:15], a[128:131], a[156:159], v[0:15]
  ds_read_b64_tr_b16 a[112:113], v251 offset:0
  ds_read_b64_tr_b16 a[114:115], v251 offset:512
  s_lshl_b32 s54, s52, 7
  s_add_u32 s54, s54, s50
  s_lshl_b32 s55, s52, 19
  s_add_u32 s55, s55, s51
  s_add_u32 s52, s52, 1
  s_and_b32 s52, s52, 7
  s_add_u32 m0, s57, 105728
  s_add_u32 s56, s54, 0
  v_mfma_f32_32x32x16_bf16 v[64:79], a[128:131], a[160:163], v[64:79]
  buffer_load_dwordx4 v253, s[20:23], s56 offen lds
  v_mfma_f32_32x32x16_bf16 v[128:143], a[128:131], a[164:167], v[128:143]
  ds_read_b128 a[144:147], v250 offset:0
  ds_read_b128 a[148:151], v250 offset:4224
  s_add_u32 m0, s57, 106784
  s_add_u32 s56, s54, 8192
  v_mfma_f32_32x32x16_bf16 v[16:31], a[132:135], a[156:159], v[16:31]
  buffer_load_dwordx4 v253, s[20:23], s56 offen lds
  v_mfma_f32_32x32x16_bf16 v[80:95], a[132:135], a[160:163], v[80:95]
  ds_read_b128 a[152:155], v250 offset:8448
  ds_read_b64_tr_b16 a[116:117], v252 offset:0
  s_add_u32 m0, s57, 107840
  s_add_u32 s56, s54, 16384
  v_mfma_f32_32x32x16_bf16 v[144:159], a[132:135], a[164:167], v[144:159]
  buffer_load_dwordx4 v253, s[20:23], s56 offen lds
  v_mfma_f32_32x32x16_bf16 v[32:47], a[136:139], a[156:159], v[32:47]
  ds_read_b64_tr_b16 a[118:119], v252 offset:512
  ds_read_b64_tr_b16 a[120:121], v251 offset:1024
  s_add_u32 m0, s57, 108896
  s_add_u32 s56, s54, 24576
  v_mfma_f32_32x32x16_bf16 v[96:111], a[136:139], a[160:163], v[96:111]
  buffer_load_dwordx4 v253, s[20:23], s56 offen lds
  v_mfma_f32_32x32x16_bf16 v[160:175], a[136:139], a[164:167], v[160:175]
  ds_read_b64_tr_b16 a[122:123], v251 offset:1536
  ds_read_b64_tr_b16 a[124:125], v252 offset:1024
  s_add_u32 m0, s57, 109952
  s_add_u32 s56, s54, 32768
  v_mfma_f32_32x32x16_bf16 v[48:63], a[140:143], a[156:159], v[48:63]
  buffer_load_dwordx4 v253, s[20:23], s56 offen lds
  v_mfma_f32_32x32x16_bf16 v[112:127], a[140:143], a[160:163], v[112:127]
  ds_read_b64_tr_b16 a[126:127], v252 offset:1536
  s_add_u32 m0, s57, 111008
  s_add_u32 s56, s54, 40960
  v_mfma_f32_32x32x16_bf16 v[176:191], a[140:143], a[164:167], v[176:191]
  buffer_load_dwordx4 v253, s[20:23], s56 offen lds
  s_waitcnt lgkmcnt(8)
  v_mfma_f32_32x32x16_bf16 v[0:15], a[112:115], a[144:147], v[0:15]
  ds_read_b64_tr_b16 a[128:129], v251 offset:8192
  ds_read_b64_tr_b16 a[130:131], v251 offset:8704
  s_add_u32 m0, s58, 131072
  s_add_u32 s56, s55, 0
  s_waitcnt lgkmcnt(9)
  v_mfma_f32_32x32x16_bf16 v[64:79], a[112:115], a[148:151], v[64:79]
  buffer_load_dwordx4 v254, s[24:27], s56 offen lds
  s_waitcnt lgkmcnt(8)
  v_mfma_f32_32x32x16_bf16 v[128:143], a[112:115], a[152:155], v[128:143]
  ds_read_b128 a[156:159], v250 offset:32
  ds_read_b128 a[160:163], v250 offset:4256
  s_add_u32 m0, s58, 135168
  s_add_u32 s56, s55, 65536
  s_waitcnt lgkmcnt(8)
  v_mfma_f32_32x32x16_bf16 v[16:31], a[116:119], a[144:147], v[16:31]
  buffer_load_dwordx4 v254, s[24:27], s56 offen lds
  v_mfma_f32_32x32x16_bf16 v[80:95], a[116:119], a[148:151], v[80:95]
  ds_read_b128 a[164:167], v250 offset:8480
  ds_read_b64_tr_b16 a[132:133], v252 offset:8192
  s_add_u32 m0, s58, 139264
  s_add_u32 s56, s55, 131072
  v_mfma_f32_32x32x16_bf16 v[144:159], a[116:119], a[152:155], v[144:159]
  buffer_load_dwordx4 v254, s[24:27], s56 offen lds
  s_waitcnt lgkmcnt(8)
  v_mfma_f32_32x32x16_bf16 v[32:47], a[120:123], a[144:147], v[32:47]
  ds_read_b64_tr_b16 a[134:135], v252 offset:8704
  ds_read_b64_tr_b16 a[136:137], v251 offset:9216
  s_add_u32 m0, s58, 143360
  s_add_u32 s56, s55, 196608
  v_mfma_f32_32x32x16_bf16 v[96:111], a[120:123], a[148:151], v[96:111]
  buffer_load_dwordx4 v254, s[24:27], s56 offen lds
  v_mfma_f32_32x32x16_bf16 v[160:175], a[120:123], a[152:155], v[160:175]
  ds_read_b64_tr_b16 a[138:139], v251 offset:9728
  ds_read_b64_tr_b16 a[140:141], v252 offset:9216
  s_add_u32 m0, s58, 147456
  s_add_u32 s56, s55, 262144
  s_waitcnt lgkmcnt(10)
  v_mfma_f32_32x32x16_bf16 v[48:63], a[124:127], a[144:147], v[48:63]
  buffer_load_dwordx4 v254, s[24:27], s56 offen lds
  v_mfma_f32_32x32x16_bf16 v[112:127], a[124:127], a[148:151], v[112:127]
  ds_read_b64_tr_b16 a[142:143], v252 offset:9728
  s_add_u32 m0, s58, 151552
  s_add_u32 s56, s55, 327680
  v_mfma_f32_32x32x16_bf16 v[176:191], a[124:127], a[152:155], v[176:191]
  buffer_load_dwordx4 v254, s[24:27], s56 offen lds
  s_waitcnt lgkmcnt(8)
  v_mfma_f32_32x32x16_bf16 v[0:15], a[128:131], a[156:159], v[0:15]
  ds_read_b64_tr_b16 a[112:113], v251 offset:16384
  ds_read_b64_tr_b16 a[114:115], v251 offset:16896
  s_add_u32 m0, s58, 155648
  s_add_u32 s56, s55, 393216
  s_waitcnt lgkmcnt(9)
  v_mfma_f32_32x32x16_bf16 v[64:79], a[128:131], a[160:163], v[64:79]
  buffer_load_dwordx4 v254, s[24:27], s56 offen lds
  s_waitcnt lgkmcnt(8)
  v_mfma_f32_32x32x16_bf16 v[128:143], a[128:131], a[164:167], v[128:143]
  ds_read_b128 a[144:147], v250 offset:64
  ds_read_b128 a[148:151], v250 offset:4288
  s_add_u32 m0, s58, 159744
  s_add_u32 s56, s55, 458752
  s_waitcnt lgkmcnt(8)
  v_mfma_f32_32x32x16_bf16 v[16:31], a[132:135], a[156:159], v[16:31]
  buffer_load_dwordx4 v254, s[24:27], s56 offen lds
  v_mfma_f32_32x32x16_bf16 v[80:95], a[132:135], a[160:163], v[80:95]
  ds_read_b128 a[152:155], v250 offset:8512
  ds_read_b64_tr_b16 a[116:117], v252 offset:16384
  s_mov_b32 s60, 16384
  v_mfma_f32_32x32x16_bf16 v[144:159], a[132:135], a[164:167], v[144:159]
  buffer_load_dwordx4 a[48:51], v245, s[36:39], s60 offen offset:0 nt
  s_waitcnt lgkmcnt(8)
  v_mfma_f32_32x32x16_bf16 v[32:47], a[136:139], a[156:159], v[32:47]
  ds_read_b64_tr_b16 a[118:119], v252 offset:16896
  ds_read_b64_tr_b16 a[120:121], v251 offset:17408
  v_mfma_f32_32x32x16_bf16 v[96:111], a[136:139], a[160:163], v[96:111]
  buffer_load_dwordx4 a[52:55], v246, s[36:39], s60 offen offset:1024 nt
  v_mfma_f32_32x32x16_bf16 v[160:175], a[136:139], a[164:167], v[160:175]
  ds_read_b64_tr_b16 a[122:123], v251 offset:17920
  ds_read_b64_tr_b16 a[124:125], v252 offset:17408
  s_waitcnt lgkmcnt(10)
  v_mfma_f32_32x32x16_bf16 v[48:63], a[140:143], a[156:159], v[48:63]
  buffer_load_dwordx4 a[56:59], v245, s[40:43], s60 offen offset:2048 nt
  v_mfma_f32_32x32x16_bf16 v[112:127], a[140:143], a[160:163], v[112:127]
  ds_read_b64_tr_b16 a[126:127], v252 offset:17920
  v_mfma_f32_32x32x16_bf16 v[176:191], a[140:143], a[164:167], v[176:191]
  buffer_load_dwordx4 a[60:63], v246, s[40:43], s60 offen offset:3072 nt
  s_waitcnt lgkmcnt(8)
  v_mfma_f32_32x32x16_bf16 v[0:15], a[112:115], a[144:147], v[0:15]
  ds_read_b64_tr_b16 a[128:129], v251 offset:24576
  ds_read_b64_tr_b16 a[130:131], v251 offset:25088
  s_waitcnt lgkmcnt(9)
  v_mfma_f32_32x32x16_bf16 v[64:79], a[112:115], a[148:151], v[64:79]
  buffer_load_dword v224, v230, s[4:7], s53 offen sc1
  s_waitcnt lgkmcnt(8)
  v_mfma_f32_32x32x16_bf16 v[128:143], a[112:115], a[152:155], v[128:143]
  ds_read_b128 a[156:159], v250 offset:96
  ds_read_b128 a[160:163], v250 offset:4320
  s_waitcnt lgkmcnt(8)
  v_mfma_f32_32x32x16_bf16 v[16:31], a[116:119], a[144:147], v[16:31]
  v_mfma_f32_32x32x16_bf16 v[80:95], a[116:119], a[148:151], v[80:95]
  ds_read_b128 a[164:167], v250 offset:8544
  ds_read_b64_tr_b16 a[132:133], v252 offset:24576
  v_mfma_f32_32x32x16_bf16 v[144:159], a[116:119], a[152:155], v[144:159]
  s_waitcnt lgkmcnt(8)
  v_mfma_f32_32x32x16_bf16 v[32:47], a[120:123], a[144:147], v[32:47]
  ds_read_b64_tr_b16 a[134:135], v252 offset:25088
  ds_read_b64_tr_b16 a[136:137], v251 offset:25600
  v_mfma_f32_32x32x16_bf16 v[96:111], a[120:123], a[148:151], v[96:111]
  v_mfma_f32_32x32x16_bf16 v[160:175], a[120:123], a[152:155], v[160:175]
  ds_read_b64_tr_b16 a[138:139], v251 offset:26112
  ds_read_b64_tr_b16 a[140:141], v252 offset:25600
  s_waitcnt lgkmcnt(10)
  v_mfma_f32_32x32x16_bf16 v[48:63], a[124:127], a[144:147], v[48:63]
  v_mfma_f32_32x32x16_bf16 v[112:127], a[124:127], a[148:151], v[112:127]
  ds_read_b64_tr_b16 a[142:143], v252 offset:26112
  v_mfma_f32_32x32x16_bf16 v[176:191], a[124:127], a[152:155], v[176:191]
  v_add_u32 v250, 58112, v250
  v_add_u32 v251, 58112, v251
  v_add_u32 v252, 58112, v252
  s_waitcnt lgkmcnt(0)
  s_waitcnt vmcnt(5)
  s_barrier
  v_mfma_f32_32x32x16_bf16 v[0:15], a[128:131], a[156:159], v[0:15]
  ds_read_b64_tr_b16 a[112:113], v251 offset:0
  ds_read_b64_tr_b16 a[114:115], v251 offset:512
  s_lshl_b32 s54, s52, 7
  s_add_u32 s54, s54, s50
  s_lshl_b32 s55, s52, 19
  s_add_u32 s55, s55, s51
  s_add_u32 s52, s52, 1
  s_and_b32 s52, s52, 7
  s_add_u32 m0, s57, 47616
  s_add_u32 s56, s54, 0
  v_mfma_f32_32x32x16_bf16 v[64:79], a[128:131], a[160:163], v[64:79]
  buffer_load_dwordx4 v253, s[20:23], s56 offen lds
  v_mfma_f32_32x32x16_bf16 v[128:143], a[128:131], a[164:167], v[128:143]
  ds_read_b128 a[144:147], v250 offset:0
  ds_read_b128 a[148:151], v250 offset:4224
  s_add_u32 m0, s57, 48672
  s_add_u32 s56, s54, 8192
  v_mfma_f32_32x32x16_bf16 v[16:31], a[132:135], a[156:159], v[16:31]
  buffer_load_dwordx4 v253, s[20:23], s56 offen lds
  v_mfma_f32_32x32x16_bf16 v[80:95], a[132:135], a[160:163], v[80:95]
  ds_read_b128 a[152:155], v250 offset:8448
  ds_read_b64_tr_b16 a[116:117], v252 offset:0
  s_add_u32 m0, s57, 49728
  s_add_u32 s56, s54, 16384
  v_mfma_f32_32x32x16_bf16 v[144:159], a[132:135], a[164:167], v[144:159]
  buffer_load_dwordx4 v253, s[20:23], s56 offen lds
  v_mfma_f32_32x32x16_bf16 v[32:47], a[136:139], a[156:159], v[32:47]
  ds_read_b64_tr_b16 a[118:119], v252 offset:512
  ds_read_b64_tr_b16 a[120:121], v251 offset:1024
  s_add_u32 m0, s57, 50784
  s_add_u32 s56, s54, 24576
  v_mfma_f32_32x32x16_bf16 v[96:111], a[136:139], a[160:163], v[96:111]
  buffer_load_dwordx4 v253, s[20:23], s56 offen lds
  v_mfma_f32_32x32x16_bf16 v[160:175], a[136:139], a[164:167], v[160:175]
  ds_read_b64_tr_b16 a[122:123], v251 offset:1536
  ds_read_b64_tr_b16 a[124:125], v252 offset:1024
  s_add_u32 m0, s57, 51840
  s_add_u32 s56, s54, 32768
  v_mfma_f32_32x32x16_bf16 v[48:63], a[140:143], a[156:159], v[48:63]
  buffer_load_dwordx4 v253, s[20:23], s56 offen lds
  v_mfma_f32_32x32x16_bf16 v[112:127], a[140:143], a[160:163], v[112:127]
  ds_read_b64_tr_b16 a[126:127], v252 offset:1536
  s_add_u32 m0, s57, 52896
  s_add_u32 s56, s54, 40960
  v_mfma_f32_32x32x16_bf16 v[176:191], a[140:143], a[164:167], v[176:191]
  buffer_load_dwordx4 v253, s[20:23], s56 offen lds
  s_waitcnt lgkmcnt(8)
  v_mfma_f32_32x32x16_bf16 v[0:15], a[112:115], a[144:147], v[0:15]
  ds_read_b64_tr_b16 a[128:129], v251 offset:8192
  ds_read_b64_tr_b16 a[130:131], v251 offset:8704
  s_add_u32 m0, s58, 72960
  s_add_u32 s56, s55, 0
  s_waitcnt lgkmcnt(9)
  v_mfma_f32_32x32x16_bf16 v[64:79], a[112:115], a[148:151], v[64:79]
  buffer_load_dwordx4 v254, s[24:27], s56 offen lds
  s_waitcnt lgkmcnt(8)
  v_mfma_f32_32x32x16_bf16 v[128:143], a[112:115], a[152:155], v[128:143]
  ds_read_b128 a[156:159], v250 offset:32
  ds_read_b128 a[160:163], v250 offset:4256
  s_add_u32 m0, s58, 77056
  s_add_u32 s56, s55, 65536
  s_waitcnt lgkmcnt(8)
  v_mfma_f32_32x32x16_bf16 v[16:31], a[116:119], a[144:147], v[16:31]
  buffer_load_dwordx4 v254, s[24:27], s56 offen lds
  v_mfma_f32_32x32x16_bf16 v[80:95], a[116:119], a[148:151], v[80:95]
  ds_read_b128 a[164:167], v250 offset:8480
  ds_read_b64_tr_b16 a[132:133], v252 offset:8192
  s_add_u32 m0, s58, 81152
  s_add_u32 s56, s55, 131072
  v_mfma_f32_32x32x16_bf16 v[144:159], a[116:119], a[152:155], v[144:159]
  buffer_load_dwordx4 v254, s[24:27], s56 offen lds
  s_waitcnt lgkmcnt(8)
  v_mfma_f32_32x32x16_bf16 v[32:47], a[120:123], a[144:147], v[32:47]
  ds_read_b64_tr_b16 a[134:135], v252 offset:8704
  ds_read_b64_tr_b16 a[136:137], v251 offset:9216
  s_add_u32 m0, s58, 85248
  s_add_u32 s56, s55, 196608
  v_mfma_f32_32x32x16_bf16 v[96:111], a[120:123], a[148:151], v[96:111]
  buffer_load_dwordx4 v254, s[24:27], s56 offen lds
  v_mfma_f32_32x32x16_bf16 v[160:175], a[120:123], a[152:155], v[160:175]
  ds_read_b64_tr_b16 a[138:139], v251 offset:9728
  ds_read_b64_tr_b16 a[140:141], v252 offset:9216
  s_add_u32 m0, s58, 89344
  s_add_u32 s56, s55, 262144
  s_waitcnt lgkmcnt(10)
  v_mfma_f32_32x32x16_bf16 v[48:63], a[124:127], a[144:147], v[48:63]
  buffer_load_dwordx4 v254, s[24:27], s56 offen lds
  v_mfma_f32_32x32x16_bf16 v[112:127], a[124:127], a[148:151], v[112:127]
  ds_read_b64_tr_b16 a[142:143], v252 offset:9728
  s_add_u32 m0, s58, 93440
  s_add_u32 s56, s55, 327680
  v_mfma_f32_32x32x16_bf16 v[176:191], a[124:127], a[152:155], v[176:191]
  buffer_load_dwordx4 v254, s[24:27], s56 offen lds
  s_waitcnt lgkmcnt(8)
  v_mfma_f32_32x32x16_bf16 v[0:15], a[128:131], a[156:159], v[0:15]
  ds_read_b64_tr_b16 a[112:113], v251 offset:16384
  ds_read_b64_tr_b16 a[114:115], v251 offset:16896
  s_add_u32 m0, s58, 97536
  s_add_u32 s56, s55, 393216
  s_waitcnt lgkmcnt(9)
  v_mfma_f32_32x32x16_bf16 v[64:79], a[128:131], a[160:163], v[64:79]
  buffer_load_dwordx4 v254, s[24:27], s56 offen lds
  s_waitcnt lgkmcnt(8)
  v_mfma_f32_32x32x16_bf16 v[128:143], a[128:131], a[164:167], v[128:143]
  ds_read_b128 a[144:147], v250 offset:64
  ds_read_b128 a[148:151], v250 offset:4288
  s_add_u32 m0, s58, 101632
  s_add_u32 s56, s55, 458752
  s_waitcnt lgkmcnt(8)
  v_mfma_f32_32x32x16_bf16 v[16:31], a[132:135], a[156:159], v[16:31]
  buffer_load_dwordx4 v254, s[24:27], s56 offen lds
  v_mfma_f32_32x32x16_bf16 v[80:95], a[132:135], a[160:163], v[80:95]
  ds_read_b128 a[152:155], v250 offset:8512
  ds_read_b64_tr_b16 a[116:117], v252 offset:16384
  s_mov_b32 s60, 24576
  v_mfma_f32_32x32x16_bf16 v[144:159], a[132:135], a[164:167], v[144:159]
  buffer_load_dwordx4 a[64:67], v243, s[28:31], s60 offen offset:0 nt
  s_waitcnt lgkmcnt(8)
  v_mfma_f32_32x32x16_bf16 v[32:47], a[136:139], a[156:159], v[32:47]
  ds_read_b64_tr_b16 a[118:119], v252 offset:16896
  ds_read_b64_tr_b16 a[120:121], v251 offset:17408
  v_mfma_f32_32x32x16_bf16 v[96:111], a[136:139], a[160:163], v[96:111]
  buffer_load_dwordx4 a[68:71], v244, s[28:31], s60 offen offset:1024 nt
  v_mfma_f32_32x32x16_bf16 v[160:175], a[136:139], a[164:167], v[160:175]
  ds_read_b64_tr_b16 a[122:123], v251 offset:17920
  ds_read_b64_tr_b16 a[124:125], v252 offset:17408
  s_waitcnt lgkmcnt(10)
  v_mfma_f32_32x32x16_bf16 v[48:63], a[140:143], a[156:159], v[48:63]
  buffer_load_dwordx4 a[72:75], v243, s[32:35], s60 offen offset:2048 nt
  v_mfma_f32_32x32x16_bf16 v[112:127], a[140:143], a[160:163], v[112:127]
  ds_read_b64_tr_b16 a[126:127], v252 offset:17920
  v_mfma_f32_32x32x16_bf16 v[176:191], a[140:143], a[164:167], v[176:191]
  buffer_load_dwordx4 a[76:79], v244, s[32:35], s60 offen offset:3072 nt
  s_waitcnt lgkmcnt(8)
  v_mfma_f32_32x32x16_bf16 v[0:15], a[112:115], a[144:147], v[0:15]
  ds_read_b64_tr_b16 a[128:129], v251 offset:24576
  ds_read_b64_tr_b16 a[130:131], v251 offset:25088
  s_waitcnt lgkmcnt(9)
  v_mfma_f32_32x32x16_bf16 v[64:79], a[112:115], a[148:151], v[64:79]
  s_waitcnt lgkmcnt(8)
  v_mfma_f32_32x32x16_bf16 v[128:143], a[112:115], a[152:155], v[128:143]
  ds_read_b128 a[156:159], v250 offset:96
  ds_read_b128 a[160:163], v250 offset:4320
  s_waitcnt lgkmcnt(8)
  v_mfma_f32_32x32x16_bf16 v[16:31], a[116:119], a[144:147], v[16:31]
  v_mfma_f32_32x32x16_bf16 v[80:95], a[116:119], a[148:151], v[80:95]
  ds_read_b128 a[164:167], v250 offset:8544
  ds_read_b64_tr_b16 a[132:133], v252 offset:24576
  v_mfma_f32_32x32x16_bf16 v[144:159], a[116:119], a[152:155], v[144:159]
  s_waitcnt lgkmcnt(8)
  v_mfma_f32_32x32x16_bf16 v[32:47], a[120:123], a[144:147], v[32:47]
  ds_read_b64_tr_b16 a[134:135], v252 offset:25088
  ds_read_b64_tr_b16 a[136:137], v251 offset:25600
  v_mfma_f32_32x32x16_bf16 v[96:111], a[120:123], a[148:151], v[96:111]
  v_mfma_f32_32x32x16_bf16 v[160:175], a[120:123], a[152:155], v[160:175]
  ds_read_b64_tr_b16 a[138:139], v251 offset:26112
  ds_read_b64_tr_b16 a[140:141], v252 offset:25600
  s_waitcnt lgkmcnt(10)
  v_mfma_f32_32x32x16_bf16 v[48:63], a[124:127], a[144:147], v[48:63]
  v_mfma_f32_32x32x16_bf16 v[112:127], a[124:127], a[148:151], v[112:127]
  ds_read_b64_tr_b16 a[142:143], v252 offset:26112
  v_mfma_f32_32x32x16_bf16 v[176:191], a[124:127], a[152:155], v[176:191]
  v_subrev_u32 v250, 58112, v250
  v_subrev_u32 v251, 58112, v251
  v_subrev_u32 v252, 58112, v252
  s_waitcnt lgkmcnt(0)
  s_waitcnt vmcnt(4)
  s_barrier
  v_mfma_f32_32x32x16_bf16 v[0:15], a[128:131], a[156:159], v[0:15]
  ds_read_b64_tr_b16 a[112:113], v251 offset:0
  ds_read_b64_tr_b16 a[114:115], v251 offset:512
  s_lshl_b32 s54, s52, 7
  s_add_u32 s54, s54, s50
  s_lshl_b32 s55, s52, 19
  s_add_u32 s55, s55, s51
  s_add_u32 s52, s52, 1
  s_and_b32 s52, s52, 7
  s_add_u32 m0, s57, 105728
  s_add_u32 s56, s54, 0
  v_mfma_f32_32x32x16_bf16 v[64:79], a[128:131], a[160:163], v[64:79]
  buffer_load_dwordx4 v253, s[20:23], s56 offen lds
  v_mfma_f32_32x32x16_bf16 v[128:143], a[128:131], a[164:167], v[128:143]
  ds_read_b128 a[144:147], v250 offset:0
  ds_read_b128 a[148:151], v250 offset:4224
  s_add_u32 m0, s57, 106784
  s_add_u32 s56, s54, 8192
  v_mfma_f32_32x32x16_bf16 v[16:31], a[132:135], a[156:159], v[16:31]
  buffer_load_dwordx4 v253, s[20:23], s56 offen lds
  v_mfma_f32_32x32x16_bf16 v[80:95], a[132:135], a[160:163], v[80:95]
  ds_read_b128 a[152:155], v250 offset:8448
  ds_read_b64_tr_b16 a[116:117], v252 offset:0
  s_add_u32 m0, s57, 107840
  s_add_u32 s56, s54, 16384
  v_mfma_f32_32x32x16_bf16 v[144:159], a[132:135], a[164:167], v[144:159]
  buffer_load_dwordx4 v253, s[20:23], s56 offen lds
  v_mfma_f32_32x32x16_bf16 v[32:47], a[136:139], a[156:159], v[32:47]
  ds_read_b64_tr_b16 a[118:119], v252 offset:512
  ds_read_b64_tr_b16 a[120:121], v251 offset:1024
  s_add_u32 m0, s57, 108896
  s_add_u32 s56, s54, 24576
  v_mfma_f32_32x32x16_bf16 v[96:111], a[136:139], a[160:163], v[96:111]
  buffer_load_dwordx4 v253, s[20:23], s56 offen lds
  v_mfma_f32_32x32x16_bf16 v[160:175], a[136:139], a[164:167], v[160:175]
  ds_read_b64_tr_b16 a[122:123], v251 offset:1536
  ds_read_b64_tr_b16 a[124:125], v252 offset:1024
  s_add_u32 m0, s57, 109952
  s_add_u32 s56, s54, 32768
  v_mfma_f32_32x32x16_bf16 v[48:63], a[140:143], a[156:159], v[48:63]
  buffer_load_dwordx4 v253, s[20:23], s56 offen lds
  v_mfma_f32_32x32x16_bf16 v[112:127], a[140:143], a[160:163], v[112:127]
  ds_read_b64_tr_b16 a[126:127], v252 offset:1536
  s_add_u32 m0, s57, 111008
  s_add_u32 s56, s54, 40960
  v_mfma_f32_32x32x16_bf16 v[176:191], a[140:143], a[164:167], v[176:191]
  buffer_load_dwordx4 v253, s[20:23], s56 offen lds
  s_waitcnt lgkmcnt(8)
  v_mfma_f32_32x32x16_bf16 v[0:15], a[112:115], a[144:147], v[0:15]
  ds_read_b64_tr_b16 a[128:129], v251 offset:8192
  ds_read_b64_tr_b16 a[130:131], v251 offset:8704
  s_add_u32 m0, s58, 131072
  s_add_u32 s56, s55, 0
  s_waitcnt lgkmcnt(9)
  v_mfma_f32_32x32x16_bf16 v[64:79], a[112:115], a[148:151], v[64:79]
  buffer_load_dwordx4 v254, s[24:27], s56 offen lds
  s_mov_b32 s12, 1
  v_and_b32 v225, 31, v224
  v_lshlrev_b32 v225, v225, 1
  s_waitcnt lgkmcnt(8)
  v_mfma_f32_32x32x16_bf16 v[128:143], a[112:115], a[152:155], v[128:143]
  ds_read_b128 a[156:159], v250 offset:32
  ds_read_b128 a[160:163], v250 offset:4256
  s_add_u32 m0, s58, 135168
  s_add_u32 s56, s55, 65536
  s_waitcnt lgkmcnt(8)
  v_mfma_f32_32x32x16_bf16 v[16:31], a[116:119], a[144:147], v[16:31]
  buffer_load_dwordx4 v254, s[24:27], s56 offen lds
  v_cmp_gt_u32 vcc, 0x100, v224
  v_mfma_f32_32x32x16_bf16 v[80:95], a[116:119], a[148:151], v[80:95]
  ds_read_b128 a[164:167], v250 offset:8480
  ds_read_b64_tr_b16 a[132:133], v252 offset:8192
  s_add_u32 m0, s58, 139264
  s_add_u32 s56, s55, 131072
  v_mfma_f32_32x32x16_bf16 v[144:159], a[116:119], a[152:155], v[144:159]
  buffer_load_dwordx4 v254, s[24:27], s56 offen lds
  v_cndmask_b32 v225, 0, v225, vcc
  s_waitcnt lgkmcnt(8)
  v_mfma_f32_32x32x16_bf16 v[32:47], a[120:123], a[144:147], v[32:47]
  ds_read_b64_tr_b16 a[134:135], v252 offset:8704
  ds_read_b64_tr_b16 a[136:137], v251 offset:9216
  s_add_u32 m0, s58, 143360
  s_add_u32 s56, s55, 196608
  v_mfma_f32_32x32x16_bf16 v[96:111], a[120:123], a[148:151], v[96:111]
  buffer_load_dwordx4 v254, s[24:27], s56 offen lds
  v_readlane_b32 s14, v225, 0
  v_mfma_f32_32x32x16_bf16 v[160:175], a[120:123], a[152:155], v[160:175]
  ds_read_b64_tr_b16 a[138:139], v251 offset:9728
  ds_read_b64_tr_b16 a[140:141], v252 offset:9216
  s_add_u32 m0, s58, 147456
  s_add_u32 s56, s55, 262144
  v_readlane_b32 s15, v225, 1
  s_or_b32 s12, s12, s14
  s_waitcnt lgkmcnt(10)
  v_mfma_f32_32x32x16_bf16 v[48:63], a[124:127], a[144:147], v[48:63]
  buffer_load_dwordx4 v254, s[24:27], s56 offen lds
  v_readlane_b32 s14, v225, 2
  s_or_b32 s12, s12, s15
  v_mfma_f32_32x32x16_bf16 v[112:127], a[124:127], a[148:151], v[112:127]
  ds_read_b64_tr_b16 a[142:143], v252 offset:9728
  s_add_u32 m0, s58, 151552
  s_add_u32 s56, s55, 327680
  v_readlane_b32 s15, v225, 3
  s_or_b32 s12, s12, s14
  v_mfma_f32_32x32x16_bf16 v[176:191], a[124:127], a[152:155], v[176:191]
  buffer_load_dwordx4 v254, s[24:27], s56 offen lds
  v_readlane_b32 s14, v225, 4
  s_or_b32 s12, s12, s15
  s_waitcnt lgkmcnt(8)
  v_mfma_f32_32x32x16_bf16 v[0:15], a[128:131], a[156:159], v[0:15]
  ds_read_b64_tr_b16 a[112:113], v251 offset:16384
  ds_read_b64_tr_b16 a[114:115], v251 offset:16896
  s_add_u32 m0, s58, 155648
  s_add_u32 s56, s55, 393216
  v_readlane_b32 s15, v225, 5
  s_or_b32 s12, s12, s14
  s_waitcnt lgkmcnt(9)
  v_mfma_f32_32x32x16_bf16 v[64:79], a[128:131], a[160:163], v[64:79]
  buffer_load_dwordx4 v254, s[24:27], s56 offen lds
  v_readlane_b32 s14, v225, 6
  s_or_b32 s12, s12, s15
  s_waitcnt lgkmcnt(8)
  v_mfma_f32_32x32x16_bf16 v[128:143], a[128:131], a[164:167], v[128:143]
  ds_read_b128 a[144:147], v250 offset:64
  ds_read_b128 a[148:151], v250 offset:4288
  s_add_u32 m0, s58, 159744
  s_add_u32 s56, s55, 458752
  v_readlane_b32 s15, v225, 7
  s_or_b32 s12, s12, s14
  s_waitcnt lgkmcnt(8)
  v_mfma_f32_32x32x16_bf16 v[16:31], a[132:135], a[156:159], v[16:31]
  buffer_load_dwordx4 v254, s[24:27], s56 offen lds
  v_readlane_b32 s14, v225, 8
  s_or_b32 s12, s12, s15
  v_mfma_f32_32x32x16_bf16 v[80:95], a[132:135], a[160:163], v[80:95]
  ds_read_b128 a[152:155], v250 offset:8512
  ds_read_b64_tr_b16 a[116:117], v252 offset:16384
  s_mov_b32 s60, 24576
  v_readlane_b32 s15, v225, 9
  s_or_b32 s12, s12, s14
  v_mfma_f32_32x32x16_bf16 v[144:159], a[132:135], a[164:167], v[144:159]
  buffer_load_dwordx4 a[80:83], v245, s[36:39], s60 offen offset:0 nt
  v_readlane_b32 s14, v225, 10
  s_or_b32 s12, s12, s15
  s_waitcnt lgkmcnt(8)
  v_mfma_f32_32x32x16_bf16 v[32:47], a[136:139], a[156:159], v[32:47]
  ds_read_b64_tr_b16 a[118:119], v252 offset:16896
  ds_read_b64_tr_b16 a[120:121], v251 offset:17408
  v_readlane_b32 s15, v225, 11
  s_or_b32 s12, s12, s14
  v_mfma_f32_32x32x16_bf16 v[96:111], a[136:139], a[160:163], v[96:111]
  buffer_load_dwordx4 a[84:87], v246, s[36:39], s60 offen offset:1024 nt
  v_readlane_b32 s14, v225, 12
  s_or_b32 s12, s12, s15
  v_mfma_f32_32x32x16_bf16 v[160:175], a[136:139], a[164:167], v[160:175]
  ds_read_b64_tr_b16 a[122:123], v251 offset:17920
  ds_read_b64_tr_b16 a[124:125], v252 offset:17408
  v_readlane_b32 s15, v225, 13
  s_or_b32 s12, s12, s14
  s_waitcnt lgkmcnt(10)
  v_mfma_f32_32x32x16_bf16 v[48:63], a[140:143], a[156:159], v[48:63]
  buffer_load_dwordx4 a[88:91], v245, s[40:43], s60 offen offset:2048 nt
  v_readlane_b32 s14, v225, 14
  s_or_b32 s12, s12, s15
  v_mfma_f32_32x32x16_bf16 v[112:127], a[140:143], a[160:163], v[112:127]
  ds_read_b64_tr_b16 a[126:127], v252 offset:17920
  v_readlane_b32 s15, v225, 15
  s_or_b32 s12, s12, s14
  v_mfma_f32_32x32x16_bf16 v[176:191], a[140:143], a[164:167], v[176:191]
  buffer_load_dwordx4 a[92:95], v246, s[40:43], s60 offen offset:3072 nt
  s_waitcnt lgkmcnt(8)
  v_mfma_f32_32x32x16_bf16 v[0:15], a[112:115], a[144:147], v[0:15]
  ds_read_b64_tr_b16 a[128:129], v251 offset:24576
  ds_read_b64_tr_b16 a[130:131], v251 offset:25088
  s_or_b32 s12, s12, s15
  s_waitcnt lgkmcnt(9)
  v_mfma_f32_32x32x16_bf16 v[64:79], a[112:115], a[148:151], v[64:79]
  s_waitcnt lgkmcnt(8)
  v_mfma_f32_32x32x16_bf16 v[128:143], a[112:115], a[152:155], v[128:143]
  ds_read_b128 a[156:159], v250 offset:96
  ds_read_b128 a[160:163], v250 offset:4320
  s_ff0_i32_b32 s12, s12
  s_waitcnt lgkmcnt(8)
  v_mfma_f32_32x32x16_bf16 v[16:31], a[116:119], a[144:147], v[16:31]
  v_mfma_f32_32x32x16_bf16 v[80:95], a[116:119], a[148:151], v[80:95]
  ds_read_b128 a[164:167], v250 offset:8544
  ds_read_b64_tr_b16 a[132:133], v252 offset:24576
  v_mfma_f32_32x32x16_bf16 v[144:159], a[116:119], a[152:155], v[144:159]
  s_waitcnt lgkmcnt(8)
  v_mfma_f32_32x32x16_bf16 v[32:47], a[120:123], a[144:147], v[32:47]
  ds_read_b64_tr_b16 a[134:135], v252 offset:25088
  ds_read_b64_tr_b16 a[136:137], v251 offset:25600
  v_mfma_f32_32x32x16_bf16 v[96:111], a[120:123], a[148:151], v[96:111]
  v_mfma_f32_32x32x16_bf16 v[160:175], a[120:123], a[152:155], v[160:175]
  ds_read_b64_tr_b16 a[138:139], v251 offset:26112
  ds_read_b64_tr_b16 a[140:141], v252 offset:25600
  s_waitcnt lgkmcnt(10)
  v_mfma_f32_32x32x16_bf16 v[48:63], a[124:127], a[144:147], v[48:63]
  v_mfma_f32_32x32x16_bf16 v[112:127], a[124:127], a[148:151], v[112:127]
  ds_read_b64_tr_b16 a[142:143], v252 offset:26112
  v_mfma_f32_32x32x16_bf16 v[176:191], a[124:127], a[152:155], v[176:191]
  v_add_u32 v250, 58112, v250
  v_add_u32 v251, 58112, v251
  v_add_u32 v252, 58112, v252
  s_waitcnt lgkmcnt(0)
  s_waitcnt vmcnt(4)
  s_barrier
  v_mfma_f32_32x32x16_bf16 v[0:15], a[128:131], a[156:159], v[0:15]
  ds_read_b64_tr_b16 a[112:113], v251 offset:0
  ds_read_b64_tr_b16 a[114:115], v251 offset:512
  v_mfma_f32_32x32x16_bf16 v[64:79], a[128:131], a[160:163], v[64:79]
  ds_read_b128 a[192:195], v250 offset:0
  ds_read_b64_tr_b16 a[116:117], v252 offset:0
  v_mfma_f32_32x32x16_bf16 v[128:143], a[128:131], a[164:167], v[128:143]
  ds_read_b64_tr_b16 a[118:119], v252 offset:512
  v_mfma_f32_32x32x16_bf16 v[16:31], a[132:135], a[156:159], v[16:31]
  ds_read_b64_tr_b16 a[120:121], v251 offset:1024
  ds_read_b64_tr_b16 a[122:123], v251 offset:1536
  v_mfma_f32_32x32x16_bf16 v[80:95], a[132:135], a[160:163], v[80:95]
  ds_read_b64_tr_b16 a[124:125], v252 offset:1024
  ds_read_b64_tr_b16 a[126:127], v252 offset:1536
  v_mfma_f32_32x32x16_bf16 v[144:159], a[132:135], a[164:167], v[144:159]
  ds_read_b64_tr_b16 a[168:169], v251 offset:8192
  v_mfma_f32_32x32x16_bf16 v[32:47], a[136:139], a[156:159], v[32:47]
  ds_read_b64_tr_b16 a[170:171], v251 offset:8704
  ds_read_b64_tr_b16 a[172:173], v252 offset:8192
  v_mfma_f32_32x32x16_bf16 v[96:111], a[136:139], a[160:163], v[96:111]
  ds_read_b64_tr_b16 a[174:175], v252 offset:8704
  ds_read_b64_tr_b16 a[176:177], v251 offset:9216
  v_mfma_f32_32x32x16_bf16 v[160:175], a[136:139], a[164:167], v[160:175]
  ds_read_b64_tr_b16 a[178:179], v251 offset:9728
  v_mfma_f32_32x32x16_bf16 v[48:63], a[140:143], a[156:159], v[48:63]
  ds_read_b64_tr_b16 a[180:181], v252 offset:9216
  ds_read_b64_tr_b16 a[182:183], v252 offset:9728
  v_mfma_f32_32x32x16_bf16 v[112:127], a[140:143], a[160:163], v[112:127]
  ds_read_b128 a[196:199], v250 offset:32
  ds_read_b128 a[200:203], v250 offset:64
  v_mfma_f32_32x32x16_bf16 v[176:191], a[140:143], a[164:167], v[176:191]
  ds_read_b128 a[204:207], v250 offset:96
  v_mbcnt_lo_u32_b32 v253, -1, 0
  v_mbcnt_hi_u32_b32 v253, -1, v253
  v_lshlrev_b32 v253, 4, v253
  v_add_u32 v254, s62, v253
  v_add_u32 v253, s61, v253
  v_mbcnt_lo_u32_b32 v237, -1, 0
  v_mbcnt_hi_u32_b32 v237, -1, v237
  v_lshlrev_b32 v237, 7, v237
  s_waitcnt lgkmcnt(15)
  v_mfma_f32_32x32x16_bf16 v[0:15], a[112:115], a[192:195], v[0:15]
  ds_read_b64_tr_b16 a[128:129], v251 offset:16384
  ds_read_b64_tr_b16 a[130:131], v251 offset:16896
  ds_write_b128 v253, a[0:3] offset:32896
  v_mfma_f32_32x32x16_bf16 v[16:31], a[116:119], a[192:195], v[16:31]
  ds_read_b64_tr_b16 a[132:133], v252 offset:16384
  ds_read_b64_tr_b16 a[134:135], v252 offset:16896
  s_waitcnt lgkmcnt(15)
  v_mfma_f32_32x32x16_bf16 v[32:47], a[120:123], a[192:195], v[32:47]
  ds_read_b64_tr_b16 a[136:137], v251 offset:17408
  ds_read_b64_tr_b16 a[138:139], v251 offset:17920
  ds_write_b128 v253, a[4:7] offset:33920
  v_mfma_f32_32x32x16_bf16 v[48:63], a[124:127], a[192:195], v[48:63]
  ds_read_b64_tr_b16 a[140:141], v252 offset:17408
  ds_read_b64_tr_b16 a[142:143], v252 offset:17920
  s_waitcnt lgkmcnt(12)
  v_mfma_f32_32x32x16_bf16 v[0:15], a[168:171], a[196:199], v[0:15]
  ds_read_b64_tr_b16 a[144:145], v251 offset:24576
  ds_read_b64_tr_b16 a[146:147], v251 offset:25088
  ds_write_b128 v253, a[8:11] offset:34944
  v_mfma_f32_32x32x16_bf16 v[16:31], a[172:175], a[196:199], v[16:31]
  ds_read_b64_tr_b16 a[148:149], v252 offset:24576
  ds_read_b64_tr_b16 a[150:151], v252 offset:25088
  v_mfma_f32_32x32x16_bf16 v[32:47], a[176:179], a[196:199], v[32:47]
  ds_read_b64_tr_b16 a[152:153], v251 offset:25600
  ds_read_b64_tr_b16 a[154:155], v251 offset:26112
  ds_write_b128 v253, a[12:15] offset:35968
  v_mfma_f32_32x32x16_bf16 v[48:63], a[180:183], a[196:199], v[48:63]
  ds_read_b64_tr_b16 a[156:157], v252 offset:25600
  ds_read_b64_tr_b16 a[158:159], v252 offset:26112
  s_waitcnt lgkmcnt(15)
  v_mfma_f32_32x32x16_bf16 v[0:15], a[128:131], a[200:203], v[0:15]
  ds_read_b128 a[208:211], v250 offset:4224
  ds_write_b128 v254, a[16:19] offset:49408
  v_mfma_f32_32x32x16_bf16 v[16:31], a[132:135], a[200:203], v[16:31]
  ds_read_b128 a[212:215], v250 offset:4256
  s_waitcnt lgkmcnt(15)
  v_mfma_f32_32x32x16_bf16 v[32:47], a[136:139], a[200:203], v[32:47]
  ds_read_b128 a[216:219], v250 offset:4288
  ds_write_b128 v254, a[20:23] offset:50432
  s_waitcnt lgkmcnt(15)
  v_mfma_f32_32x32x16_bf16 v[48:63], a[140:143], a[200:203], v[48:63]
  ds_read_b128 a[220:223], v250 offset:4320
  s_waitcnt lgkmcnt(14)
  v_mfma_f32_32x32x16_bf16 v[0:15], a[144:147], a[204:207], v[0:15]
  ds_write_b128 v254, a[24:27] offset:51456
  buffer_load_dword a184, v237, s[8:11], s63 offen offset:1024
  s_waitcnt lgkmcnt(12)
  v_mfma_f32_32x32x16_bf16 v[16:31], a[148:151], a[204:207], v[16:31]
  s_waitcnt lgkmcnt(10)
  v_mfma_f32_32x32x16_bf16 v[32:47], a[152:155], a[204:207], v[32:47]
  ds_write_b128 v254, a[28:31] offset:52480
  buffer_load_dword a185, v237, s[8:11], s63 offen offset:1088
  s_waitcnt lgkmcnt(8)
  v_mfma_f32_32x32x16_bf16 v[48:63], a[156:159], a[204:207], v[48:63]
  v_add_u32 v253, 65792, v253
  v_add_u32 v254, 65792, v254
  v_mul_f32 v0, s64, v0
  v_mul_f32 v1, s64, v1
  v_mul_f32 v2, s64, v2
  v_mul_f32 v3, s64, v3
  v_mul_f32 v4, s64, v4
  s_waitcnt lgkmcnt(7)
  v_mfma_f32_32x32x16_bf16 v[64:79], a[112:115], a[208:211], v[64:79]
  ds_write_b128 v253, a[32:35] offset:0
  v_mul_f32 v5, s64, v5
  v_mul_f32 v6, s64, v6
  v_mul_f32 v7, s64, v7
  v_cvt_pk_bf16_f32 v192, v0, v1
  v_cvt_pk_bf16_f32 v193, v2, v3
  v_mfma_f32_32x32x16_bf16 v[80:95], a[116:119], a[208:211], v[80:95]
  ds_read_b128 a[192:195], v250 offset:8448
  v_cvt_pk_bf16_f32 v194, v4, v5
  v_cvt_pk_bf16_f32 v195, v6, v7
  v_mul_f32 v8, s64, v8
  v_mul_f32 v9, s64, v9
  v_mul_f32 v10, s64, v10
  v_mul_f32 v11, s64, v11
  v_mfma_f32_32x32x16_bf16 v[96:111], a[120:123], a[208:211], v[96:111]
  ds_read_b128 a[196:199], v250 offset:8480
  ds_write_b128 v253, a[36:39] offset:1024
  v_mul_f32 v12, s64, v12
  v_mul_f32 v13, s64, v13
  v_mul_f32 v14, s64, v14
  v_mul_f32 v15, s64, v15
  v_mfma_f32_32x32x16_bf16 v[112:127], a[124:127], a[208:211], v[112:127]
  ds_read_b128 a[200:203], v250 offset:8512
  v_cvt_pk_bf16_f32 v196, v8, v9
  v_cvt_pk_bf16_f32 v197, v10, v11
  v_cvt_pk_bf16_f32 v198, v12, v13
  v_cvt_pk_bf16_f32 v199, v14, v15
  v_mul_f32 v16, s64, v16
  v_mul_f32 v17, s64, v17
  s_waitcnt lgkmcnt(10)
  v_mfma_f32_32x32x16_bf16 v[64:79], a[168:171], a[212:215], v[64:79]
  ds_read_b128 a[204:207], v250 offset:8544
  ds_write_b128 v253, a[40:43] offset:2048
  v_mul_f32 v18, s64, v18
  v_mul_f32 v19, s64, v19
  v_mul_f32 v20, s64, v20
  v_mul_f32 v21, s64, v21
  v_mfma_f32_32x32x16_bf16 v[80:95], a[172:175], a[212:215], v[80:95]
  v_mul_f32 v22, s64, v22
  v_mul_f32 v23, s64, v23
  v_cvt_pk_bf16_f32 v200, v16, v17
  v_cvt_pk_bf16_f32 v201, v18, v19
  v_cvt_pk_bf16_f32 v202, v20, v21
  v_cvt_pk_bf16_f32 v203, v22, v23
  v_mul_f32 v24, s64, v24
  v_mfma_f32_32x32x16_bf16 v[96:111], a[176:179], a[212:215], v[96:111]
  ds_write_b128 v253, a[44:47] offset:3072
  v_mul_f32 v25, s64, v25
  v_mul_f32 v26, s64, v26
  v_mul_f32 v27, s64, v27
  v_mul_f32 v28, s64, v28
  v_mul_f32 v29, s64, v29
  v_mfma_f32_32x32x16_bf16 v[112:127], a[180:183], a[212:215], v[112:127]
  v_mul_f32 v30, s64, v30
  v_mul_f32 v31, s64, v31
  v_cvt_pk_bf16_f32 v204, v24, v25
  v_cvt_pk_bf16_f32 v205, v26, v27
  v_cvt_pk_bf16_f32 v206, v28, v29
  v_cvt_pk_bf16_f32 v207, v30, v31
  v_mul_f32 v32, s64, v32
  s_waitcnt lgkmcnt(12)
  v_mfma_f32_32x32x16_bf16 v[64:79], a[128:131], a[216:219], v[64:79]
  ds_write_b128 v254, a[48:51] offset:16512
  v_mul_f32 v33, s64, v33
  v_mul_f32 v34, s64, v34
  v_mul_f32 v35, s64, v35
  v_mul_f32 v36, s64, v36
  v_mul_f32 v37, s64, v37
  v_mfma_f32_32x32x16_bf16 v[80:95], a[132:135], a[216:219], v[80:95]
  s_waitcnt lgkmcnt(1)
  s_barrier
  v_mul_f32 v38, s64, v38
  v_mul_f32 v39, s64, v39
  v_cvt_pk_bf16_f32 v208, v32, v33
  v_cvt_pk_bf16_f32 v209, v34, v35
  v_cvt_pk_bf16_f32 v210, v36, v37
  v_mfma_f32_32x32x16_bf16 v[96:111], a[136:139], a[216:219], v[96:111]
  ds_write_b128 v254, a[52:55] offset:17536
  v_cvt_pk_bf16_f32 v211, v38, v39
  v_mul_f32 v40, s64, v40
  v_mul_f32 v41, s64, v41
  v_mul_f32 v42, s64, v42
  v_mul_f32 v43, s64, v43
  v_mfma_f32_32x32x16_bf16 v[112:127], a[140:143], a[216:219], v[112:127]
  v_mul_f32 v44, s64, v44
  v_mul_f32 v45, s64, v45
  v_mul_f32 v46, s64, v46
  v_mul_f32 v47, s64, v47
  v_cvt_pk_bf16_f32 v212, v40, v41
  v_cvt_pk_bf16_f32 v213, v42, v43
  v_cvt_pk_bf16_f32 v214, v44, v45
  v_mfma_f32_32x32x16_bf16 v[64:79], a[144:147], a[220:223], v[64:79]
  ds_write_b128 v254, a[56:59] offset:18560
  v_cvt_pk_bf16_f32 v215, v46, v47
  v_mul_f32 v48, s64, v48
  v_mul_f32 v49, s64, v49
  v_mul_f32 v50, s64, v50
  v_mul_f32 v51, s64, v51
  v_mfma_f32_32x32x16_bf16 v[80:95], a[148:151], a[220:223], v[80:95]
  v_mul_f32 v52, s64, v52
  v_mul_f32 v53, s64, v53
  v_mul_f32 v54, s64, v54
  v_mul_f32 v55, s64, v55
  v_cvt_pk_bf16_f32 v216, v48, v49
  v_cvt_pk_bf16_f32 v217, v50, v51
  v_cvt_pk_bf16_f32 v218, v52, v53
  v_mfma_f32_32x32x16_bf16 v[96:111], a[152:155], a[220:223], v[96:111]
  ds_write_b128 v254, a[60:63] offset:19584
  s_add_u32 m0, s61, 131584
  s_mov_b32 s59, 32768
  v_cvt_pk_bf16_f32 v219, v54, v55
  v_mul_f32 v56, s64, v56
  v_mul_f32 v57, s64, v57
  v_mfma_f32_32x32x16_bf16 v[112:127], a[156:159], a[220:223], v[112:127]
  buffer_load_dwordx4 v243, s[28:31], s59 offen offset:0 nt lds
  v_mul_f32 v58, s64, v58
  v_mul_f32 v59, s64, v59
  v_mul_f32 v60, s64, v60
  v_mul_f32 v61, s64, v61
  v_mfma_f32_32x32x16_bf16 v[128:143], a[112:115], a[192:195], v[128:143]
  ds_write_b128 v253, a[64:67] offset:32896
  v_accvgpr_write_b32 a208, s12
  v_accvgpr_write_b32 a209, 0
  v_mul_f32 v62, s64, v62
  v_mul_f32 v63, s64, v63
  v_cvt_pk_bf16_f32 v220, v56, v57
  v_mfma_f32_32x32x16_bf16 v[144:159], a[116:119], a[192:195], v[144:159]
  ds_read_b128 a[224:227], v240 offset:0
  v_cvt_pk_bf16_f32 v221, v58, v59
  v_cvt_pk_bf16_f32 v222, v60, v61
  v_cvt_pk_bf16_f32 v223, v62, v63
  v_mul_f32 v64, s64, v64
  v_mul_f32 v65, s64, v65
  v_mul_f32 v66, s64, v66
  v_mfma_f32_32x32x16_bf16 v[160:175], a[120:123], a[192:195], v[160:175]
  ds_write_b128 v253, a[68:71] offset:33920
  buffer_atomic_cmpswap a[208:209], v255, s[72:75], s65 offen sc0 sc1
  v_mul_f32 v67, s64, v67
  v_mul_f32 v68, s64, v68
  v_mfma_f32_32x32x16_bf16 v[176:191], a[124:127], a[192:195], v[176:191]
  ds_read_b128 a[228:231], v240 offset:32
  v_mul_f32 v69, s64, v69
  v_mul_f32 v70, s64, v70
  v_mul_f32 v71, s64, v71
  v_cvt_pk_bf16_f32 v0, v64, v65
  v_cvt_pk_bf16_f32 v1, v66, v67
  v_cvt_pk_bf16_f32 v2, v68, v69
  v_mfma_f32_32x32x16_bf16 v[128:143], a[168:171], a[196:199], v[128:143]
  ds_write_b128 v253, a[72:75] offset:34944
  v_cvt_pk_bf16_f32 v3, v70, v71
  v_mul_f32 v72, s64, v72
  v_mul_f32 v73, s64, v73
  v_mul_f32 v74, s64, v74
  v_mul_f32 v75, s64, v75
  v_mfma_f32_32x32x16_bf16 v[144:159], a[172:175], a[196:199], v[144:159]
  ds_read_b128 a[232:235], v240 offset:64
  v_mul_f32 v76, s64, v76
  v_mul_f32 v77, s64, v77
  v_mul_f32 v78, s64, v78
  v_mul_f32 v79, s64, v79
  v_cvt_pk_bf16_f32 v4, v72, v73
  v_cvt_pk_bf16_f32 v5, v74, v75
  v_mfma_f32_32x32x16_bf16 v[160:175], a[176:179], a[196:199], v[160:175]
  buffer_load_dwordx4 v244, s[28:31], s59 offen offset:1024 nt lds
  ds_write_b128 v253, a[76:79] offset:35968
  v_cvt_pk_bf16_f32 v6, v76, v77
  v_cvt_pk_bf16_f32 v7, v78, v79
  v_mfma_f32_32x32x16_bf16 v[176:191], a[180:183], a[196:199], v[176:191]
  ds_read_b128 a[236:239], v240 offset:96
  v_mul_f32 v80, s64, v80
  v_mul_f32 v81, s64, v81
  v_mul_f32 v82, s64, v82
  v_mul_f32 v83, s64, v83
  v_mul_f32 v84, s64, v84
  v_mul_f32 v85, s64, v85
  v_mfma_f32_32x32x16_bf16 v[128:143], a[128:131], a[200:203], v[128:143]
  s_waitcnt vmcnt(8)
  ds_write_b128 v254, a[80:83] offset:49408
  v_mul_f32 v86, s64, v86
  v_mul_f32 v87, s64, v87
  v_cvt_pk_bf16_f32 v8, v80, v81
  v_cvt_pk_bf16_f32 v9, v82, v83
  v_cvt_pk_bf16_f32 v10, v84, v85
  v_mfma_f32_32x32x16_bf16 v[144:159], a[132:135], a[200:203], v[144:159]
  ds_read_b128 a[240:243], v240 offset:1024
  v_cvt_pk_bf16_f32 v11, v86, v87
  v_mul_f32 v88, s64, v88
  v_mul_f32 v89, s64, v89
  v_mul_f32 v90, s64, v90
  v_mul_f32 v91, s64, v91
  v_mul_f32 v92, s64, v92
  v_mfma_f32_32x32x16_bf16 v[160:175], a[136:139], a[200:203], v[160:175]
  s_waitcnt vmcnt(7)
  ds_write_b128 v254, a[84:87] offset:50432
  v_mul_f32 v93, s64, v93
  v_mul_f32 v94, s64, v94
  v_mul_f32 v95, s64, v95
  v_cvt_pk_bf16_f32 v12, v88, v89
  v_cvt_pk_bf16_f32 v13, v90, v91
  v_mfma_f32_32x32x16_bf16 v[176:191], a[140:143], a[200:203], v[176:191]
  ds_read_b128 a[244:247], v240 offset:1056
  v_cvt_pk_bf16_f32 v14, v92, v93
  v_cvt_pk_bf16_f32 v15, v94, v95
  v_mul_f32 v96, s64, v96
  v_mul_f32 v97, s64, v97
  v_mul_f32 v98, s64, v98
  v_mul_f32 v99, s64, v99
  v_mfma_f32_32x32x16_bf16 v[128:143], a[144:147], a[204:207], v[128:143]
  s_waitcnt vmcnt(6)
  ds_write_b128 v254, a[88:91] offset:51456
  v_mul_f32 v100, s64, v100
  v_mul_f32 v101, s64, v101
  v_mul_f32 v102, s64, v102
  v_mul_f32 v103, s64, v103
  v_cvt_pk_bf16_f32 v16, v96, v97
  v_mfma_f32_32x32x16_bf16 v[144:159], a[148:151], a[204:207], v[144:159]
  ds_read_b128 a[248:251], v240 offset:1088
  v_cvt_pk_bf16_f32 v17, v98, v99
  v_cvt_pk_bf16_f32 v18, v100, v101
  v_cvt_pk_bf16_f32 v19, v102, v103
  v_mul_f32 v104, s64, v104
  v_mul_f32 v105, s64, v105
  v_mul_f32 v106, s64, v106
  v_mfma_f32_32x32x16_bf16 v[160:175], a[152:155], a[204:207], v[160:175]
  buffer_load_dwordx4 v243, s[32:35], s59 offen offset:2048 nt lds
  s_waitcnt vmcnt(6)
  ds_write_b128 v254, a[92:95] offset:52480
  v_mul_f32 v107, s64, v107
  v_mul_f32 v108, s64, v108
  v_mfma_f32_32x32x16_bf16 v[176:191], a[156:159], a[204:207], v[176:191]
  ds_read_b128 a[252:255], v240 offset:1120
  v_mul_f32 v109, s64, v109
  v_mul_f32 v110, s64, v110
  v_mul_f32 v111, s64, v111
  v_cvt_pk_bf16_f32 v20, v104, v105
  v_cvt_pk_bf16_f32 v21, v106, v107
  v_cvt_pk_bf16_f32 v22, v108, v109
  s_waitcnt lgkmcnt(14)
  v_mfma_f32_32x32x16_bf16 v[64:79], a[224:227], v[192:195], 0
  v_cvt_pk_bf16_f32 v23, v110, v111
  v_mul_f32 v112, s64, v112
  v_mul_f32 v113, s64, v113
  v_mul_f32 v114, s64, v114
  v_mul_f32 v115, s64, v115
  v_mul_f32 v116, s64, v116
  v_mul_f32 v117, s64, v117
  s_waitcnt lgkmcnt(12)
  v_mfma_f32_32x32x16_bf16 v[64:79], a[228:231], v[196:199], v[64:79]
  v_mul_f32 v118, s64, v118
  v_mul_f32 v119, s64, v119
  v_cvt_pk_bf16_f32 v24, v112, v113
  v_cvt_pk_bf16_f32 v25, v114, v115
  v_cvt_pk_bf16_f32 v26, v116, v117
  v_cvt_pk_bf16_f32 v27, v118, v119
  v_mul_f32 v120, s64, v120
  s_waitcnt lgkmcnt(10)
  v_mfma_f32_32x32x16_bf16 v[64:79], a[232:235], v[200:203], v[64:79]
  v_mul_f32 v121, s64, v121
  v_mul_f32 v122, s64, v122
  v_mul_f32 v123, s64, v123
  v_mul_f32 v124, s64, v124
  v_mul_f32 v125, s64, v125
  v_mul_f32 v126, s64, v126
  v_mul_f32 v127, s64, v127
  s_waitcnt lgkmcnt(8)
  v_mfma_f32_32x32x16_bf16 v[64:79], a[236:239], v[204:207], v[64:79]
  v_cvt_pk_bf16_f32 v28, v120, v121
  v_cvt_pk_bf16_f32 v29, v122, v123
  v_cvt_pk_bf16_f32 v30, v124, v125
  v_cvt_pk_bf16_f32 v31, v126, v127
  v_mul_f32 v128, s64, v128
  v_mul_f32 v129, s64, v129
  v_mul_f32 v130, s64, v130
  s_waitcnt lgkmcnt(6)
  v_mfma_f32_32x32x16_bf16 v[64:79], a[240:243], v[208:211], v[64:79]
  s_waitcnt lgkmcnt(0)
  s_barrier
  v_mul_f32 v131, s64, v131
  v_mul_f32 v132, s64, v132
  v_mul_f32 v133, s64, v133
  v_mul_f32 v134, s64, v134
  v_mul_f32 v135, s64, v135
  v_mfma_f32_32x32x16_bf16 v[64:79], a[244:247], v[212:215], v[64:79]
  buffer_load_dwordx4 v244, s[32:35], s59 offen offset:3072 nt lds
  v_cvt_pk_bf16_f32 v32, v128, v129
  v_cvt_pk_bf16_f32 v33, v130, v131
  v_cvt_pk_bf16_f32 v34, v132, v133
  v_cvt_pk_bf16_f32 v35, v134, v135
  v_mfma_f32_32x32x16_bf16 v[64:79], a[248:251], v[216:219], v[64:79]
  v_mul_f32 v136, s64, v136
  v_mul_f32 v137, s64, v137
  v_mul_f32 v138, s64, v138
  v_mul_f32 v139, s64, v139
  v_mul_f32 v140, s64, v140
  v_mul_f32 v141, s64, v141
  v_mul_f32 v142, s64, v142
  v_mfma_f32_32x32x16_bf16 v[64:79], a[252:255], v[220:223], v[64:79]
  v_mul_f32 v143, s64, v143
  v_cvt_pk_bf16_f32 v36, v136, v137
  v_cvt_pk_bf16_f32 v37, v138, v139
  v_cvt_pk_bf16_f32 v38, v140, v141
  v_cvt_pk_bf16_f32 v39, v142, v143
  v_mul_f32 v144, s64, v144
  v_mul_f32 v145, s64, v145
  v_mfma_f32_32x32x16_bf16 v[80:95], a[224:227], v[0:3], 0
  v_mul_f32 v146, s64, v146
  v_mul_f32 v147, s64, v147
  v_mul_f32 v148, s64, v148
  v_mul_f32 v149, s64, v149
  v_mul_f32 v150, s64, v150
  v_mul_f32 v151, s64, v151
  v_cvt_pk_bf16_f32 v40, v144, v145
  v_mfma_f32_32x32x16_bf16 v[80:95], a[228:231], v[4:7], v[80:95]
  v_cvt_pk_bf16_f32 v41, v146, v147
  v_cvt_pk_bf16_f32 v42, v148, v149
  v_cvt_pk_bf16_f32 v43, v150, v151
  v_mul_f32 v152, s64, v152
  v_mul_f32 v153, s64, v153
  v_mul_f32 v154, s64, v154
  v_mul_f32 v155, s64, v155
  v_mfma_f32_32x32x16_bf16 v[80:95], a[232:235], v[8:11], v[80:95]
  v_mul_f32 v156, s64, v156
  v_mul_f32 v157, s64, v157
  v_mul_f32 v158, s64, v158
  v_mul_f32 v159, s64, v159
  v_cvt_pk_bf16_f32 v44, v152, v153
  v_cvt_pk_bf16_f32 v45, v154, v155
  v_cvt_pk_bf16_f32 v46, v156, v157
  v_mfma_f32_32x32x16_bf16 v[80:95], a[236:239], v[12:15], v[80:95]
  s_mov_b32 s60, 32768
  v_cvt_pk_bf16_f32 v47, v158, v159
  v_mul_f32 v160, s64, v160
  v_mul_f32 v161, s64, v161
  v_mul_f32 v162, s64, v162
  v_mul_f32 v163, s64, v163
  v_mul_f32 v164, s64, v164
  v_mfma_f32_32x32x16_bf16 v[80:95], a[240:243], v[16:19], v[80:95]
  buffer_load_dwordx4 a[192:195], v245, s[36:39], s60 offen offset:0 nt
  v_mul_f32 v165, s64, v165
  v_mul_f32 v166, s64, v166
  v_mul_f32 v167, s64, v167
  v_cvt_pk_bf16_f32 v48, v160, v161
  v_mfma_f32_32x32x16_bf16 v[80:95], a[244:247], v[20:23], v[80:95]
  v_cvt_pk_bf16_f32 v49, v162, v163
  v_cvt_pk_bf16_f32 v50, v164, v165
  v_cvt_pk_bf16_f32 v51, v166, v167
  v_mul_f32 v168, s64, v168
  v_mul_f32 v169, s64, v169
  v_mul_f32 v170, s64, v170
  v_mul_f32 v171, s64, v171
  v_mfma_f32_32x32x16_bf16 v[80:95], a[248:251], v[24:27], v[80:95]
  v_mul_f32 v172, s64, v172
  v_mul_f32 v173, s64, v173
  v_mul_f32 v174, s64, v174
  v_mul_f32 v175, s64, v175
  v_cvt_pk_bf16_f32 v52, v168, v169
  v_cvt_pk_bf16_f32 v53, v170, v171
  v_cvt_pk_bf16_f32 v54, v172, v173
  v_mfma_f32_32x32x16_bf16 v[80:95], a[252:255], v[28:31], v[80:95]
  v_cvt_pk_bf16_f32 v55, v174, v175
  v_mul_f32 v176, s64, v176
  v_mul_f32 v177, s64, v177
  v_mul_f32 v178, s64, v178
  v_mul_f32 v179, s64, v179
  v_mul_f32 v180, s64, v180
  v_mul_f32 v181, s64, v181
  v_mfma_f32_32x32x16_bf16 v[96:111], a[224:227], v[32:35], 0
  v_mul_f32 v182, s64, v182
  v_mul_f32 v183, s64, v183
  v_cvt_pk_bf16_f32 v56, v176, v177
  v_cvt_pk_bf16_f32 v57, v178, v179
  v_cvt_pk_bf16_f32 v58, v180, v181
  v_cvt_pk_bf16_f32 v59, v182, v183
  v_mul_f32 v184, s64, v184
  v_mfma_f32_32x32x16_bf16 v[96:111], a[228:231], v[36:39], v[96:111]
  ds_read_b128 a[224:227], v240 offset:32896
  v_mul_f32 v185, s64, v185
  v_mul_f32 v186, s64, v186
  v_mul_f32 v187, s64, v187
  v_mul_f32 v188, s64, v188
  v_mul_f32 v189, s64, v189
  v_mul_f32 v190, s64, v190
  v_mfma_f32_32x32x16_bf16 v[96:111], a[232:235], v[40:43], v[96:111]
  ds_read_b128 a[228:231], v240 offset:32928
  v_mul_f32 v191, s64, v191
  v_cvt_pk_bf16_f32 v60, v184, v185
  v_cvt_pk_bf16_f32 v61, v186, v187
  v_cvt_pk_bf16_f32 v62, v188, v189
  v_cvt_pk_bf16_f32 v63, v190, v191
  v_max3_f32 v250, v64, v65, v66
  v_mfma_f32_32x32x16_bf16 v[96:111], a[236:239], v[44:47], v[96:111]
  buffer_load_dwordx4 a[196:199], v246, s[36:39], s60 offen offset:1024 nt
  ds_read_b128 a[232:235], v240 offset:32960
  v_max3_f32 v250, v250, v67, v68
  v_max3_f32 v250, v250, v69, v70
  v_max3_f32 v250, v250, v71, v72
  v_mfma_f32_32x32x16_bf16 v[96:111], a[240:243], v[48:51], v[96:111]
  ds_read_b128 a[236:239], v240 offset:32992
  v_max3_f32 v250, v250, v73, v74
  v_max3_f32 v250, v250, v75, v76
  v_max3_f32 v250, v250, v77, v78
  v_max_f32 v250, v250, v79
  v_mov_b32 v253, v250
  s_nop 1
  v_mfma_f32_32x32x16_bf16 v[96:111], a[244:247], v[52:55], v[96:111]
  ds_read_b128 a[240:243], v240 offset:33920
  v_permlane32_swap_b32 v253, v250
  v_max_f32 v250, v250, v253
  v_sub_f32 v224, 0, v250
  v_sub_f32 v225, 0, v250
  v_sub_f32 v226, 0, v250
  v_sub_f32 v227, 0, v250
  v_mfma_f32_32x32x16_bf16 v[96:111], a[248:251], v[56:59], v[96:111]
  ds_read_b128 a[244:247], v240 offset:33952
  v_sub_f32 v228, 0, v250
  v_sub_f32 v229, 0, v250
  v_sub_f32 v230, 0, v250
  v_sub_f32 v231, 0, v250
  v_sub_f32 v232, 0, v250
  v_sub_f32 v233, 0, v250
  v_sub_f32 v234, 0, v250
  v_sub_f32 v235, 0, v250
  v_sub_f32 v236, 0, v250
  v_sub_f32 v237, 0, v250
  v_sub_f32 v238, 0, v250
  v_sub_f32 v239, 0, v250
  v_mfma_f32_32x32x16_bf16 v[96:111], a[252:255], v[60:63], v[96:111]
  ds_read_b128 a[248:251], v240 offset:33984
  v_max3_f32 v251, v80, v81, v82
  v_max3_f32 v251, v251, v83, v84
  v_max3_f32 v251, v251, v85, v86
  v_max3_f32 v251, v251, v87, v88
  v_max3_f32 v251, v251, v89, v90
  v_max3_f32 v251, v251, v91, v92
  s_waitcnt lgkmcnt(6)
  v_mfma_f32_32x32x16_bf16 v[112:127], a[224:227], v[192:195], v[224:239]
  ds_read_b128 a[252:255], v240 offset:34016
  v_max3_f32 v251, v251, v93, v94
  v_max_f32 v251, v251, v95
  v_mov_b32 v254, v251
  s_nop 1
  v_permlane32_swap_b32 v254, v251
  v_max_f32 v251, v251, v254
  s_waitcnt lgkmcnt(6)
  v_mfma_f32_32x32x16_bf16 v[112:127], a[228:231], v[196:199], v[112:127]
  v_sub_f32 v160, 0, v251
  v_sub_f32 v161, 0, v251
  v_sub_f32 v162, 0, v251
  v_sub_f32 v163, 0, v251
  v_sub_f32 v164, 0, v251
  v_sub_f32 v165, 0, v251
  v_sub_f32 v166, 0, v251
  s_waitcnt lgkmcnt(5)
  v_mfma_f32_32x32x16_bf16 v[112:127], a[232:235], v[200:203], v[112:127]
  v_sub_f32 v167, 0, v251
  v_sub_f32 v168, 0, v251
  v_sub_f32 v169, 0, v251
  v_sub_f32 v170, 0, v251
  v_sub_f32 v171, 0, v251
  v_sub_f32 v172, 0, v251
  v_sub_f32 v173, 0, v251
  s_waitcnt lgkmcnt(4)
  v_mfma_f32_32x32x16_bf16 v[112:127], a[236:239], v[204:207], v[112:127]
  buffer_load_dwordx4 a[200:203], v245, s[40:43], s60 offen offset:2048 nt
  v_sub_f32 v174, 0, v251
  v_sub_f32 v175, 0, v251
  v_max3_f32 v252, v96, v97, v98
  v_max3_f32 v252, v252, v99, v100
  s_waitcnt lgkmcnt(3)
  v_mfma_f32_32x32x16_bf16 v[112:127], a[240:243], v[208:211], v[112:127]
  v_max3_f32 v252, v252, v101, v102
  v_max3_f32 v252, v252, v103, v104
  v_max3_f32 v252, v252, v105, v106
  v_max3_f32 v252, v252, v107, v108
  v_max3_f32 v252, v252, v109, v110
  v_max_f32 v252, v252, v111
  v_mov_b32 v253, v252
  s_waitcnt lgkmcnt(2)
  v_mfma_f32_32x32x16_bf16 v[112:127], a[244:247], v[212:215], v[112:127]
  s_nop 1
  v_permlane32_swap_b32 v253, v252
  v_max_f32 v252, v252, v253
  v_sub_f32 v176, 0, v252
  v_sub_f32 v177, 0, v252
  v_sub_f32 v178, 0, v252
  v_sub_f32 v179, 0, v252
  s_waitcnt lgkmcnt(1)
  v_mfma_f32_32x32x16_bf16 v[112:127], a[248:251], v[216:219], v[112:127]
  v_sub_f32 v180, 0, v252
  v_sub_f32 v181, 0, v252
  v_sub_f32 v182, 0, v252
  v_sub_f32 v183, 0, v252
  v_sub_f32 v184, 0, v252
  v_sub_f32 v185, 0, v252
  v_sub_f32 v186, 0, v252
  s_waitcnt lgkmcnt(0)
  v_mfma_f32_32x32x16_bf16 v[112:127], a[252:255], v[220:223], v[112:127]
  v_sub_f32 v187, 0, v252
  v_sub_f32 v188, 0, v252
  v_sub_f32 v189, 0, v252
  v_sub_f32 v190, 0, v252
  v_sub_f32 v191, 0, v252
  v_sub_f32 v64, v64, v250
  v_mfma_f32_32x32x16_bf16 v[128:143], a[224:227], v[0:3], v[160:175]
  v_exp_f32 v64, v64
  v_sub_f32 v65, v65, v250
  v_exp_f32 v65, v65
  v_add_f32 v247, v247, v64
  v_sub_f32 v66, v66, v250
  v_mfma_f32_32x32x16_bf16 v[128:143], a[228:231], v[4:7], v[128:143]
  v_exp_f32 v66, v66
  v_add_f32 v247, v247, v65
  v_cvt_pk_bf16_f32 v64, v64, v65
  v_sub_f32 v67, v67, v250
  v_exp_f32 v67, v67
  v_mfma_f32_32x32x16_bf16 v[128:143], a[232:235], v[8:11], v[128:143]
  buffer_load_dwordx4 a[204:207], v246, s[40:43], s60 offen offset:3072 nt
  v_add_f32 v247, v247, v66
  v_sub_f32 v68, v68, v250
  v_exp_f32 v68, v68
  v_mfma_f32_32x32x16_bf16 v[128:143], a[236:239], v[12:15], v[128:143]
  v_add_f32 v247, v247, v67
  v_cvt_pk_bf16_f32 v65, v66, v67
  v_sub_f32 v69, v69, v250
  v_exp_f32 v69, v69
  v_add_f32 v247, v247, v68
  v_sub_f32 v70, v70, v250
  v_mfma_f32_32x32x16_bf16 v[128:143], a[240:243], v[16:19], v[128:143]
  v_exp_f32 v70, v70
  v_add_f32 v247, v247, v69
  v_cvt_pk_bf16_f32 v66, v68, v69
  v_sub_f32 v71, v71, v250
  v_exp_f32 v71, v71
  v_mfma_f32_32x32x16_bf16 v[128:143], a[244:247], v[20:23], v[128:143]
  v_add_f32 v247, v247, v70
  v_sub_f32 v80, v80, v251
  v_exp_f32 v80, v80
  v_add_f32 v247, v247, v71
  v_cvt_pk_bf16_f32 v67, v70, v71
  v_sub_f32 v81, v81, v251
  v_mfma_f32_32x32x16_bf16 v[128:143], a[248:251], v[24:27], v[128:143]
  v_exp_f32 v81, v81
  v_add_f32 v248, v248, v80
  v_sub_f32 v82, v82, v251
  v_exp_f32 v82, v82
  v_add_f32 v248, v248, v81
  v_mfma_f32_32x32x16_bf16 v[128:143], a[252:255], v[28:31], v[128:143]
  v_cvt_pk_bf16_f32 v80, v80, v81
  v_sub_f32 v83, v83, v251
  v_exp_f32 v83, v83
  v_add_f32 v248, v248, v82
  v_sub_f32 v84, v84, v251
  v_mfma_f32_32x32x16_bf16 v[144:159], a[224:227], v[32:35], v[176:191]
  s_add_u32 m0, s61, 0
  s_mov_b32 s59, 40960
  v_exp_f32 v84, v84
  v_add_f32 v248, v248, v83
  v_cvt_pk_bf16_f32 v81, v82, v83
  v_sub_f32 v85, v85, v251
  v_mfma_f32_32x32x16_bf16 v[144:159], a[228:231], v[36:39], v[144:159]
  buffer_load_dwordx4 v243, s[28:31], s59 offen offset:0 nt lds
  ds_read_b64_tr_b16 a[224:225], v241 offset:16512
  ds_read_b64_tr_b16 a[226:227], v241 offset:20608
  v_exp_f32 v85, v85
  v_mfma_f32_32x32x16_bf16 v[144:159], a[232:235], v[40:43], v[144:159]
  ds_read_b64_tr_b16 a[228:229], v242 offset:16512
  ds_read_b64_tr_b16 a[230:231], v242 offset:20608
  v_add_f32 v248, v248, v84
  v_sub_f32 v86, v86, v251
  v_exp_f32 v86, v86
  v_add_f32 v248, v248, v85
  v_mfma_f32_32x32x16_bf16 v[144:159], a[236:239], v[44:47], v[144:159]
  v_cvt_pk_bf16_f32 v82, v84, v85
  v_sub_f32 v87, v87, v251
  v_exp_f32 v87, v87
  v_add_f32 v248, v248, v86
  v_sub_f32 v96, v96, v252
  v_mfma_f32_32x32x16_bf16 v[144:159], a[240:243], v[48:51], v[144:159]
  v_exp_f32 v96, v96
  v_add_f32 v248, v248, v87
  v_cvt_pk_bf16_f32 v83, v86, v87
  v_sub_f32 v97, v97, v252
  v_exp_f32 v97, v97
  v_mfma_f32_32x32x16_bf16 v[144:159], a[244:247], v[52:55], v[144:159]
  ds_read_b64_tr_b16 a[232:233], v241 offset:17536
  v_add_f32 v249, v249, v96
  v_sub_f32 v98, v98, v252
  v_exp_f32 v98, v98
  v_add_f32 v249, v249, v97
  v_cvt_pk_bf16_f32 v96, v96, v97
  v_mfma_f32_32x32x16_bf16 v[144:159], a[248:251], v[56:59], v[144:159]
  ds_read_b64_tr_b16 a[234:235], v241 offset:21632
  v_sub_f32 v99, v99, v252
  v_exp_f32 v99, v99
  v_add_f32 v249, v249, v98
  v_sub_f32 v100, v100, v252
  v_mfma_f32_32x32x16_bf16 v[144:159], a[252:255], v[60:63], v[144:159]
  v_exp_f32 v100, v100
  v_add_f32 v249, v249, v99
  v_cvt_pk_bf16_f32 v97, v98, v99
  v_sub_f32 v101, v101, v252
  v_exp_f32 v101, v101
  v_add_f32 v249, v249, v100
  v_sub_f32 v102, v102, v252
  v_exp_f32 v102, v102
  v_add_f32 v249, v249, v101
  v_cvt_pk_bf16_f32 v98, v100, v101
  v_sub_f32 v103, v103, v252
  v_exp_f32 v103, v103
  s_waitcnt lgkmcnt(4)
  v_mfma_f32_32x32x16_bf16 a[0:15], a[224:227], v[64:67], 0
  buffer_load_dwordx4 v244, s[28:31], s59 offen offset:1024 nt lds
  ds_read_b64_tr_b16 a[236:237], v242 offset:17536
  v_add_f32 v249, v249, v102
  v_sub_f32 v72, v72, v250
  v_exp_f32 v72, v72
  v_add_f32 v249, v249, v103
  v_cvt_pk_bf16_f32 v99, v102, v103
  v_mfma_f32_32x32x16_bf16 a[16:31], a[224:227], v[80:83], 0
  ds_read_b64_tr_b16 a[238:239], v242 offset:21632
  v_sub_f32 v73, v73, v250
  v_exp_f32 v73, v73
  v_add_f32 v247, v247, v72
  v_sub_f32 v74, v74, v250
  v_mfma_f32_32x32x16_bf16 a[32:47], a[224:227], v[96:99], 0
  v_exp_f32 v74, v74
  v_add_f32 v247, v247, v73
  v_cvt_pk_bf16_f32 v72, v72, v73
  v_sub_f32 v75, v75, v250
  v_exp_f32 v75, v75
  s_waitcnt lgkmcnt(4)
  v_mfma_f32_32x32x16_bf16 a[48:63], a[228:231], v[64:67], 0
  ds_read_b64_tr_b16 a[240:241], v241 offset:24704
  v_add_f32 v247, v247, v74
  v_sub_f32 v76, v76, v250
  v_exp_f32 v76, v76
  v_add_f32 v247, v247, v75
  v_cvt_pk_bf16_f32 v73, v74, v75
  v_mfma_f32_32x32x16_bf16 a[64:79], a[228:231], v[80:83], 0
  ds_read_b64_tr_b16 a[242:243], v241 offset:28800
  v_sub_f32 v77, v77, v250
  v_exp_f32 v77, v77
  v_add_f32 v247, v247, v76
  v_sub_f32 v78, v78, v250
  v_mfma_f32_32x32x16_bf16 a[80:95], a[228:231], v[96:99], 0
  v_exp_f32 v78, v78
  v_add_f32 v247, v247, v77
  v_cvt_pk_bf16_f32 v74, v76, v77
  v_sub_f32 v79, v79, v250
  v_exp_f32 v79, v79
  s_waitcnt lgkmcnt(4)
  v_mfma_f32_32x32x16_bf16 a[96:111], a[232:235], v[64:67], 0
  ds_read_b64_tr_b16 a[244:245], v242 offset:24704
  v_add_f32 v247, v247, v78
  v_sub_f32 v88, v88, v251
  v_exp_f32 v88, v88
  v_add_f32 v247, v247, v79
  v_cvt_pk_bf16_f32 v75, v78, v79
  v_mfma_f32_32x32x16_bf16 a[112:127], a[232:235], v[80:83], 0
  ds_read_b64_tr_b16 a[246:247], v242 offset:28800
  v_sub_f32 v89, v89, v251
  v_exp_f32 v89, v89
  v_add_f32 v248, v248, v88
  v_sub_f32 v90, v90, v251
  v_mfma_f32_32x32x16_bf16 a[128:143], a[232:235], v[96:99], 0
  buffer_load_dwordx4 v243, s[32:35], s59 offen offset:2048 nt lds
  v_exp_f32 v90, v90
  v_add_f32 v248, v248, v89
  v_cvt_pk_bf16_f32 v88, v88, v89
  s_waitcnt lgkmcnt(4)
  v_mfma_f32_32x32x16_bf16 a[144:159], a[236:239], v[64:67], 0
  ds_read_b64_tr_b16 a[248:249], v241 offset:25728
  v_sub_f32 v91, v91, v251
  v_exp_f32 v91, v91
  v_add_f32 v248, v248, v90
  v_sub_f32 v92, v92, v251
  v_mfma_f32_32x32x16_bf16 a[160:175], a[236:239], v[80:83], 0
  ds_read_b64_tr_b16 a[250:251], v241 offset:29824
  v_exp_f32 v92, v92
  v_add_f32 v248, v248, v91
  v_cvt_pk_bf16_f32 v89, v90, v91
  v_sub_f32 v93, v93, v251
  v_exp_f32 v93, v93
  v_add_f32 v248, v248, v92
  v_sub_f32 v94, v94, v251
  v_exp_f32 v94, v94
  v_add_f32 v248, v248, v93
  v_cvt_pk_bf16_f32 v90, v92, v93
  v_sub_f32 v95, v95, v251
  v_exp_f32 v95, v95
  s_waitcnt vmcnt(12)
  v_mfma_f32_32x32x16_bf16 a[176:191], a[236:239], v[96:99], 0
  v_add_f32 v248, v248, v94
  v_sub_f32 v104, v104, v252
  v_exp_f32 v104, v104
  v_add_f32 v248, v248, v95
  v_cvt_pk_bf16_f32 v91, v94, v95
  v_sub_f32 v105, v105, v252
  v_exp_f32 v105, v105
  v_add_f32 v249, v249, v104
  v_sub_f32 v106, v106, v252
  v_exp_f32 v106, v106
  v_add_f32 v249, v249, v105
  v_cvt_pk_bf16_f32 v104, v104, v105
  v_sub_f32 v107, v107, v252
  v_exp_f32 v107, v107
  v_add_f32 v249, v249, v106
  v_sub_f32 v108, v108, v252
  v_exp_f32 v108, v108
  v_add_f32 v249, v249, v107
  v_cvt_pk_bf16_f32 v105, v106, v107
  v_sub_f32 v109, v109, v252
  v_exp_f32 v109, v109
  v_add_f32 v249, v249, v108
  v_sub_f32 v110, v110, v252
  v_exp_f32 v110, v110
  v_add_f32 v249, v249, v109
  v_cvt_pk_bf16_f32 v106, v108, v109
  v_sub_f32 v111, v111, v252
  v_exp_f32 v111, v111
  s_waitcnt lgkmcnt(4)
  v_mfma_f32_32x32x16_bf16 a[0:15], a[240:243], v[72:75], a[0:15]
  ds_read_b64_tr_b16 a[252:253], v242 offset:25728
  v_add_f32 v249, v249, v110
  v_add_f32 v249, v249, v111
  v_cvt_pk_bf16_f32 v107, v110, v111
  v_exp_f32 v112, v112
  v_mfma_f32_32x32x16_bf16 a[16:31], a[240:243], v[88:91], a[16:31]
  ds_read_b64_tr_b16 a[254:255], v242 offset:29824
  v_exp_f32 v113, v113
  v_add_f32 v247, v247, v112
  v_exp_f32 v114, v114
  v_add_f32 v247, v247, v113
  v_mfma_f32_32x32x16_bf16 a[32:47], a[240:243], v[104:107], a[32:47]
  v_add_u32 v240, 65792, v240
  v_cvt_pk_bf16_f32 v112, v112, v113
  v_exp_f32 v115, v115
  v_add_f32 v247, v247, v114
  v_exp_f32 v116, v116
  s_waitcnt lgkmcnt(4)
  v_mfma_f32_32x32x16_bf16 a[48:63], a[244:247], v[72:75], a[48:63]
  buffer_load_dwordx4 v244, s[32:35], s59 offen offset:3072 nt lds
  v_add_f32 v247, v247, v115
  v_cvt_pk_bf16_f32 v113, v114, v115
  v_exp_f32 v117, v117
  v_mfma_f32_32x32x16_bf16 a[64:79], a[244:247], v[88:91], a[64:79]
  s_waitcnt lgkmcnt(0)
  s_barrier
  v_add_f32 v247, v247, v116
  v_exp_f32 v118, v118
  v_add_f32 v247, v247, v117
  v_cvt_pk_bf16_f32 v114, v116, v117
  v_mfma_f32_32x32x16_bf16 a[80:95], a[244:247], v[104:107], a[80:95]
  v_exp_f32 v119, v119
  v_add_f32 v247, v247, v118
  v_exp_f32 v128, v128
  v_add_f32 v247, v247, v119
  v_cvt_pk_bf16_f32 v115, v118, v119
  v_mfma_f32_32x32x16_bf16 a[96:111], a[248:251], v[72:75], a[96:111]
  ds_read_b128 a[224:227], v240 offset:0
  v_exp_f32 v129, v129
  v_add_f32 v248, v248, v128
  v_exp_f32 v130, v130
  v_add_f32 v248, v248, v129
  v_mfma_f32_32x32x16_bf16 a[112:127], a[248:251], v[88:91], a[112:127]
  v_cvt_pk_bf16_f32 v128, v128, v129
  v_exp_f32 v131, v131
  v_add_f32 v248, v248, v130
  v_exp_f32 v132, v132
  v_add_f32 v248, v248, v131
  v_mfma_f32_32x32x16_bf16 a[128:143], a[248:251], v[104:107], a[128:143]
  ds_read_b128 a[228:231], v240 offset:32
  v_cvt_pk_bf16_f32 v129, v130, v131
  v_exp_f32 v133, v133
  v_add_f32 v248, v248, v132
  v_exp_f32 v134, v134
  v_mfma_f32_32x32x16_bf16 a[144:159], a[252:255], v[72:75], a[144:159]
  s_add_u32 m0, s61, 32896
  s_mov_b32 s59, 49152
  v_add_f32 v248, v248, v133
  v_cvt_pk_bf16_f32 v130, v132, v133
  v_exp_f32 v135, v135
  v_add_f32 v248, v248, v134
  v_mfma_f32_32x32x16_bf16 a[160:175], a[252:255], v[88:91], a[160:175]
  buffer_load_dwordx4 v243, s[28:31], s59 offen offset:0 nt lds
  ds_read_b128 a[232:235], v240 offset:64
  v_exp_f32 v144, v144
  v_add_f32 v248, v248, v135
  v_mfma_f32_32x32x16_bf16 a[176:191], a[252:255], v[104:107], a[176:191]
  v_cvt_pk_bf16_f32 v131, v134, v135
  v_exp_f32 v145, v145
  v_add_f32 v249, v249, v144
  v_exp_f32 v146, v146
  v_add_f32 v249, v249, v145
  s_waitcnt lgkmcnt(2)
  v_mfma_f32_32x32x16_bf16 v[64:79], a[224:227], v[192:195], v[224:239]
  v_cvt_pk_bf16_f32 v144, v144, v145
  v_exp_f32 v147, v147
  v_add_f32 v249, v249, v146
  v_exp_f32 v148, v148
  v_mfma_f32_32x32x16_bf16 v[80:95], a[224:227], v[0:3], v[160:175]
  ds_read_b128 a[236:239], v240 offset:96
  v_add_f32 v249, v249, v147
  v_cvt_pk_bf16_f32 v145, v146, v147
  v_exp_f32 v149, v149
  v_add_f32 v249, v249, v148
  v_mfma_f32_32x32x16_bf16 v[96:111], a[224:227], v[32:35], v[176:191]
  v_exp_f32 v150, v150
  v_add_f32 v249, v249, v149
  v_cvt_pk_bf16_f32 v146, v148, v149
  s_waitcnt lgkmcnt(2)
  v_mfma_f32_32x32x16_bf16 v[64:79], a[228:231], v[196:199], v[64:79]
  v_exp_f32 v151, v151
  v_add_f32 v249, v249, v150
  v_exp_f32 v120, v120
  v_add_f32 v249, v249, v151
  v_mfma_f32_32x32x16_bf16 v[80:95], a[228:231], v[4:7], v[80:95]
  ds_read_b128 a[240:243], v240 offset:1024
  v_cvt_pk_bf16_f32 v147, v150, v151
  v_exp_f32 v121, v121
  v_add_f32 v247, v247, v120
  v_mfma_f32_32x32x16_bf16 v[96:111], a[228:231], v[36:39], v[96:111]
  buffer_load_dwordx4 v244, s[28:31], s59 offen offset:1024 nt lds
  v_exp_f32 v122, v122
  s_waitcnt lgkmcnt(2)
  v_mfma_f32_32x32x16_bf16 v[64:79], a[232:235], v[200:203], v[64:79]
  v_add_f32 v247, v247, v121
  v_cvt_pk_bf16_f32 v120, v120, v121
  v_exp_f32 v123, v123
  v_add_f32 v247, v247, v122
  v_mfma_f32_32x32x16_bf16 v[80:95], a[232:235], v[8:11], v[80:95]
  ds_read_b128 a[244:247], v240 offset:1056
  v_exp_f32 v124, v124
  v_add_f32 v247, v247, v123
  v_cvt_pk_bf16_f32 v121, v122, v123
  v_mfma_f32_32x32x16_bf16 v[96:111], a[232:235], v[40:43], v[96:111]
  v_exp_f32 v125, v125
  v_add_f32 v247, v247, v124
  v_exp_f32 v126, v126
  s_waitcnt lgkmcnt(2)
  v_mfma_f32_32x32x16_bf16 v[64:79], a[236:239], v[204:207], v[64:79]
  v_add_f32 v247, v247, v125
  v_cvt_pk_bf16_f32 v122, v124, v125
  v_exp_f32 v127, v127
  v_add_f32 v247, v247, v126
  v_mfma_f32_32x32x16_bf16 v[80:95], a[236:239], v[12:15], v[80:95]
  ds_read_b128 a[248:251], v240 offset:1088
  v_exp_f32 v136, v136
  v_add_f32 v247, v247, v127
  v_cvt_pk_bf16_f32 v123, v126, v127
  v_mfma_f32_32x32x16_bf16 v[96:111], a[236:239], v[44:47], v[96:111]
  v_exp_f32 v137, v137
  v_add_f32 v248, v248, v136
  v_exp_f32 v138, v138
  s_waitcnt lgkmcnt(2)
  v_mfma_f32_32x32x16_bf16 v[64:79], a[240:243], v[208:211], v[64:79]
  v_add_f32 v248, v248, v137
  v_cvt_pk_bf16_f32 v136, v136, v137
  v_exp_f32 v139, v139
  v_add_f32 v248, v248, v138
  v_mfma_f32_32x32x16_bf16 v[80:95], a[240:243], v[16:19], v[80:95]
  buffer_load_dwordx4 v243, s[32:35], s59 offen offset:2048 nt lds
  ds_read_b128 a[252:255], v240 offset:1120
  v_exp_f32 v140, v140
  v_mfma_f32_32x32x16_bf16 v[96:111], a[240:243], v[48:51], v[96:111]
  v_add_f32 v248, v248, v139
  v_cvt_pk_bf16_f32 v137, v138, v139
  v_exp_f32 v141, v141
  v_add_f32 v248, v248, v140
  s_waitcnt lgkmcnt(2)
  v_mfma_f32_32x32x16_bf16 v[64:79], a[244:247], v[212:215], v[64:79]
  ds_read_b64_tr_b16 a[224:225], v241 offset:49408
  v_exp_f32 v142, v142
  v_add_f32 v248, v248, v141
  v_cvt_pk_bf16_f32 v138, v140, v141
  v_mfma_f32_32x32x16_bf16 v[80:95], a[244:247], v[20:23], v[80:95]
  ds_read_b64_tr_b16 a[226:227], v241 offset:53504
  v_exp_f32 v143, v143
  v_add_f32 v248, v248, v142
  v_exp_f32 v152, v152
  v_mfma_f32_32x32x16_bf16 v[96:111], a[244:247], v[52:55], v[96:111]
  v_add_f32 v248, v248, v143
  v_cvt_pk_bf16_f32 v139, v142, v143
  v_exp_f32 v153, v153
  v_add_f32 v249, v249, v152
  s_waitcnt lgkmcnt(3)
  v_mfma_f32_32x32x16_bf16 v[64:79], a[248:251], v[216:219], v[64:79]
  ds_read_b64_tr_b16 a[228:229], v242 offset:49408
  v_exp_f32 v154, v154
  v_add_f32 v249, v249, v153
  v_cvt_pk_bf16_f32 v152, v152, v153
  v_mfma_f32_32x32x16_bf16 v[80:95], a[248:251], v[24:27], v[80:95]
  ds_read_b64_tr_b16 a[230:231], v242 offset:53504
  v_exp_f32 v155, v155
  v_add_f32 v249, v249, v154
  v_exp_f32 v156, v156
  v_mfma_f32_32x32x16_bf16 v[96:111], a[248:251], v[56:59], v[96:111]
  buffer_load_dwordx4 v244, s[32:35], s59 offen offset:3072 nt lds
  v_add_f32 v249, v249, v155
  v_cvt_pk_bf16_f32 v153, v154, v155
  s_waitcnt lgkmcnt(4)
  v_mfma_f32_32x32x16_bf16 v[64:79], a[252:255], v[220:223], v[64:79]
  ds_read_b64_tr_b16 a[232:233], v241 offset:50432
  v_exp_f32 v157, v157
  v_add_f32 v249, v249, v156
  v_exp_f32 v158, v158
  v_mfma_f32_32x32x16_bf16 v[80:95], a[252:255], v[28:31], v[80:95]
  ds_read_b64_tr_b16 a[234:235], v241 offset:54528
  v_add_f32 v249, v249, v157
  v_cvt_pk_bf16_f32 v154, v156, v157
  v_exp_f32 v159, v159
  v_add_f32 v249, v249, v158
  v_mfma_f32_32x32x16_bf16 v[96:111], a[252:255], v[60:63], v[96:111]
  v_add_f32 v249, v249, v159
  v_cvt_pk_bf16_f32 v155, v158, v159
  s_waitcnt lgkmcnt(4)
  v_mfma_f32_32x32x16_bf16 a[0:15], a[224:227], v[112:115], a[0:15]
  ds_read_b64_tr_b16 a[236:237], v242 offset:50432
  v_mfma_f32_32x32x16_bf16 a[16:31], a[224:227], v[128:131], a[16:31]
  ds_read_b64_tr_b16 a[238:239], v242 offset:54528
  v_exp_f32 v64, v64
  v_exp_f32 v65, v65
  v_add_f32 v247, v247, v64
  v_mfma_f32_32x32x16_bf16 a[32:47], a[224:227], v[144:147], a[32:47]
  v_exp_f32 v66, v66
  v_add_f32 v247, v247, v65
  v_cvt_pk_bf16_f32 v64, v64, v65
  s_waitcnt lgkmcnt(4)
  v_mfma_f32_32x32x16_bf16 a[48:63], a[228:231], v[112:115], a[48:63]
  ds_read_b64_tr_b16 a[240:241], v241 offset:57600
  v_exp_f32 v67, v67
  v_add_f32 v247, v247, v66
  v_exp_f32 v68, v68
  v_mfma_f32_32x32x16_bf16 a[64:79], a[228:231], v[128:131], a[64:79]
  ds_read_b64_tr_b16 a[242:243], v241 offset:61696
  v_add_f32 v247, v247, v67
  v_cvt_pk_bf16_f32 v65, v66, v67
  v_exp_f32 v69, v69
  v_add_f32 v247, v247, v68
  v_mfma_f32_32x32x16_bf16 a[80:95], a[228:231], v[144:147], a[80:95]
  v_exp_f32 v70, v70
  v_add_f32 v247, v247, v69
  v_cvt_pk_bf16_f32 v66, v68, v69
  s_waitcnt lgkmcnt(4)
  v_mfma_f32_32x32x16_bf16 a[96:111], a[232:235], v[112:115], a[96:111]
  ds_read_b64_tr_b16 a[244:245], v242 offset:57600
  v_exp_f32 v71, v71
  v_add_f32 v247, v247, v70
  v_exp_f32 v80, v80
  v_mfma_f32_32x32x16_bf16 a[112:127], a[232:235], v[128:131], a[112:127]
  ds_read_b64_tr_b16 a[246:247], v242 offset:61696
  v_add_f32 v247, v247, v71
  v_cvt_pk_bf16_f32 v67, v70, v71
  v_exp_f32 v81, v81
  v_add_f32 v248, v248, v80
  v_mfma_f32_32x32x16_bf16 a[128:143], a[232:235], v[144:147], a[128:143]
  v_exp_f32 v82, v82
  v_add_f32 v248, v248, v81
  v_cvt_pk_bf16_f32 v80, v80, v81
  s_waitcnt lgkmcnt(4)
  v_mfma_f32_32x32x16_bf16 a[144:159], a[236:239], v[112:115], a[144:159]
  ds_read_b64_tr_b16 a[248:249], v241 offset:58624
  v_exp_f32 v83, v83
  v_add_f32 v248, v248, v82
  v_exp_f32 v84, v84
  v_mfma_f32_32x32x16_bf16 a[160:175], a[236:239], v[128:131], a[160:175]
  ds_read_b64_tr_b16 a[250:251], v241 offset:62720
  v_add_f32 v248, v248, v83
  v_cvt_pk_bf16_f32 v81, v82, v83
  v_exp_f32 v85, v85
  v_add_f32 v248, v248, v84
  v_mfma_f32_32x32x16_bf16 a[176:191], a[236:239], v[144:147], a[176:191]
  v_exp_f32 v86, v86
  v_add_f32 v248, v248, v85
  v_cvt_pk_bf16_f32 v82, v84, v85
  s_waitcnt lgkmcnt(4)
  v_mfma_f32_32x32x16_bf16 a[0:15], a[240:243], v[120:123], a[0:15]
  ds_read_b64_tr_b16 a[252:253], v242 offset:58624
  v_exp_f32 v87, v87
  v_add_f32 v248, v248, v86
  v_exp_f32 v96, v96
  v_mfma_f32_32x32x16_bf16 a[16:31], a[240:243], v[136:139], a[16:31]
  ds_read_b64_tr_b16 a[254:255], v242 offset:62720
  v_add_f32 v248, v248, v87
  v_cvt_pk_bf16_f32 v83, v86, v87
  v_exp_f32 v97, v97
  v_add_f32 v249, v249, v96
  v_mfma_f32_32x32x16_bf16 a[32:47], a[240:243], v[152:155], a[32:47]
  v_exp_f32 v98, v98
  v_add_f32 v249, v249, v97
  v_cvt_pk_bf16_f32 v96, v96, v97
  s_waitcnt lgkmcnt(4)
  v_mfma_f32_32x32x16_bf16 a[48:63], a[244:247], v[120:123], a[48:63]
  v_exp_f32 v99, v99
  v_add_f32 v249, v249, v98
  v_exp_f32 v100, v100
  v_add_f32 v249, v249, v99
  v_mfma_f32_32x32x16_bf16 a[64:79], a[244:247], v[136:139], a[64:79]
  s_waitcnt lgkmcnt(0)
  s_barrier
  v_cvt_pk_bf16_f32 v97, v98, v99
  v_exp_f32 v101, v101
  v_add_f32 v249, v249, v100
  v_mfma_f32_32x32x16_bf16 a[80:95], a[244:247], v[152:155], a[80:95]
  s_add_u32 m0, s61, 65792
  s_mov_b32 s59, 57344
  v_exp_f32 v102, v102
  v_add_f32 v249, v249, v101
  v_mfma_f32_32x32x16_bf16 a[96:111], a[248:251], v[120:123], a[96:111]
  buffer_load_dwordx4 v243, s[28:31], s59 offen offset:0 nt lds
  ds_read_b128 a[224:227], v240 offset:32896
  v_cvt_pk_bf16_f32 v98, v100, v101
  v_mfma_f32_32x32x16_bf16 a[112:127], a[248:251], v[136:139], a[112:127]
  v_exp_f32 v103, v103
  v_add_f32 v249, v249, v102
  v_exp_f32 v72, v72
  v_add_f32 v249, v249, v103
  v_mfma_f32_32x32x16_bf16 a[128:143], a[248:251], v[152:155], a[128:143]
  ds_read_b128 a[228:231], v240 offset:32928
  v_cvt_pk_bf16_f32 v99, v102, v103
  v_exp_f32 v73, v73
  v_add_f32 v247, v247, v72
  v_mfma_f32_32x32x16_bf16 a[144:159], a[252:255], v[120:123], a[144:159]
  v_exp_f32 v74, v74
  v_add_f32 v247, v247, v73
  v_cvt_pk_bf16_f32 v72, v72, v73
  v_exp_f32 v75, v75
  v_mfma_f32_32x32x16_bf16 a[160:175], a[252:255], v[136:139], a[160:175]
  ds_read_b128 a[232:235], v240 offset:32960
  v_add_f32 v247, v247, v74
  v_exp_f32 v76, v76
  v_add_f32 v247, v247, v75
  v_cvt_pk_bf16_f32 v73, v74, v75
  v_mfma_f32_32x32x16_bf16 a[176:191], a[252:255], v[152:155], a[176:191]
  v_exp_f32 v77, v77
  v_add_f32 v247, v247, v76
  v_exp_f32 v78, v78
  s_waitcnt lgkmcnt(2)
  v_mfma_f32_32x32x16_bf16 v[112:127], a[224:227], v[192:195], v[224:239]
  v_add_f32 v247, v247, v77
  v_cvt_pk_bf16_f32 v74, v76, v77
  v_exp_f32 v79, v79
  v_add_f32 v247, v247, v78
  v_mfma_f32_32x32x16_bf16 v[128:143], a[224:227], v[0:3], v[160:175]
  buffer_load_dwordx4 v244, s[28:31], s59 offen offset:1024 nt lds
  ds_read_b128 a[236:239], v240 offset:32992
  v_exp_f32 v88, v88
  v_mfma_f32_32x32x16_bf16 v[144:159], a[224:227], v[32:35], v[176:191]
  v_add_f32 v247, v247, v79
  v_cvt_pk_bf16_f32 v75, v78, v79
  v_exp_f32 v89, v89
  v_add_f32 v248, v248, v88
  s_waitcnt lgkmcnt(2)
  v_mfma_f32_32x32x16_bf16 v[112:127], a[228:231], v[196:199], v[112:127]
  v_exp_f32 v90, v90
  v_add_f32 v248, v248, v89
  v_cvt_pk_bf16_f32 v88, v88, v89
  v_exp_f32 v91, v91
  v_mfma_f32_32x32x16_bf16 v[128:143], a[228:231], v[4:7], v[128:143]
  ds_read_b128 a[240:243], v240 offset:33920
  v_add_f32 v248, v248, v90
  v_exp_f32 v92, v92
  v_add_f32 v248, v248, v91
  v_cvt_pk_bf16_f32 v89, v90, v91
  v_mfma_f32_32x32x16_bf16 v[144:159], a[228:231], v[36:39], v[144:159]
  v_exp_f32 v93, v93
  v_add_f32 v248, v248, v92
  v_exp_f32 v94, v94
  s_waitcnt lgkmcnt(2)
  v_mfma_f32_32x32x16_bf16 v[112:127], a[232:235], v[200:203], v[112:127]
  v_add_f32 v248, v248, v93
  v_cvt_pk_bf16_f32 v90, v92, v93
  v_exp_f32 v95, v95
  v_add_f32 v248, v248, v94
  v_mfma_f32_32x32x16_bf16 v[128:143], a[232:235], v[8:11], v[128:143]
  ds_read_b128 a[244:247], v240 offset:33952
  v_exp_f32 v104, v104
  v_add_f32 v248, v248, v95
  v_cvt_pk_bf16_f32 v91, v94, v95
  v_mfma_f32_32x32x16_bf16 v[144:159], a[232:235], v[40:43], v[144:159]
  buffer_load_dwordx4 v243, s[32:35], s59 offen offset:2048 nt lds
  v_exp_f32 v105, v105
  s_waitcnt lgkmcnt(2)
  v_mfma_f32_32x32x16_bf16 v[112:127], a[236:239], v[204:207], v[112:127]
  v_add_f32 v249, v249, v104
  v_exp_f32 v106, v106
  v_add_f32 v249, v249, v105
  v_cvt_pk_bf16_f32 v104, v104, v105
  v_mfma_f32_32x32x16_bf16 v[128:143], a[236:239], v[12:15], v[128:143]
  ds_read_b128 a[248:251], v240 offset:33984
  v_add_u32 v241, 65792, v241
  v_add_u32 v242, 65792, v242
  v_exp_f32 v107, v107
  v_add_f32 v249, v249, v106
  v_mfma_f32_32x32x16_bf16 v[144:159], a[236:239], v[44:47], v[144:159]
  v_exp_f32 v108, v108
  v_add_f32 v249, v249, v107
  v_cvt_pk_bf16_f32 v105, v106, v107
  s_waitcnt lgkmcnt(2)
  v_mfma_f32_32x32x16_bf16 v[112:127], a[240:243], v[208:211], v[112:127]
  v_exp_f32 v109, v109
  v_add_f32 v249, v249, v108
  v_exp_f32 v110, v110
  v_add_f32 v249, v249, v109
  v_mfma_f32_32x32x16_bf16 v[128:143], a[240:243], v[16:19], v[128:143]
  ds_read_b128 a[252:255], v240 offset:34016
  v_cvt_pk_bf16_f32 v106, v108, v109
  v_exp_f32 v111, v111
  v_add_f32 v249, v249, v110
  v_add_f32 v249, v249, v111
  v_mfma_f32_32x32x16_bf16 v[144:159], a[240:243], v[48:51], v[144:159]
  v_mbcnt_lo_u32_b32 v254, -1, 0
  v_mbcnt_hi_u32_b32 v254, -1, v254
  v_cvt_pk_bf16_f32 v107, v110, v111
  s_waitcnt lgkmcnt(2)
  v_mfma_f32_32x32x16_bf16 v[112:127], a[244:247], v[212:215], v[112:127]
  buffer_load_dwordx4 v244, s[32:35], s59 offen offset:3072 nt lds
  ds_read_b64_tr_b16 a[224:225], v241 offset:16512
  v_mfma_f32_32x32x16_bf16 v[128:143], a[244:247], v[20:23], v[128:143]
  ds_read_b64_tr_b16 a[226:227], v241 offset:20608
  v_lshlrev_b32 v254, 4, v254
  v_add_u32 v254, s62, v254
  v_mfma_f32_32x32x16_bf16 v[144:159], a[244:247], v[52:55], v[144:159]
  s_waitcnt lgkmcnt(3)
  v_mfma_f32_32x32x16_bf16 v[112:127], a[248:251], v[216:219], v[112:127]
  ds_read_b64_tr_b16 a[228:229], v242 offset:16512
  s_waitcnt vmcnt(15)
  ds_write_b128 v254, a[192:195] offset:16512
  v_mfma_f32_32x32x16_bf16 v[128:143], a[248:251], v[24:27], v[128:143]
  ds_read_b64_tr_b16 a[230:231], v242 offset:20608
  v_mfma_f32_32x32x16_bf16 v[144:159], a[248:251], v[56:59], v[144:159]
  s_waitcnt vmcnt(14)
  ds_write_b128 v254, a[196:199] offset:17536
  s_waitcnt lgkmcnt(6)
  v_mfma_f32_32x32x16_bf16 v[112:127], a[252:255], v[220:223], v[112:127]
  ds_read_b64_tr_b16 a[232:233], v241 offset:17536
  s_add_u32 m0, s62, 49408
  s_mov_b32 s59, 40960
  v_mfma_f32_32x32x16_bf16 v[128:143], a[252:255], v[28:31], v[128:143]
  buffer_load_dwordx4 v245, s[36:39], s59 offen offset:0 nt lds
  ds_read_b64_tr_b16 a[234:235], v241 offset:21632
  s_waitcnt vmcnt(14)
  ds_write_b128 v254, a[200:203] offset:18560
  v_mfma_f32_32x32x16_bf16 v[144:159], a[252:255], v[60:63], v[144:159]
  s_waitcnt lgkmcnt(7)
  v_mfma_f32_32x32x16_bf16 a[0:15], a[224:227], v[64:67], a[0:15]
  ds_read_b64_tr_b16 a[236:237], v242 offset:17536
  s_waitcnt vmcnt(13)
  ds_write_b128 v254, a[204:207] offset:19584
  v_mfma_f32_32x32x16_bf16 a[16:31], a[224:227], v[80:83], a[16:31]
  ds_read_b64_tr_b16 a[238:239], v242 offset:21632
  v_exp_f32 v112, v112
  v_exp_f32 v113, v113
  v_add_f32 v247, v247, v112
  v_mfma_f32_32x32x16_bf16 a[32:47], a[224:227], v[96:99], a[32:47]
  v_exp_f32 v114, v114
  v_add_f32 v247, v247, v113
  v_cvt_pk_bf16_f32 v112, v112, v113
  s_waitcnt lgkmcnt(7)
  v_mfma_f32_32x32x16_bf16 a[48:63], a[228:231], v[64:67], a[48:63]
  ds_read_b64_tr_b16 a[240:241], v241 offset:24704
  v_exp_f32 v115, v115
  v_add_f32 v247, v247, v114
  v_exp_f32 v116, v116
  v_mfma_f32_32x32x16_bf16 a[64:79], a[228:231], v[80:83], a[64:79]
  ds_read_b64_tr_b16 a[242:243], v241 offset:28800
  v_add_f32 v247, v247, v115
  v_cvt_pk_bf16_f32 v113, v114, v115
  v_exp_f32 v117, v117
  v_add_f32 v247, v247, v116
  v_mfma_f32_32x32x16_bf16 a[80:95], a[228:231], v[96:99], a[80:95]
  buffer_load_dwordx4 v246, s[36:39], s59 offen offset:1024 nt lds
  v_exp_f32 v118, v118
  s_waitcnt lgkmcnt(6)
  v_mfma_f32_32x32x16_bf16 a[96:111], a[232:235], v[64:67], a[96:111]
  ds_read_b64_tr_b16 a[244:245], v242 offset:24704
  v_add_f32 v247, v247, v117
  v_cvt_pk_bf16_f32 v114, v116, v117
  v_exp_f32 v119, v119
  v_add_f32 v247, v247, v118
  v_mfma_f32_32x32x16_bf16 a[112:127], a[232:235], v[80:83], a[112:127]
  ds_read_b64_tr_b16 a[246:247], v242 offset:28800
  v_exp_f32 v128, v128
  v_add_f32 v247, v247, v119
  v_cvt_pk_bf16_f32 v115, v118, v119
  v_mfma_f32_32x32x16_bf16 a[128:143], a[232:235], v[96:99], a[128:143]
  v_exp_f32 v129, v129
  v_add_f32 v248, v248, v128
  v_exp_f32 v130, v130
  s_waitcnt lgkmcnt(4)
  v_mfma_f32_32x32x16_bf16 a[144:159], a[236:239], v[64:67], a[144:159]
  ds_read_b64_tr_b16 a[248:249], v241 offset:25728
  v_add_f32 v248, v248, v129
  v_cvt_pk_bf16_f32 v128, v128, v129
  v_exp_f32 v131, v131
  v_add_f32 v248, v248, v130
  v_mfma_f32_32x32x16_bf16 a[160:175], a[236:239], v[80:83], a[160:175]
  ds_read_b64_tr_b16 a[250:251], v241 offset:29824
  v_exp_f32 v132, v132
  v_add_f32 v248, v248, v131
  v_cvt_pk_bf16_f32 v129, v130, v131
  v_mfma_f32_32x32x16_bf16 a[176:191], a[236:239], v[96:99], a[176:191]
  v_exp_f32 v133, v133
  v_add_f32 v248, v248, v132
  v_exp_f32 v134, v134
  s_waitcnt lgkmcnt(4)
  v_mfma_f32_32x32x16_bf16 a[0:15], a[240:243], v[72:75], a[0:15]
  buffer_load_dwordx4 v245, s[40:43], s59 offen offset:2048 nt lds
  ds_read_b64_tr_b16 a[252:253], v242 offset:25728
  v_add_f32 v248, v248, v133
  v_cvt_pk_bf16_f32 v130, v132, v133
  v_mfma_f32_32x32x16_bf16 a[16:31], a[240:243], v[88:91], a[16:31]
  ds_read_b64_tr_b16 a[254:255], v242 offset:29824
  v_exp_f32 v135, v135
  v_add_f32 v248, v248, v134
  v_exp_f32 v144, v144
  v_mfma_f32_32x32x16_bf16 a[32:47], a[240:243], v[104:107], a[32:47]
  v_add_u32 v240, 65792, v240
  v_add_f32 v248, v248, v135
  v_cvt_pk_bf16_f32 v131, v134, v135
  v_exp_f32 v145, v145
  s_waitcnt lgkmcnt(4)
  v_mfma_f32_32x32x16_bf16 a[48:63], a[244:247], v[72:75], a[48:63]
  v_add_f32 v249, v249, v144
  v_exp_f32 v146, v146
  v_add_f32 v249, v249, v145
  v_cvt_pk_bf16_f32 v144, v144, v145
  v_mfma_f32_32x32x16_bf16 a[64:79], a[244:247], v[88:91], a[64:79]
  s_waitcnt lgkmcnt(0)
  s_barrier
  v_exp_f32 v147, v147
  v_add_f32 v249, v249, v146
  v_mfma_f32_32x32x16_bf16 a[80:95], a[244:247], v[104:107], a[80:95]
  v_exp_f32 v148, v148
  v_add_f32 v249, v249, v147
  v_cvt_pk_bf16_f32 v145, v146, v147
  v_mfma_f32_32x32x16_bf16 a[96:111], a[248:251], v[72:75], a[96:111]
  ds_read_b128 a[224:227], v240 offset:0
  v_exp_f32 v149, v149
  v_add_f32 v249, v249, v148
  v_exp_f32 v150, v150
  v_mfma_f32_32x32x16_bf16 a[112:127], a[248:251], v[88:91], a[112:127]
  buffer_load_dwordx4 v246, s[40:43], s59 offen offset:3072 nt lds
  v_add_f32 v249, v249, v149
  v_cvt_pk_bf16_f32 v146, v148, v149
  v_mfma_f32_32x32x16_bf16 a[128:143], a[248:251], v[104:107], a[128:143]
  ds_read_b128 a[228:231], v240 offset:32
  v_exp_f32 v151, v151
  v_add_f32 v249, v249, v150
  v_mfma_f32_32x32x16_bf16 a[144:159], a[252:255], v[72:75], a[144:159]
  v_exp_f32 v120, v120
  v_add_f32 v249, v249, v151
  v_cvt_pk_bf16_f32 v147, v150, v151
  v_exp_f32 v121, v121
  v_mfma_f32_32x32x16_bf16 a[160:175], a[252:255], v[88:91], a[160:175]
  ds_read_b128 a[232:235], v240 offset:64
  v_add_f32 v247, v247, v120
  v_exp_f32 v122, v122
  v_add_f32 v247, v247, v121
  v_cvt_pk_bf16_f32 v120, v120, v121
  v_mfma_f32_32x32x16_bf16 a[176:191], a[252:255], v[104:107], a[176:191]
  v_exp_f32 v123, v123
  v_add_f32 v247, v247, v122
  v_exp_f32 v124, v124
  s_waitcnt lgkmcnt(2)
  v_mfma_f32_32x32x16_bf16 v[64:79], a[224:227], v[192:195], v[224:239]
  v_add_f32 v247, v247, v123
  v_cvt_pk_bf16_f32 v121, v122, v123
  v_exp_f32 v125, v125
  v_add_f32 v247, v247, v124
  v_mfma_f32_32x32x16_bf16 v[80:95], a[224:227], v[0:3], v[160:175]
  ds_read_b128 a[236:239], v240 offset:96
  s_add_u32 m0, s62, 82304
  s_mov_b32 s59, 49152
  v_exp_f32 v126, v126
  v_add_f32 v247, v247, v125
  v_mfma_f32_32x32x16_bf16 v[96:111], a[224:227], v[32:35], v[176:191]
  buffer_load_dwordx4 v245, s[36:39], s59 offen offset:0 nt lds
  v_cvt_pk_bf16_f32 v122, v124, v125
  s_waitcnt lgkmcnt(2)
  v_mfma_f32_32x32x16_bf16 v[64:79], a[228:231], v[196:199], v[64:79]
  v_exp_f32 v127, v127
  v_add_f32 v247, v247, v126
  v_exp_f32 v136, v136
  v_add_f32 v247, v247, v127
  v_mfma_f32_32x32x16_bf16 v[80:95], a[228:231], v[4:7], v[80:95]
  ds_read_b128 a[240:243], v240 offset:1024
  v_cvt_pk_bf16_f32 v123, v126, v127
  v_exp_f32 v137, v137
  v_add_f32 v248, v248, v136
  v_mfma_f32_32x32x16_bf16 v[96:111], a[228:231], v[36:39], v[96:111]
  v_exp_f32 v138, v138
  v_add_f32 v248, v248, v137
  v_cvt_pk_bf16_f32 v136, v136, v137
  s_waitcnt lgkmcnt(2)
  v_mfma_f32_32x32x16_bf16 v[64:79], a[232:235], v[200:203], v[64:79]
  v_exp_f32 v139, v139
  v_add_f32 v248, v248, v138
  v_exp_f32 v140, v140
  v_add_f32 v248, v248, v139
  v_mfma_f32_32x32x16_bf16 v[80:95], a[232:235], v[8:11], v[80:95]
  ds_read_b128 a[244:247], v240 offset:1056
  v_cvt_pk_bf16_f32 v137, v138, v139
  v_exp_f32 v141, v141
  v_add_f32 v248, v248, v140
  v_mfma_f32_32x32x16_bf16 v[96:111], a[232:235], v[40:43], v[96:111]
  v_exp_f32 v142, v142
  v_add_f32 v248, v248, v141
  v_cvt_pk_bf16_f32 v138, v140, v141
  s_waitcnt lgkmcnt(2)
  v_mfma_f32_32x32x16_bf16 v[64:79], a[236:239], v[204:207], v[64:79]
  buffer_load_dwordx4 v246, s[36:39], s59 offen offset:1024 nt lds
  v_exp_f32 v143, v143
  v_add_f32 v248, v248, v142
  v_mfma_f32_32x32x16_bf16 v[80:95], a[236:239], v[12:15], v[80:95]
  ds_read_b128 a[248:251], v240 offset:1088
  v_exp_f32 v152, v152
  v_add_f32 v248, v248, v143
  v_cvt_pk_bf16_f32 v139, v142, v143
  v_mfma_f32_32x32x16_bf16 v[96:111], a[236:239], v[44:47], v[96:111]
  v_exp_f32 v153, v153
  v_add_f32 v249, v249, v152
  v_exp_f32 v154, v154
  s_waitcnt lgkmcnt(2)
  v_mfma_f32_32x32x16_bf16 v[64:79], a[240:243], v[208:211], v[64:79]
  v_add_f32 v249, v249, v153
  v_cvt_pk_bf16_f32 v152, v152, v153
  v_exp_f32 v155, v155
  v_add_f32 v249, v249, v154
  v_mfma_f32_32x32x16_bf16 v[80:95], a[240:243], v[16:19], v[80:95]
  ds_read_b128 a[252:255], v240 offset:1120
  v_exp_f32 v156, v156
  v_add_f32 v249, v249, v155
  v_cvt_pk_bf16_f32 v153, v154, v155
  v_mfma_f32_32x32x16_bf16 v[96:111], a[240:243], v[48:51], v[96:111]
  v_exp_f32 v157, v157
  v_add_f32 v249, v249, v156
  v_exp_f32 v158, v158
  s_waitcnt lgkmcnt(2)
  v_mfma_f32_32x32x16_bf16 v[64:79], a[244:247], v[212:215], v[64:79]
  ds_read_b64_tr_b16 a[224:225], v241 offset:49408
  v_add_f32 v249, v249, v157
  v_cvt_pk_bf16_f32 v154, v156, v157
  v_exp_f32 v159, v159
  v_add_f32 v249, v249, v158
  v_mfma_f32_32x32x16_bf16 v[80:95], a[244:247], v[20:23], v[80:95]
  buffer_load_dwordx4 v245, s[40:43], s59 offen offset:2048 nt lds
  ds_read_b64_tr_b16 a[226:227], v241 offset:53504
  v_add_f32 v249, v249, v159
  v_cvt_pk_bf16_f32 v155, v158, v159
  v_mfma_f32_32x32x16_bf16 v[96:111], a[244:247], v[52:55], v[96:111]
  s_waitcnt lgkmcnt(3)
  v_mfma_f32_32x32x16_bf16 v[64:79], a[248:251], v[216:219], v[64:79]
  ds_read_b64_tr_b16 a[228:229], v242 offset:49408
  v_mfma_f32_32x32x16_bf16 v[80:95], a[248:251], v[24:27], v[80:95]
  ds_read_b64_tr_b16 a[230:231], v242 offset:53504
  v_mfma_f32_32x32x16_bf16 v[96:111], a[248:251], v[56:59], v[96:111]
  s_waitcnt lgkmcnt(4)
  v_mfma_f32_32x32x16_bf16 v[64:79], a[252:255], v[220:223], v[64:79]
  ds_read_b64_tr_b16 a[232:233], v241 offset:50432
  v_mfma_f32_32x32x16_bf16 v[80:95], a[252:255], v[28:31], v[80:95]
  ds_read_b64_tr_b16 a[234:235], v241 offset:54528
  v_mfma_f32_32x32x16_bf16 v[96:111], a[252:255], v[60:63], v[96:111]
  buffer_load_dwordx4 v246, s[40:43], s59 offen offset:3072 nt lds
  s_waitcnt lgkmcnt(4)
  v_mfma_f32_32x32x16_bf16 a[0:15], a[224:227], v[112:115], a[0:15]
  ds_read_b64_tr_b16 a[236:237], v242 offset:50432
  v_mfma_f32_32x32x16_bf16 a[16:31], a[224:227], v[128:131], a[16:31]
  ds_read_b64_tr_b16 a[238:239], v242 offset:54528
  s_nop 1
  v_exp_f32 v64, v64
  v_exp_f32 v65, v65
  v_add_f32 v247, v247, v64
  v_mfma_f32_32x32x16_bf16 a[32:47], a[224:227], v[144:147], a[32:47]
  v_exp_f32 v66, v66
  v_add_f32 v247, v247, v65
  v_cvt_pk_bf16_f32 v64, v64, v65
  s_waitcnt lgkmcnt(4)
  v_mfma_f32_32x32x16_bf16 a[48:63], a[228:231], v[112:115], a[48:63]
  ds_read_b64_tr_b16 a[240:241], v241 offset:57600
  v_exp_f32 v67, v67
  v_add_f32 v247, v247, v66
  v_exp_f32 v68, v68
  v_mfma_f32_32x32x16_bf16 a[64:79], a[228:231], v[128:131], a[64:79]
  ds_read_b64_tr_b16 a[242:243], v241 offset:61696
  v_add_f32 v247, v247, v67
  v_cvt_pk_bf16_f32 v65, v66, v67
  v_exp_f32 v69, v69
  v_add_f32 v247, v247, v68
  v_mfma_f32_32x32x16_bf16 a[80:95], a[228:231], v[144:147], a[80:95]
  s_add_u32 m0, s61, 98688
  s_mov_b32 s59, 65536
  v_exp_f32 v70, v70
  v_add_f32 v247, v247, v69
  s_waitcnt lgkmcnt(4)
  v_mfma_f32_32x32x16_bf16 a[96:111], a[232:235], v[112:115], a[96:111]
  buffer_load_dwordx4 v243, s[28:31], s59 offen offset:0 nt lds
  ds_read_b64_tr_b16 a[244:245], v242 offset:57600
  v_cvt_pk_bf16_f32 v66, v68, v69
  v_mfma_f32_32x32x16_bf16 a[112:127], a[232:235], v[128:131], a[112:127]
  ds_read_b64_tr_b16 a[246:247], v242 offset:61696
  v_exp_f32 v71, v71
  v_add_f32 v247, v247, v70
  v_exp_f32 v80, v80
  v_mfma_f32_32x32x16_bf16 a[128:143], a[232:235], v[144:147], a[128:143]
  v_add_f32 v247, v247, v71
  v_cvt_pk_bf16_f32 v67, v70, v71
  v_exp_f32 v81, v81
  v_add_f32 v248, v248, v80
  s_waitcnt lgkmcnt(4)
  v_mfma_f32_32x32x16_bf16 a[144:159], a[236:239], v[112:115], a[144:159]
  ds_read_b64_tr_b16 a[248:249], v241 offset:58624
  v_exp_f32 v82, v82
  v_add_f32 v248, v248, v81
  v_cvt_pk_bf16_f32 v80, v80, v81
  v_mfma_f32_32x32x16_bf16 a[160:175], a[236:239], v[128:131], a[160:175]
  ds_read_b64_tr_b16 a[250:251], v241 offset:62720
  v_exp_f32 v83, v83
  v_add_f32 v248, v248, v82
  v_exp_f32 v84, v84
  v_mfma_f32_32x32x16_bf16 a[176:191], a[236:239], v[144:147], a[176:191]
  v_add_f32 v248, v248, v83
  v_cvt_pk_bf16_f32 v81, v82, v83
  v_exp_f32 v85, v85
  v_add_f32 v248, v248, v84
  s_waitcnt lgkmcnt(4)
  v_mfma_f32_32x32x16_bf16 a[0:15], a[240:243], v[120:123], a[0:15]
  ds_read_b64_tr_b16 a[252:253], v242 offset:58624
  v_exp_f32 v86, v86
  v_add_f32 v248, v248, v85
  v_cvt_pk_bf16_f32 v82, v84, v85
  v_mfma_f32_32x32x16_bf16 a[16:31], a[240:243], v[136:139], a[16:31]
  buffer_load_dwordx4 v244, s[28:31], s59 offen offset:1024 nt lds
  ds_read_b64_tr_b16 a[254:255], v242 offset:62720
  v_exp_f32 v87, v87
  v_mfma_f32_32x32x16_bf16 a[32:47], a[240:243], v[152:155], a[32:47]
  v_subrev_u32 v240, 131584, v240
  v_add_f32 v248, v248, v86
  v_exp_f32 v96, v96
  v_add_f32 v248, v248, v87
  s_waitcnt lgkmcnt(4)
  v_mfma_f32_32x32x16_bf16 a[48:63], a[244:247], v[120:123], a[48:63]
  v_cvt_pk_bf16_f32 v83, v86, v87
  v_exp_f32 v97, v97
  v_add_f32 v249, v249, v96
  v_exp_f32 v98, v98
  v_mfma_f32_32x32x16_bf16 a[64:79], a[244:247], v[136:139], a[64:79]
  s_waitcnt lgkmcnt(0)
  s_waitcnt vmcnt(18)
  s_barrier
  v_add_f32 v249, v249, v97
  v_cvt_pk_bf16_f32 v96, v96, v97
  v_exp_f32 v99, v99
  v_mfma_f32_32x32x16_bf16 a[80:95], a[244:247], v[152:155], a[80:95]
  v_add_f32 v249, v249, v98
  v_exp_f32 v100, v100
  v_add_f32 v249, v249, v99
  v_cvt_pk_bf16_f32 v97, v98, v99
  v_mfma_f32_32x32x16_bf16 a[96:111], a[248:251], v[120:123], a[96:111]
  ds_read_b128 a[224:227], v240 offset:0
  v_exp_f32 v101, v101
  v_add_f32 v249, v249, v100
  v_exp_f32 v102, v102
  v_mfma_f32_32x32x16_bf16 a[112:127], a[248:251], v[136:139], a[112:127]
  v_add_f32 v249, v249, v101
  v_cvt_pk_bf16_f32 v98, v100, v101
  v_exp_f32 v103, v103
  v_add_f32 v249, v249, v102
  v_mfma_f32_32x32x16_bf16 a[128:143], a[248:251], v[152:155], a[128:143]
  buffer_load_dwordx4 v243, s[32:35], s59 offen offset:2048 nt lds
  ds_read_b128 a[228:231], v240 offset:32
  v_mfma_f32_32x32x16_bf16 a[144:159], a[252:255], v[120:123], a[144:159]
  v_exp_f32 v72, v72
  v_add_f32 v249, v249, v103
  v_cvt_pk_bf16_f32 v99, v102, v103
  v_exp_f32 v73, v73
  v_mfma_f32_32x32x16_bf16 a[160:175], a[252:255], v[136:139], a[160:175]
  ds_read_b128 a[232:235], v240 offset:64
  v_add_f32 v247, v247, v72
  v_exp_f32 v74, v74
  v_add_f32 v247, v247, v73
  v_cvt_pk_bf16_f32 v72, v72, v73
  v_mfma_f32_32x32x16_bf16 a[176:191], a[252:255], v[152:155], a[176:191]
  v_exp_f32 v75, v75
  v_add_f32 v247, v247, v74
  v_exp_f32 v76, v76
  s_waitcnt lgkmcnt(2)
  v_mfma_f32_32x32x16_bf16 v[112:127], a[224:227], v[192:195], v[224:239]
  v_add_f32 v247, v247, v75
  v_cvt_pk_bf16_f32 v73, v74, v75
  v_exp_f32 v77, v77
  v_add_f32 v247, v247, v76
  v_mfma_f32_32x32x16_bf16 v[128:143], a[224:227], v[0:3], v[160:175]
  ds_read_b128 a[236:239], v240 offset:96
  v_exp_f32 v78, v78
  v_add_f32 v247, v247, v77
  v_cvt_pk_bf16_f32 v74, v76, v77
  v_mfma_f32_32x32x16_bf16 v[144:159], a[224:227], v[32:35], v[176:191]
  v_exp_f32 v79, v79
  v_add_f32 v247, v247, v78
  v_exp_f32 v88, v88
  s_waitcnt lgkmcnt(2)
  v_mfma_f32_32x32x16_bf16 v[112:127], a[228:231], v[196:199], v[112:127]
  buffer_load_dwordx4 v244, s[32:35], s59 offen offset:3072 nt lds
  v_add_f32 v247, v247, v79
  v_cvt_pk_bf16_f32 v75, v78, v79
  v_mfma_f32_32x32x16_bf16 v[128:143], a[228:231], v[4:7], v[128:143]
  ds_read_b128 a[240:243], v240 offset:1024
  v_exp_f32 v89, v89
  v_add_f32 v248, v248, v88
  v_exp_f32 v90, v90
  v_mfma_f32_32x32x16_bf16 v[144:159], a[228:231], v[36:39], v[144:159]
  v_add_f32 v248, v248, v89
  v_cvt_pk_bf16_f32 v88, v88, v89
  v_exp_f32 v91, v91
  v_add_f32 v248, v248, v90
  s_waitcnt lgkmcnt(2)
  v_mfma_f32_32x32x16_bf16 v[112:127], a[232:235], v[200:203], v[112:127]
  v_exp_f32 v92, v92
  v_add_f32 v248, v248, v91
  v_cvt_pk_bf16_f32 v89, v90, v91
  v_exp_f32 v93, v93
  v_mfma_f32_32x32x16_bf16 v[128:143], a[232:235], v[8:11], v[128:143]
  ds_read_b128 a[244:247], v240 offset:1056
  v_add_f32 v248, v248, v92
  v_exp_f32 v94, v94
  v_add_f32 v248, v248, v93
  v_cvt_pk_bf16_f32 v90, v92, v93
  v_mfma_f32_32x32x16_bf16 v[144:159], a[232:235], v[40:43], v[144:159]
  v_exp_f32 v95, v95
  v_add_f32 v248, v248, v94
  v_exp_f32 v104, v104
  s_waitcnt lgkmcnt(2)
  v_mfma_f32_32x32x16_bf16 v[112:127], a[236:239], v[204:207], v[112:127]
  s_add_u32 m0, s62, 115200
  s_mov_b32 s59, 57344
  v_add_f32 v248, v248, v95
  v_cvt_pk_bf16_f32 v91, v94, v95
  v_exp_f32 v105, v105
  v_mfma_f32_32x32x16_bf16 v[128:143], a[236:239], v[12:15], v[128:143]
  buffer_load_dwordx4 v245, s[36:39], s59 offen offset:0 nt lds
  ds_read_b128 a[248:251], v240 offset:1088
  v_subrev_u32 v241, 65792, v241
  v_subrev_u32 v242, 65792, v242
  v_mfma_f32_32x32x16_bf16 v[144:159], a[236:239], v[44:47], v[144:159]
  v_add_f32 v249, v249, v104
  v_exp_f32 v106, v106
  v_add_f32 v249, v249, v105
  v_cvt_pk_bf16_f32 v104, v104, v105
  s_waitcnt lgkmcnt(2)
  v_mfma_f32_32x32x16_bf16 v[112:127], a[240:243], v[208:211], v[112:127]
  v_exp_f32 v107, v107
  v_add_f32 v249, v249, v106
  v_exp_f32 v108, v108
  v_add_f32 v249, v249, v107
  v_mfma_f32_32x32x16_bf16 v[128:143], a[240:243], v[16:19], v[128:143]
  ds_read_b128 a[252:255], v240 offset:1120
  v_cvt_pk_bf16_f32 v105, v106, v107
  v_exp_f32 v109, v109
  v_add_f32 v249, v249, v108
  v_mfma_f32_32x32x16_bf16 v[144:159], a[240:243], v[48:51], v[144:159]
  v_exp_f32 v110, v110
  v_add_f32 v249, v249, v109
  v_cvt_pk_bf16_f32 v106, v108, v109
  s_waitcnt lgkmcnt(2)
  v_mfma_f32_32x32x16_bf16 v[112:127], a[244:247], v[212:215], v[112:127]
  ds_read_b64_tr_b16 a[224:225], v241 offset:16512
  v_exp_f32 v111, v111
  v_add_f32 v249, v249, v110
  v_add_f32 v249, v249, v111
  v_cvt_pk_bf16_f32 v107, v110, v111
  v_mfma_f32_32x32x16_bf16 v[128:143], a[244:247], v[20:23], v[128:143]
  ds_read_b64_tr_b16 a[226:227], v241 offset:20608
  v_mfma_f32_32x32x16_bf16 v[144:159], a[244:247], v[52:55], v[144:159]
  buffer_load_dwordx4 v246, s[36:39], s59 offen offset:1024 nt lds
  s_waitcnt lgkmcnt(3)
  v_mfma_f32_32x32x16_bf16 v[112:127], a[248:251], v[216:219], v[112:127]
  ds_read_b64_tr_b16 a[228:229], v242 offset:16512
  v_mfma_f32_32x32x16_bf16 v[128:143], a[248:251], v[24:27], v[128:143]
  ds_read_b64_tr_b16 a[230:231], v242 offset:20608
  v_mfma_f32_32x32x16_bf16 v[144:159], a[248:251], v[56:59], v[144:159]
  s_waitcnt lgkmcnt(4)
  v_mfma_f32_32x32x16_bf16 v[112:127], a[252:255], v[220:223], v[112:127]
  ds_read_b64_tr_b16 a[232:233], v241 offset:17536
  v_mfma_f32_32x32x16_bf16 v[128:143], a[252:255], v[28:31], v[128:143]
  ds_read_b64_tr_b16 a[234:235], v241 offset:21632
  v_mfma_f32_32x32x16_bf16 v[144:159], a[252:255], v[60:63], v[144:159]
  s_waitcnt lgkmcnt(4)
  v_mfma_f32_32x32x16_bf16 a[0:15], a[224:227], v[64:67], a[0:15]
  buffer_load_dwordx4 v245, s[40:43], s59 offen offset:2048 nt lds
  ds_read_b64_tr_b16 a[236:237], v242 offset:17536
  v_mfma_f32_32x32x16_bf16 a[16:31], a[224:227], v[80:83], a[16:31]
  ds_read_b64_tr_b16 a[238:239], v242 offset:21632
  s_nop 1
  v_exp_f32 v112, v112
  v_exp_f32 v113, v113
  v_add_f32 v247, v247, v112
  v_mfma_f32_32x32x16_bf16 a[32:47], a[224:227], v[96:99], a[32:47]
  v_exp_f32 v114, v114
  v_add_f32 v247, v247, v113
  v_cvt_pk_bf16_f32 v112, v112, v113
  s_waitcnt lgkmcnt(4)
  v_mfma_f32_32x32x16_bf16 a[48:63], a[228:231], v[64:67], a[48:63]
  ds_read_b64_tr_b16 a[240:241], v241 offset:24704
  v_exp_f32 v115, v115
  v_add_f32 v247, v247, v114
  v_exp_f32 v116, v116
  v_mfma_f32_32x32x16_bf16 a[64:79], a[228:231], v[80:83], a[64:79]
  ds_read_b64_tr_b16 a[242:243], v241 offset:28800
  v_add_f32 v247, v247, v115
  v_cvt_pk_bf16_f32 v113, v114, v115
  v_exp_f32 v117, v117
  v_add_f32 v247, v247, v116
  v_mfma_f32_32x32x16_bf16 a[80:95], a[228:231], v[96:99], a[80:95]
  v_exp_f32 v118, v118
  v_add_f32 v247, v247, v117
  v_cvt_pk_bf16_f32 v114, v116, v117
  s_waitcnt lgkmcnt(4)
  v_mfma_f32_32x32x16_bf16 a[96:111], a[232:235], v[64:67], a[96:111]
  ds_read_b64_tr_b16 a[244:245], v242 offset:24704
  v_exp_f32 v119, v119
  v_add_f32 v247, v247, v118
  v_exp_f32 v128, v128
  v_mfma_f32_32x32x16_bf16 a[112:127], a[232:235], v[80:83], a[112:127]
  buffer_load_dwordx4 v246, s[40:43], s59 offen offset:3072 nt lds
  ds_read_b64_tr_b16 a[246:247], v242 offset:28800
  v_add_f32 v247, v247, v119
  v_cvt_pk_bf16_f32 v115, v118, v119
  v_mfma_f32_32x32x16_bf16 a[128:143], a[232:235], v[96:99], a[128:143]
  v_exp_f32 v129, v129
  v_add_f32 v248, v248, v128
  v_exp_f32 v130, v130
  s_waitcnt lgkmcnt(4)
  v_mfma_f32_32x32x16_bf16 a[144:159], a[236:239], v[64:67], a[144:159]
  ds_read_b64_tr_b16 a[248:249], v241 offset:25728
  v_add_f32 v248, v248, v129
  v_cvt_pk_bf16_f32 v128, v128, v129
  v_exp_f32 v131, v131
  v_add_f32 v248, v248, v130
  v_mfma_f32_32x32x16_bf16 a[160:175], a[236:239], v[80:83], a[160:175]
  ds_read_b64_tr_b16 a[250:251], v241 offset:29824
  v_exp_f32 v132, v132
  v_add_f32 v248, v248, v131
  v_cvt_pk_bf16_f32 v129, v130, v131
  v_mfma_f32_32x32x16_bf16 a[176:191], a[236:239], v[96:99], a[176:191]
  v_exp_f32 v133, v133
  v_add_f32 v248, v248, v132
  v_exp_f32 v134, v134
  s_waitcnt lgkmcnt(4)
  v_mfma_f32_32x32x16_bf16 a[0:15], a[240:243], v[72:75], a[0:15]
  ds_read_b64_tr_b16 a[252:253], v242 offset:25728
  v_add_f32 v248, v248, v133
  v_cvt_pk_bf16_f32 v130, v132, v133
  v_exp_f32 v135, v135
  v_add_f32 v248, v248, v134
  v_mfma_f32_32x32x16_bf16 a[16:31], a[240:243], v[88:91], a[16:31]
  ds_read_b64_tr_b16 a[254:255], v242 offset:29824
  s_add_u32 m0, s61, 131584
  s_mov_b32 s59, 73728
  v_exp_f32 v144, v144
  v_add_f32 v248, v248, v135
  v_mfma_f32_32x32x16_bf16 a[32:47], a[240:243], v[104:107], a[32:47]
  buffer_load_dwordx4 v243, s[28:31], s59 offen offset:0 nt lds
  v_cvt_pk_bf16_f32 v131, v134, v135
  s_waitcnt lgkmcnt(4)
  v_mfma_f32_32x32x16_bf16 a[48:63], a[244:247], v[72:75], a[48:63]
  v_exp_f32 v145, v145
  v_add_f32 v249, v249, v144
  v_exp_f32 v146, v146
  v_add_f32 v249, v249, v145
  v_mfma_f32_32x32x16_bf16 a[64:79], a[244:247], v[88:91], a[64:79]
  s_waitcnt lgkmcnt(0)
  s_waitcnt vmcnt(13)
  s_barrier
  v_cvt_pk_bf16_f32 v144, v144, v145
  v_exp_f32 v147, v147
  v_add_f32 v249, v249, v146
  v_mfma_f32_32x32x16_bf16 a[80:95], a[244:247], v[104:107], a[80:95]
  v_exp_f32 v148, v148
  v_add_f32 v249, v249, v147
  v_cvt_pk_bf16_f32 v145, v146, v147
  v_mfma_f32_32x32x16_bf16 a[96:111], a[248:251], v[72:75], a[96:111]
  ds_read_b128 a[224:227], v240 offset:32896
  v_exp_f32 v149, v149
  v_add_f32 v249, v249, v148
  v_exp_f32 v150, v150
  v_mfma_f32_32x32x16_bf16 a[112:127], a[248:251], v[88:91], a[112:127]
  v_add_f32 v249, v249, v149
  v_cvt_pk_bf16_f32 v146, v148, v149
  v_exp_f32 v151, v151
  v_add_f32 v249, v249, v150
  v_mfma_f32_32x32x16_bf16 a[128:143], a[248:251], v[104:107], a[128:143]
  ds_read_b128 a[228:231], v240 offset:32928
  v_exp_f32 v120, v120
  v_add_f32 v249, v249, v151
  v_cvt_pk_bf16_f32 v147, v150, v151
  v_mfma_f32_32x32x16_bf16 a[144:159], a[252:255], v[72:75], a[144:159]
  buffer_load_dwordx4 v244, s[28:31], s59 offen offset:1024 nt lds
  v_exp_f32 v121, v121
  v_add_f32 v247, v247, v120
  v_mfma_f32_32x32x16_bf16 a[160:175], a[252:255], v[88:91], a[160:175]
  ds_read_b128 a[232:235], v240 offset:32960
  v_exp_f32 v122, v122
  v_add_f32 v247, v247, v121
  v_cvt_pk_bf16_f32 v120, v120, v121
  v_mfma_f32_32x32x16_bf16 a[176:191], a[252:255], v[104:107], a[176:191]
  v_exp_f32 v123, v123
  v_add_f32 v247, v247, v122
  v_exp_f32 v124, v124
  s_waitcnt lgkmcnt(2)
  v_mfma_f32_32x32x16_bf16 v[64:79], a[224:227], v[192:195], v[224:239]
  v_add_f32 v247, v247, v123
  v_cvt_pk_bf16_f32 v121, v122, v123
  v_exp_f32 v125, v125
  v_add_f32 v247, v247, v124
  v_mfma_f32_32x32x16_bf16 v[80:95], a[224:227], v[0:3], v[160:175]
  ds_read_b128 a[236:239], v240 offset:32992
  v_exp_f32 v126, v126
  v_add_f32 v247, v247, v125
  v_cvt_pk_bf16_f32 v122, v124, v125
  v_mfma_f32_32x32x16_bf16 v[96:111], a[224:227], v[32:35], v[176:191]
  v_exp_f32 v127, v127
  v_add_f32 v247, v247, v126
  v_exp_f32 v136, v136
  s_waitcnt lgkmcnt(2)
  v_mfma_f32_32x32x16_bf16 v[64:79], a[228:231], v[196:199], v[64:79]
  v_add_f32 v247, v247, v127
  v_cvt_pk_bf16_f32 v123, v126, v127
  v_exp_f32 v137, v137
  v_add_f32 v248, v248, v136
  v_mfma_f32_32x32x16_bf16 v[80:95], a[228:231], v[4:7], v[80:95]
  buffer_load_dwordx4 v243, s[32:35], s59 offen offset:2048 nt lds
  ds_read_b128 a[240:243], v240 offset:33920
  v_exp_f32 v138, v138
  v_mfma_f32_32x32x16_bf16 v[96:111], a[228:231], v[36:39], v[96:111]
  v_add_f32 v248, v248, v137
  v_cvt_pk_bf16_f32 v136, v136, v137
  v_exp_f32 v139, v139
  v_add_f32 v248, v248, v138
  s_waitcnt lgkmcnt(2)
  v_mfma_f32_32x32x16_bf16 v[64:79], a[232:235], v[200:203], v[64:79]
  v_exp_f32 v140, v140
  v_add_f32 v248, v248, v139
  v_cvt_pk_bf16_f32 v137, v138, v139
  v_exp_f32 v141, v141
  v_mfma_f32_32x32x16_bf16 v[80:95], a[232:235], v[8:11], v[80:95]
  ds_read_b128 a[244:247], v240 offset:33952
  v_add_f32 v248, v248, v140
  v_exp_f32 v142, v142
  v_add_f32 v248, v248, v141
  v_cvt_pk_bf16_f32 v138, v140, v141
  v_mfma_f32_32x32x16_bf16 v[96:111], a[232:235], v[40:43], v[96:111]
  v_exp_f32 v143, v143
  v_add_f32 v248, v248, v142
  v_exp_f32 v152, v152
  s_waitcnt lgkmcnt(2)
  v_mfma_f32_32x32x16_bf16 v[64:79], a[236:239], v[204:207], v[64:79]
  v_add_f32 v248, v248, v143
  v_cvt_pk_bf16_f32 v139, v142, v143
  v_exp_f32 v153, v153
  v_add_f32 v249, v249, v152
  v_mfma_f32_32x32x16_bf16 v[80:95], a[236:239], v[12:15], v[80:95]
  ds_read_b128 a[248:251], v240 offset:33984
  v_exp_f32 v154, v154
  v_add_f32 v249, v249, v153
  v_cvt_pk_bf16_f32 v152, v152, v153
  v_mfma_f32_32x32x16_bf16 v[96:111], a[236:239], v[44:47], v[96:111]
  buffer_load_dwordx4 v244, s[32:35], s59 offen offset:3072 nt lds
  v_exp_f32 v155, v155
  s_waitcnt lgkmcnt(2)
  v_mfma_f32_32x32x16_bf16 v[64:79], a[240:243], v[208:211], v[64:79]
  v_add_f32 v249, v249, v154
  v_exp_f32 v156, v156
  v_add_f32 v249, v249, v155
  v_cvt_pk_bf16_f32 v153, v154, v155
  v_mfma_f32_32x32x16_bf16 v[80:95], a[240:243], v[16:19], v[80:95]
  ds_read_b128 a[252:255], v240 offset:34016
  v_exp_f32 v157, v157
  v_add_f32 v249, v249, v156
  v_exp_f32 v158, v158
  v_mfma_f32_32x32x16_bf16 v[96:111], a[240:243], v[48:51], v[96:111]
  v_add_f32 v249, v249, v157
  v_cvt_pk_bf16_f32 v154, v156, v157
  v_exp_f32 v159, v159
  v_add_f32 v249, v249, v158
  s_waitcnt lgkmcnt(2)
  v_mfma_f32_32x32x16_bf16 v[64:79], a[244:247], v[212:215], v[64:79]
  ds_read_b64_tr_b16 a[224:225], v241 offset:49408
  v_add_f32 v249, v249, v159
  v_cvt_pk_bf16_f32 v155, v158, v159
  v_mfma_f32_32x32x16_bf16 v[80:95], a[244:247], v[20:23], v[80:95]
  ds_read_b64_tr_b16 a[226:227], v241 offset:53504
  v_mfma_f32_32x32x16_bf16 v[96:111], a[244:247], v[52:55], v[96:111]
  s_add_u32 m0, s62, 16512
  s_mov_b32 s59, 65536
  s_waitcnt lgkmcnt(3)
  v_mfma_f32_32x32x16_bf16 v[64:79], a[248:251], v[216:219], v[64:79]
  buffer_load_dwordx4 v245, s[36:39], s59 offen offset:0 nt lds
  ds_read_b64_tr_b16 a[228:229], v242 offset:49408
  v_mfma_f32_32x32x16_bf16 v[80:95], a[248:251], v[24:27], v[80:95]
  ds_read_b64_tr_b16 a[230:231], v242 offset:53504
  v_mfma_f32_32x32x16_bf16 v[96:111], a[248:251], v[56:59], v[96:111]
  s_waitcnt lgkmcnt(4)
  v_mfma_f32_32x32x16_bf16 v[64:79], a[252:255], v[220:223], v[64:79]
  ds_read_b64_tr_b16 a[232:233], v241 offset:50432
  v_mfma_f32_32x32x16_bf16 v[80:95], a[252:255], v[28:31], v[80:95]
  ds_read_b64_tr_b16 a[234:235], v241 offset:54528
  v_mfma_f32_32x32x16_bf16 v[96:111], a[252:255], v[60:63], v[96:111]
  s_waitcnt lgkmcnt(4)
  v_mfma_f32_32x32x16_bf16 a[0:15], a[224:227], v[112:115], a[0:15]
  ds_read_b64_tr_b16 a[236:237], v242 offset:50432
  v_mfma_f32_32x32x16_bf16 a[16:31], a[224:227], v[128:131], a[16:31]
  buffer_load_dwordx4 v246, s[36:39], s59 offen offset:1024 nt lds
  ds_read_b64_tr_b16 a[238:239], v242 offset:54528
  s_nop 1
  v_exp_f32 v64, v64
  v_mfma_f32_32x32x16_bf16 a[32:47], a[224:227], v[144:147], a[32:47]
  v_exp_f32 v65, v65
  v_add_f32 v247, v247, v64
  v_exp_f32 v66, v66
  s_waitcnt lgkmcnt(4)
  v_mfma_f32_32x32x16_bf16 a[48:63], a[228:231], v[112:115], a[48:63]
  ds_read_b64_tr_b16 a[240:241], v241 offset:57600
  v_add_f32 v247, v247, v65
  v_cvt_pk_bf16_f32 v64, v64, v65
  v_exp_f32 v67, v67
  v_add_f32 v247, v247, v66
  v_mfma_f32_32x32x16_bf16 a[64:79], a[228:231], v[128:131], a[64:79]
  ds_read_b64_tr_b16 a[242:243], v241 offset:61696
  v_exp_f32 v68, v68
  v_add_f32 v247, v247, v67
  v_cvt_pk_bf16_f32 v65, v66, v67
  v_mfma_f32_32x32x16_bf16 a[80:95], a[228:231], v[144:147], a[80:95]
  v_exp_f32 v69, v69
  v_add_f32 v247, v247, v68
  v_exp_f32 v70, v70
  s_waitcnt lgkmcnt(4)
  v_mfma_f32_32x32x16_bf16 a[96:111], a[232:235], v[112:115], a[96:111]
  ds_read_b64_tr_b16 a[244:245], v242 offset:57600
  v_add_f32 v247, v247, v69
  v_cvt_pk_bf16_f32 v66, v68, v69
  v_exp_f32 v71, v71
  v_add_f32 v247, v247, v70
  v_mfma_f32_32x32x16_bf16 a[112:127], a[232:235], v[128:131], a[112:127]
  ds_read_b64_tr_b16 a[246:247], v242 offset:61696
  v_exp_f32 v80, v80
  v_add_f32 v247, v247, v71
  v_cvt_pk_bf16_f32 v67, v70, v71
  v_mfma_f32_32x32x16_bf16 a[128:143], a[232:235], v[144:147], a[128:143]
  buffer_load_dwordx4 v245, s[40:43], s59 offen offset:2048 nt lds
  v_exp_f32 v81, v81
  s_waitcnt lgkmcnt(4)
  v_mfma_f32_32x32x16_bf16 a[144:159], a[236:239], v[112:115], a[144:159]
  ds_read_b64_tr_b16 a[248:249], v241 offset:58624
  v_add_f32 v248, v248, v80
  v_exp_f32 v82, v82
  v_add_f32 v248, v248, v81
  v_cvt_pk_bf16_f32 v80, v80, v81
  v_mfma_f32_32x32x16_bf16 a[160:175], a[236:239], v[128:131], a[160:175]
  ds_read_b64_tr_b16 a[250:251], v241 offset:62720
  v_exp_f32 v83, v83
  v_add_f32 v248, v248, v82
  v_exp_f32 v84, v84
  v_mfma_f32_32x32x16_bf16 a[176:191], a[236:239], v[144:147], a[176:191]
  v_add_f32 v248, v248, v83
  v_cvt_pk_bf16_f32 v81, v82, v83
  v_exp_f32 v85, v85
  v_add_f32 v248, v248, v84
  s_waitcnt lgkmcnt(4)
  v_mfma_f32_32x32x16_bf16 a[0:15], a[240:243], v[120:123], a[0:15]
  ds_read_b64_tr_b16 a[252:253], v242 offset:58624
  v_exp_f32 v86, v86
  v_add_f32 v248, v248, v85
  v_cvt_pk_bf16_f32 v82, v84, v85
  v_mfma_f32_32x32x16_bf16 a[16:31], a[240:243], v[136:139], a[16:31]
  ds_read_b64_tr_b16 a[254:255], v242 offset:62720
  v_exp_f32 v87, v87
  v_add_f32 v248, v248, v86
  v_exp_f32 v96, v96
  v_mfma_f32_32x32x16_bf16 a[32:47], a[240:243], v[152:155], a[32:47]
  v_add_u32 v240, 65792, v240
  v_add_f32 v248, v248, v87
  v_cvt_pk_bf16_f32 v83, v86, v87
  v_exp_f32 v97, v97
  s_waitcnt lgkmcnt(4)
  v_mfma_f32_32x32x16_bf16 a[48:63], a[244:247], v[120:123], a[48:63]
  buffer_load_dwordx4 v246, s[40:43], s59 offen offset:3072 nt lds
  v_add_f32 v249, v249, v96
  v_exp_f32 v98, v98
  v_mfma_f32_32x32x16_bf16 a[64:79], a[244:247], v[136:139], a[64:79]
  s_waitcnt lgkmcnt(0)
  s_waitcnt vmcnt(16)
  s_barrier
  v_add_f32 v249, v249, v97
  v_cvt_pk_bf16_f32 v96, v96, v97
  v_exp_f32 v99, v99
  v_mfma_f32_32x32x16_bf16 a[80:95], a[244:247], v[152:155], a[80:95]
  v_add_f32 v249, v249, v98
  v_exp_f32 v100, v100
  v_add_f32 v249, v249, v99
  v_cvt_pk_bf16_f32 v97, v98, v99
  v_mfma_f32_32x32x16_bf16 a[96:111], a[248:251], v[120:123], a[96:111]
  ds_read_b128 a[224:227], v240 offset:0
  v_exp_f32 v101, v101
  v_add_f32 v249, v249, v100
  v_exp_f32 v102, v102
  v_mfma_f32_32x32x16_bf16 a[112:127], a[248:251], v[136:139], a[112:127]
  v_add_f32 v249, v249, v101
  v_cvt_pk_bf16_f32 v98, v100, v101
  v_exp_f32 v103, v103
  v_add_f32 v249, v249, v102
  v_mfma_f32_32x32x16_bf16 a[128:143], a[248:251], v[152:155], a[128:143]
  ds_read_b128 a[228:231], v240 offset:32
  v_exp_f32 v72, v72
  v_add_f32 v249, v249, v103
  v_cvt_pk_bf16_f32 v99, v102, v103
  v_mfma_f32_32x32x16_bf16 a[144:159], a[252:255], v[120:123], a[144:159]
  s_add_u32 m0, s62, 49408
  s_mov_b32 s59, 73728
  v_exp_f32 v73, v73
  v_add_f32 v247, v247, v72
  v_mfma_f32_32x32x16_bf16 a[160:175], a[252:255], v[136:139], a[160:175]
  buffer_load_dwordx4 v245, s[36:39], s59 offen offset:0 nt lds
  ds_read_b128 a[232:235], v240 offset:64
  v_exp_f32 v74, v74
  v_mfma_f32_32x32x16_bf16 a[176:191], a[252:255], v[152:155], a[176:191]
  v_add_f32 v247, v247, v73
  v_cvt_pk_bf16_f32 v72, v72, v73
  v_exp_f32 v75, v75
  v_add_f32 v247, v247, v74
  s_waitcnt lgkmcnt(2)
  v_mfma_f32_32x32x16_bf16 v[112:127], a[224:227], v[192:195], v[224:239]
  v_exp_f32 v76, v76
  v_add_f32 v247, v247, v75
  v_cvt_pk_bf16_f32 v73, v74, v75
  v_exp_f32 v77, v77
  v_mfma_f32_32x32x16_bf16 v[128:143], a[224:227], v[0:3], v[160:175]
  ds_read_b128 a[236:239], v240 offset:96
  v_add_f32 v247, v247, v76
  v_exp_f32 v78, v78
  v_add_f32 v247, v247, v77
  v_cvt_pk_bf16_f32 v74, v76, v77
  v_mfma_f32_32x32x16_bf16 v[144:159], a[224:227], v[32:35], v[176:191]
  v_exp_f32 v79, v79
  v_add_f32 v247, v247, v78
  v_exp_f32 v88, v88
  s_waitcnt lgkmcnt(2)
  v_mfma_f32_32x32x16_bf16 v[112:127], a[228:231], v[196:199], v[112:127]
  v_add_f32 v247, v247, v79
  v_cvt_pk_bf16_f32 v75, v78, v79
  v_exp_f32 v89, v89
  v_add_f32 v248, v248, v88
  v_mfma_f32_32x32x16_bf16 v[128:143], a[228:231], v[4:7], v[128:143]
  ds_read_b128 a[240:243], v240 offset:1024
  v_exp_f32 v90, v90
  v_add_f32 v248, v248, v89
  v_cvt_pk_bf16_f32 v88, v88, v89
  v_mfma_f32_32x32x16_bf16 v[144:159], a[228:231], v[36:39], v[144:159]
  buffer_load_dwordx4 v246, s[36:39], s59 offen offset:1024 nt lds
  v_exp_f32 v91, v91
  s_waitcnt lgkmcnt(2)
  v_mfma_f32_32x32x16_bf16 v[112:127], a[232:235], v[200:203], v[112:127]
  v_add_f32 v248, v248, v90
  v_exp_f32 v92, v92
  v_add_f32 v248, v248, v91
  v_cvt_pk_bf16_f32 v89, v90, v91
  v_mfma_f32_32x32x16_bf16 v[128:143], a[232:235], v[8:11], v[128:143]
  ds_read_b128 a[244:247], v240 offset:1056
  v_exp_f32 v93, v93
  v_add_f32 v248, v248, v92
  v_exp_f32 v94, v94
  v_mfma_f32_32x32x16_bf16 v[144:159], a[232:235], v[40:43], v[144:159]
  v_add_f32 v248, v248, v93
  v_cvt_pk_bf16_f32 v90, v92, v93
  v_exp_f32 v95, v95
  v_add_f32 v248, v248, v94
  s_waitcnt lgkmcnt(2)
  v_mfma_f32_32x32x16_bf16 v[112:127], a[236:239], v[204:207], v[112:127]
  v_exp_f32 v104, v104
  v_add_f32 v248, v248, v95
  v_cvt_pk_bf16_f32 v91, v94, v95
  v_exp_f32 v105, v105
  v_mfma_f32_32x32x16_bf16 v[128:143], a[236:239], v[12:15], v[128:143]
  ds_read_b128 a[248:251], v240 offset:1088
  v_add_u32 v241, 65792, v241
  v_add_u32 v242, 65792, v242
  v_add_f32 v249, v249, v104
  v_exp_f32 v106, v106
  v_mfma_f32_32x32x16_bf16 v[144:159], a[236:239], v[44:47], v[144:159]
  v_add_f32 v249, v249, v105
  v_cvt_pk_bf16_f32 v104, v104, v105
  v_exp_f32 v107, v107
  v_add_f32 v249, v249, v106
  s_waitcnt lgkmcnt(2)
  v_mfma_f32_32x32x16_bf16 v[112:127], a[240:243], v[208:211], v[112:127]
  buffer_load_dwordx4 v245, s[40:43], s59 offen offset:2048 nt lds
  v_exp_f32 v108, v108
  v_add_f32 v249, v249, v107
  v_mfma_f32_32x32x16_bf16 v[128:143], a[240:243], v[16:19], v[128:143]
  ds_read_b128 a[252:255], v240 offset:1120
  v_cvt_pk_bf16_f32 v105, v106, v107
  v_exp_f32 v109, v109
  v_add_f32 v249, v249, v108
  v_mfma_f32_32x32x16_bf16 v[144:159], a[240:243], v[48:51], v[144:159]
  v_exp_f32 v110, v110
  v_add_f32 v249, v249, v109
  v_cvt_pk_bf16_f32 v106, v108, v109
  s_waitcnt lgkmcnt(2)
  v_mfma_f32_32x32x16_bf16 v[112:127], a[244:247], v[212:215], v[112:127]
  ds_read_b64_tr_b16 a[224:225], v241 offset:16512
  v_exp_f32 v111, v111
  v_add_f32 v249, v249, v110
  v_add_f32 v249, v249, v111
  v_cvt_pk_bf16_f32 v107, v110, v111
  v_mfma_f32_32x32x16_bf16 v[128:143], a[244:247], v[20:23], v[128:143]
  ds_read_b64_tr_b16 a[226:227], v241 offset:20608
  v_mfma_f32_32x32x16_bf16 v[144:159], a[244:247], v[52:55], v[144:159]
  s_waitcnt lgkmcnt(3)
  v_mfma_f32_32x32x16_bf16 v[112:127], a[248:251], v[216:219], v[112:127]
  ds_read_b64_tr_b16 a[228:229], v242 offset:16512
  v_mfma_f32_32x32x16_bf16 v[128:143], a[248:251], v[24:27], v[128:143]
  buffer_load_dwordx4 v246, s[40:43], s59 offen offset:3072 nt lds
  ds_read_b64_tr_b16 a[230:231], v242 offset:20608
  v_mfma_f32_32x32x16_bf16 v[144:159], a[248:251], v[56:59], v[144:159]
  s_waitcnt lgkmcnt(4)
  v_mfma_f32_32x32x16_bf16 v[112:127], a[252:255], v[220:223], v[112:127]
  ds_read_b64_tr_b16 a[232:233], v241 offset:17536
  v_mfma_f32_32x32x16_bf16 v[128:143], a[252:255], v[28:31], v[128:143]
  ds_read_b64_tr_b16 a[234:235], v241 offset:21632
  v_mfma_f32_32x32x16_bf16 v[144:159], a[252:255], v[60:63], v[144:159]
  s_waitcnt lgkmcnt(4)
  v_mfma_f32_32x32x16_bf16 a[0:15], a[224:227], v[64:67], a[0:15]
  ds_read_b64_tr_b16 a[236:237], v242 offset:17536
  v_mfma_f32_32x32x16_bf16 a[16:31], a[224:227], v[80:83], a[16:31]
  ds_read_b64_tr_b16 a[238:239], v242 offset:21632
  s_add_u32 m0, s61, 0
  s_mov_b32 s59, 81920
  s_nop 0
  v_exp_f32 v112, v112
  v_mfma_f32_32x32x16_bf16 a[32:47], a[224:227], v[96:99], a[32:47]
  buffer_load_dwordx4 v243, s[28:31], s59 offen offset:0 nt lds
  v_exp_f32 v113, v113
  s_waitcnt lgkmcnt(4)
  v_mfma_f32_32x32x16_bf16 a[48:63], a[228:231], v[64:67], a[48:63]
  ds_read_b64_tr_b16 a[240:241], v241 offset:24704
  v_add_f32 v247, v247, v112
  v_exp_f32 v114, v114
  v_add_f32 v247, v247, v113
  v_cvt_pk_bf16_f32 v112, v112, v113
  v_mfma_f32_32x32x16_bf16 a[64:79], a[228:231], v[80:83], a[64:79]
  ds_read_b64_tr_b16 a[242:243], v241 offset:28800
  v_exp_f32 v115, v115
  v_add_f32 v247, v247, v114
  v_exp_f32 v116, v116
  v_mfma_f32_32x32x16_bf16 a[80:95], a[228:231], v[96:99], a[80:95]
  v_add_f32 v247, v247, v115
  v_cvt_pk_bf16_f32 v113, v114, v115
  v_exp_f32 v117, v117
  v_add_f32 v247, v247, v116
  s_waitcnt lgkmcnt(4)
  v_mfma_f32_32x32x16_bf16 a[96:111], a[232:235], v[64:67], a[96:111]
  ds_read_b64_tr_b16 a[244:245], v242 offset:24704
  v_exp_f32 v118, v118
  v_add_f32 v247, v247, v117
  v_cvt_pk_bf16_f32 v114, v116, v117
  v_mfma_f32_32x32x16_bf16 a[112:127], a[232:235], v[80:83], a[112:127]
  ds_read_b64_tr_b16 a[246:247], v242 offset:28800
  v_exp_f32 v119, v119
  v_add_f32 v247, v247, v118
  v_exp_f32 v128, v128
  v_mfma_f32_32x32x16_bf16 a[128:143], a[232:235], v[96:99], a[128:143]
  v_add_f32 v247, v247, v119
  v_cvt_pk_bf16_f32 v115, v118, v119
  v_exp_f32 v129, v129
  v_add_f32 v248, v248, v128
  s_waitcnt lgkmcnt(4)
  v_mfma_f32_32x32x16_bf16 a[144:159], a[236:239], v[64:67], a[144:159]
  buffer_load_dwordx4 v244, s[28:31], s59 offen offset:1024 nt lds
  ds_read_b64_tr_b16 a[248:249], v241 offset:25728
  v_exp_f32 v130, v130
  v_mfma_f32_32x32x16_bf16 a[160:175], a[236:239], v[80:83], a[160:175]
  ds_read_b64_tr_b16 a[250:251], v241 offset:29824
  v_add_f32 v248, v248, v129
  v_cvt_pk_bf16_f32 v128, v128, v129
  v_exp_f32 v131, v131
  v_add_f32 v248, v248, v130
  v_mfma_f32_32x32x16_bf16 a[176:191], a[236:239], v[96:99], a[176:191]
  v_exp_f32 v132, v132
  v_add_f32 v248, v248, v131
  v_cvt_pk_bf16_f32 v129, v130, v131
  s_waitcnt lgkmcnt(4)
  v_mfma_f32_32x32x16_bf16 a[0:15], a[240:243], v[72:75], a[0:15]
  ds_read_b64_tr_b16 a[252:253], v242 offset:25728
  v_exp_f32 v133, v133
  v_add_f32 v248, v248, v132
  v_exp_f32 v134, v134
  v_mfma_f32_32x32x16_bf16 a[16:31], a[240:243], v[88:91], a[16:31]
  ds_read_b64_tr_b16 a[254:255], v242 offset:29824
  v_add_f32 v248, v248, v133
  v_cvt_pk_bf16_f32 v130, v132, v133
  v_exp_f32 v135, v135
  v_add_f32 v248, v248, v134
  v_mfma_f32_32x32x16_bf16 a[32:47], a[240:243], v[104:107], a[32:47]
  v_exp_f32 v144, v144
  v_add_f32 v248, v248, v135
  v_cvt_pk_bf16_f32 v131, v134, v135
  s_waitcnt lgkmcnt(4)
  v_mfma_f32_32x32x16_bf16 a[48:63], a[244:247], v[72:75], a[48:63]
  v_exp_f32 v145, v145
  v_add_f32 v249, v249, v144
  v_exp_f32 v146, v146
  v_add_f32 v249, v249, v145
  v_mfma_f32_32x32x16_bf16 a[64:79], a[244:247], v[88:91], a[64:79]
  s_waitcnt lgkmcnt(0)
  s_waitcnt vmcnt(14)
  s_barrier
  v_cvt_pk_bf16_f32 v144, v144, v145
  v_exp_f32 v147, v147
  v_add_f32 v249, v249, v146
  v_mfma_f32_32x32x16_bf16 a[80:95], a[244:247], v[104:107], a[80:95]
  buffer_load_dwordx4 v243, s[32:35], s59 offen offset:2048 nt lds
  v_exp_f32 v148, v148
  v_mfma_f32_32x32x16_bf16 a[96:111], a[248:251], v[72:75], a[96:111]
  ds_read_b128 a[224:227], v240 offset:32896
  v_add_f32 v249, v249, v147
  v_cvt_pk_bf16_f32 v145, v146, v147
  v_exp_f32 v149, v149
  v_add_f32 v249, v249, v148
  v_mfma_f32_32x32x16_bf16 a[112:127], a[248:251], v[88:91], a[112:127]
  v_exp_f32 v150, v150
  v_add_f32 v249, v249, v149
  v_cvt_pk_bf16_f32 v146, v148, v149
  v_exp_f32 v151, v151
  v_mfma_f32_32x32x16_bf16 a[128:143], a[248:251], v[104:107], a[128:143]
  ds_read_b128 a[228:231], v240 offset:32928
  v_add_f32 v249, v249, v150
  v_exp_f32 v120, v120
  v_add_f32 v249, v249, v151
  v_mfma_f32_32x32x16_bf16 a[144:159], a[252:255], v[72:75], a[144:159]
  v_cvt_pk_bf16_f32 v147, v150, v151
  v_exp_f32 v121, v121
  v_add_f32 v247, v247, v120
  v_exp_f32 v122, v122
  v_mfma_f32_32x32x16_bf16 a[160:175], a[252:255], v[88:91], a[160:175]
  ds_read_b128 a[232:235], v240 offset:32960
  v_add_f32 v247, v247, v121
  v_cvt_pk_bf16_f32 v120, v120, v121
  v_exp_f32 v123, v123
  v_add_f32 v247, v247, v122
  v_mfma_f32_32x32x16_bf16 a[176:191], a[252:255], v[104:107], a[176:191]
  v_exp_f32 v124, v124
  v_add_f32 v247, v247, v123
  v_cvt_pk_bf16_f32 v121, v122, v123
  s_waitcnt lgkmcnt(2)
  v_mfma_f32_32x32x16_bf16 v[64:79], a[224:227], v[192:195], v[224:239]
  buffer_load_dwordx4 v244, s[32:35], s59 offen offset:3072 nt lds
  v_exp_f32 v125, v125
  v_add_f32 v247, v247, v124
  v_mfma_f32_32x32x16_bf16 v[80:95], a[224:227], v[0:3], v[160:175]
  ds_read_b128 a[236:239], v240 offset:32992
  v_exp_f32 v126, v126
  v_add_f32 v247, v247, v125
  v_cvt_pk_bf16_f32 v122, v124, v125
  v_mfma_f32_32x32x16_bf16 v[96:111], a[224:227], v[32:35], v[176:191]
  v_exp_f32 v127, v127
  v_add_f32 v247, v247, v126
  v_exp_f32 v136, v136
  s_waitcnt lgkmcnt(2)
  v_mfma_f32_32x32x16_bf16 v[64:79], a[228:231], v[196:199], v[64:79]
  v_add_f32 v247, v247, v127
  v_cvt_pk_bf16_f32 v123, v126, v127
  v_exp_f32 v137, v137
  v_add_f32 v248, v248, v136
  v_mfma_f32_32x32x16_bf16 v[80:95], a[228:231], v[4:7], v[80:95]
  ds_read_b128 a[240:243], v240 offset:33920
  v_exp_f32 v138, v138
  v_add_f32 v248, v248, v137
  v_cvt_pk_bf16_f32 v136, v136, v137
  v_mfma_f32_32x32x16_bf16 v[96:111], a[228:231], v[36:39], v[96:111]
  v_exp_f32 v139, v139
  v_add_f32 v248, v248, v138
  v_exp_f32 v140, v140
  s_waitcnt lgkmcnt(2)
  v_mfma_f32_32x32x16_bf16 v[64:79], a[232:235], v[200:203], v[64:79]
  s_add_u32 m0, s62, 82304
  s_mov_b32 s59, 81920
  v_add_f32 v248, v248, v139
  v_cvt_pk_bf16_f32 v137, v138, v139
  v_exp_f32 v141, v141
  v_mfma_f32_32x32x16_bf16 v[80:95], a[232:235], v[8:11], v[80:95]
  buffer_load_dwordx4 v245, s[36:39], s59 offen offset:0 nt lds
  ds_read_b128 a[244:247], v240 offset:33952
  v_add_f32 v248, v248, v140
  v_mfma_f32_32x32x16_bf16 v[96:111], a[232:235], v[40:43], v[96:111]
  v_exp_f32 v142, v142
  v_add_f32 v248, v248, v141
  v_cvt_pk_bf16_f32 v138, v140, v141
  s_waitcnt lgkmcnt(2)
  v_mfma_f32_32x32x16_bf16 v[64:79], a[236:239], v[204:207], v[64:79]
  v_exp_f32 v143, v143
  v_add_f32 v248, v248, v142
  v_exp_f32 v152, v152
  v_add_f32 v248, v248, v143
  v_mfma_f32_32x32x16_bf16 v[80:95], a[236:239], v[12:15], v[80:95]
  ds_read_b128 a[248:251], v240 offset:33984
  v_cvt_pk_bf16_f32 v139, v142, v143
  v_exp_f32 v153, v153
  v_add_f32 v249, v249, v152
  v_mfma_f32_32x32x16_bf16 v[96:111], a[236:239], v[44:47], v[96:111]
  v_exp_f32 v154, v154
  v_add_f32 v249, v249, v153
  v_cvt_pk_bf16_f32 v152, v152, v153
  s_waitcnt lgkmcnt(2)
  v_mfma_f32_32x32x16_bf16 v[64:79], a[240:243], v[208:211], v[64:79]
  v_exp_f32 v155, v155
  v_add_f32 v249, v249, v154
  v_exp_f32 v156, v156
  v_add_f32 v249, v249, v155
  v_mfma_f32_32x32x16_bf16 v[80:95], a[240:243], v[16:19], v[80:95]
  ds_read_b128 a[252:255], v240 offset:34016
  v_cvt_pk_bf16_f32 v153, v154, v155
  v_exp_f32 v157, v157
  v_add_f32 v249, v249, v156
  v_mfma_f32_32x32x16_bf16 v[96:111], a[240:243], v[48:51], v[96:111]
  buffer_load_dwordx4 v246, s[36:39], s59 offen offset:1024 nt lds
  v_exp_f32 v158, v158
  s_waitcnt lgkmcnt(2)
  v_mfma_f32_32x32x16_bf16 v[64:79], a[244:247], v[212:215], v[64:79]
  ds_read_b64_tr_b16 a[224:225], v241 offset:49408
  v_add_f32 v249, v249, v157
  v_cvt_pk_bf16_f32 v154, v156, v157
  v_exp_f32 v159, v159
  v_add_f32 v249, v249, v158
  v_mfma_f32_32x32x16_bf16 v[80:95], a[244:247], v[20:23], v[80:95]
  ds_read_b64_tr_b16 a[226:227], v241 offset:53504
  v_add_f32 v249, v249, v159
  v_cvt_pk_bf16_f32 v155, v158, v159
  v_mfma_f32_32x32x16_bf16 v[96:111], a[244:247], v[52:55], v[96:111]
  s_waitcnt lgkmcnt(3)
  v_mfma_f32_32x32x16_bf16 v[64:79], a[248:251], v[216:219], v[64:79]
  ds_read_b64_tr_b16 a[228:229], v242 offset:49408
  v_mfma_f32_32x32x16_bf16 v[80:95], a[248:251], v[24:27], v[80:95]
  ds_read_b64_tr_b16 a[230:231], v242 offset:53504
  v_mfma_f32_32x32x16_bf16 v[96:111], a[248:251], v[56:59], v[96:111]
  s_waitcnt lgkmcnt(4)
  v_mfma_f32_32x32x16_bf16 v[64:79], a[252:255], v[220:223], v[64:79]
  buffer_load_dwordx4 v245, s[40:43], s59 offen offset:2048 nt lds
  ds_read_b64_tr_b16 a[232:233], v241 offset:50432
  v_mfma_f32_32x32x16_bf16 v[80:95], a[252:255], v[28:31], v[80:95]
  ds_read_b64_tr_b16 a[234:235], v241 offset:54528
  v_mfma_f32_32x32x16_bf16 v[96:111], a[252:255], v[60:63], v[96:111]
  s_waitcnt lgkmcnt(4)
  v_mfma_f32_32x32x16_bf16 a[0:15], a[224:227], v[112:115], a[0:15]
  ds_read_b64_tr_b16 a[236:237], v242 offset:50432
  v_mfma_f32_32x32x16_bf16 a[16:31], a[224:227], v[128:131], a[16:31]
  ds_read_b64_tr_b16 a[238:239], v242 offset:54528
  s_nop 1
  v_exp_f32 v64, v64
  v_exp_f32 v65, v65
  v_add_f32 v247, v247, v64
  v_mfma_f32_32x32x16_bf16 a[32:47], a[224:227], v[144:147], a[32:47]
  v_exp_f32 v66, v66
  v_add_f32 v247, v247, v65
  v_cvt_pk_bf16_f32 v64, v64, v65
  s_waitcnt lgkmcnt(4)
  v_mfma_f32_32x32x16_bf16 a[48:63], a[228:231], v[112:115], a[48:63]
  ds_read_b64_tr_b16 a[240:241], v241 offset:57600
  v_exp_f32 v67, v67
  v_add_f32 v247, v247, v66
  v_exp_f32 v68, v68
  v_mfma_f32_32x32x16_bf16 a[64:79], a[228:231], v[128:131], a[64:79]
  buffer_load_dwordx4 v246, s[40:43], s59 offen offset:3072 nt lds
  ds_read_b64_tr_b16 a[242:243], v241 offset:61696
  v_add_f32 v247, v247, v67
  v_cvt_pk_bf16_f32 v65, v66, v67
  v_mfma_f32_32x32x16_bf16 a[80:95], a[228:231], v[144:147], a[80:95]
  v_exp_f32 v69, v69
  v_add_f32 v247, v247, v68
  v_exp_f32 v70, v70
  s_waitcnt lgkmcnt(4)
  v_mfma_f32_32x32x16_bf16 a[96:111], a[232:235], v[112:115], a[96:111]
  ds_read_b64_tr_b16 a[244:245], v242 offset:57600
  v_add_f32 v247, v247, v69
  v_cvt_pk_bf16_f32 v66, v68, v69
  v_exp_f32 v71, v71
  v_add_f32 v247, v247, v70
  v_mfma_f32_32x32x16_bf16 a[112:127], a[232:235], v[128:131], a[112:127]
  ds_read_b64_tr_b16 a[246:247], v242 offset:61696
  v_exp_f32 v80, v80
  v_add_f32 v247, v247, v71
  v_cvt_pk_bf16_f32 v67, v70, v71
  v_mfma_f32_32x32x16_bf16 a[128:143], a[232:235], v[144:147], a[128:143]
  v_exp_f32 v81, v81
  v_add_f32 v248, v248, v80
  v_exp_f32 v82, v82
  s_waitcnt lgkmcnt(4)
  v_mfma_f32_32x32x16_bf16 a[144:159], a[236:239], v[112:115], a[144:159]
  ds_read_b64_tr_b16 a[248:249], v241 offset:58624
  v_add_f32 v248, v248, v81
  v_cvt_pk_bf16_f32 v80, v80, v81
  v_exp_f32 v83, v83
  v_add_f32 v248, v248, v82
  v_mfma_f32_32x32x16_bf16 a[160:175], a[236:239], v[128:131], a[160:175]
  ds_read_b64_tr_b16 a[250:251], v241 offset:62720
  s_add_u32 m0, s61, 32896
  s_mov_b32 s59, 90112
  v_exp_f32 v84, v84
  v_add_f32 v248, v248, v83
  v_mfma_f32_32x32x16_bf16 a[176:191], a[236:239], v[144:147], a[176:191]
  buffer_load_dwordx4 v243, s[28:31], s59 offen offset:0 nt lds
  v_cvt_pk_bf16_f32 v81, v82, v83
  s_waitcnt lgkmcnt(4)
  v_mfma_f32_32x32x16_bf16 a[0:15], a[240:243], v[120:123], a[0:15]
  ds_read_b64_tr_b16 a[252:253], v242 offset:58624
  v_exp_f32 v85, v85
  v_add_f32 v248, v248, v84
  v_exp_f32 v86, v86
  v_mfma_f32_32x32x16_bf16 a[16:31], a[240:243], v[136:139], a[16:31]
  ds_read_b64_tr_b16 a[254:255], v242 offset:62720
  v_add_f32 v248, v248, v85
  v_cvt_pk_bf16_f32 v82, v84, v85
  v_exp_f32 v87, v87
  v_add_f32 v248, v248, v86
  v_mfma_f32_32x32x16_bf16 a[32:47], a[240:243], v[152:155], a[32:47]
  v_add_u32 v240, 65792, v240
  v_exp_f32 v96, v96
  v_add_f32 v248, v248, v87
  v_cvt_pk_bf16_f32 v83, v86, v87
  s_waitcnt lgkmcnt(4)
  v_mfma_f32_32x32x16_bf16 a[48:63], a[244:247], v[120:123], a[48:63]
  v_exp_f32 v97, v97
  v_add_f32 v249, v249, v96
  v_exp_f32 v98, v98
  v_add_f32 v249, v249, v97
  v_mfma_f32_32x32x16_bf16 a[64:79], a[244:247], v[136:139], a[64:79]
  s_waitcnt lgkmcnt(0)
  s_waitcnt vmcnt(13)
  s_barrier
  v_cvt_pk_bf16_f32 v96, v96, v97
  v_exp_f32 v99, v99
  v_add_f32 v249, v249, v98
  v_mfma_f32_32x32x16_bf16 a[80:95], a[244:247], v[152:155], a[80:95]
  v_exp_f32 v100, v100
  v_add_f32 v249, v249, v99
  v_cvt_pk_bf16_f32 v97, v98, v99
  v_mfma_f32_32x32x16_bf16 a[96:111], a[248:251], v[120:123], a[96:111]
  buffer_load_dwordx4 v244, s[28:31], s59 offen offset:1024 nt lds
  ds_read_b128 a[224:227], v240 offset:0
  v_exp_f32 v101, v101
  v_mfma_f32_32x32x16_bf16 a[112:127], a[248:251], v[136:139], a[112:127]
  v_add_f32 v249, v249, v100
  v_exp_f32 v102, v102
  v_add_f32 v249, v249, v101
  v_cvt_pk_bf16_f32 v98, v100, v101
  v_mfma_f32_32x32x16_bf16 a[128:143], a[248:251], v[152:155], a[128:143]
  ds_read_b128 a[228:231], v240 offset:32
  v_exp_f32 v103, v103
  v_add_f32 v249, v249, v102
  v_mfma_f32_32x32x16_bf16 a[144:159], a[252:255], v[120:123], a[144:159]
  v_exp_f32 v72, v72
  v_add_f32 v249, v249, v103
  v_cvt_pk_bf16_f32 v99, v102, v103
  v_exp_f32 v73, v73
  v_mfma_f32_32x32x16_bf16 a[160:175], a[252:255], v[136:139], a[160:175]
  ds_read_b128 a[232:235], v240 offset:64
  v_add_f32 v247, v247, v72
  v_exp_f32 v74, v74
  v_add_f32 v247, v247, v73
  v_cvt_pk_bf16_f32 v72, v72, v73
  v_mfma_f32_32x32x16_bf16 a[176:191], a[252:255], v[152:155], a[176:191]
  v_exp_f32 v75, v75
  v_add_f32 v247, v247, v74
  v_exp_f32 v76, v76
  s_waitcnt lgkmcnt(2)
  v_mfma_f32_32x32x16_bf16 v[112:127], a[224:227], v[192:195], v[224:239]
  v_add_f32 v247, v247, v75
  v_cvt_pk_bf16_f32 v73, v74, v75
  v_exp_f32 v77, v77
  v_add_f32 v247, v247, v76
  v_mfma_f32_32x32x16_bf16 v[128:143], a[224:227], v[0:3], v[160:175]
  buffer_load_dwordx4 v243, s[32:35], s59 offen offset:2048 nt lds
  ds_read_b128 a[236:239], v240 offset:96
  v_exp_f32 v78, v78
  v_mfma_f32_32x32x16_bf16 v[144:159], a[224:227], v[32:35], v[176:191]
  v_add_f32 v247, v247, v77
  v_cvt_pk_bf16_f32 v74, v76, v77
  v_exp_f32 v79, v79
  v_add_f32 v247, v247, v78
  s_waitcnt lgkmcnt(2)
  v_mfma_f32_32x32x16_bf16 v[112:127], a[228:231], v[196:199], v[112:127]
  v_exp_f32 v88, v88
  v_add_f32 v247, v247, v79
  v_cvt_pk_bf16_f32 v75, v78, v79
  v_exp_f32 v89, v89
  v_mfma_f32_32x32x16_bf16 v[128:143], a[228:231], v[4:7], v[128:143]
  ds_read_b128 a[240:243], v240 offset:1024
  v_add_f32 v248, v248, v88
  v_exp_f32 v90, v90
  v_add_f32 v248, v248, v89
  v_cvt_pk_bf16_f32 v88, v88, v89
  v_mfma_f32_32x32x16_bf16 v[144:159], a[228:231], v[36:39], v[144:159]
  v_exp_f32 v91, v91
  v_add_f32 v248, v248, v90
  v_exp_f32 v92, v92
  s_waitcnt lgkmcnt(2)
  v_mfma_f32_32x32x16_bf16 v[112:127], a[232:235], v[200:203], v[112:127]
  v_accvgpr_read_b32 v250, a208
  v_add_f32 v248, v248, v91
  v_cvt_pk_bf16_f32 v89, v90, v91
  v_exp_f32 v93, v93
  v_add_f32 v248, v248, v92
  v_mfma_f32_32x32x16_bf16 v[128:143], a[232:235], v[8:11], v[128:143]
  ds_read_b128 a[244:247], v240 offset:1056
  v_exp_f32 v94, v94
  v_add_f32 v248, v248, v93
  v_cvt_pk_bf16_f32 v90, v92, v93
  v_mfma_f32_32x32x16_bf16 v[144:159], a[232:235], v[40:43], v[144:159]
  buffer_load_dwordx4 v244, s[32:35], s59 offen offset:3072 nt lds
  v_readfirstlane_b32 s13, v250
  s_waitcnt lgkmcnt(2)
  v_mfma_f32_32x32x16_bf16 v[112:127], a[236:239], v[204:207], v[112:127]
  v_exp_f32 v95, v95
  v_add_f32 v248, v248, v94
  v_exp_f32 v104, v104
  v_add_f32 v248, v248, v95
  v_mfma_f32_32x32x16_bf16 v[128:143], a[236:239], v[12:15], v[128:143]
  ds_read_b128 a[248:251], v240 offset:1088
  v_subrev_u32 v241, 65792, v241
  v_subrev_u32 v242, 65792, v242
  s_cmp_eq_u32 s13, 0
  s_cselect_b32 s13, s12, s13
  v_cvt_pk_bf16_f32 v91, v94, v95
  v_mfma_f32_32x32x16_bf16 v[144:159], a[236:239], v[44:47], v[144:159]
  v_exp_f32 v105, v105
  v_add_f32 v249, v249, v104
  v_exp_f32 v106, v106
  s_waitcnt lgkmcnt(2)
  v_mfma_f32_32x32x16_bf16 v[112:127], a[240:243], v[208:211], v[112:127]
  v_add_f32 v249, v249, v105
  v_cvt_pk_bf16_f32 v104, v104, v105
  v_exp_f32 v107, v107
  v_add_f32 v249, v249, v106
  v_mfma_f32_32x32x16_bf16 v[128:143], a[240:243], v[16:19], v[128:143]
  ds_read_b128 a[252:255], v240 offset:1120
  v_exp_f32 v108, v108
  v_add_f32 v249, v249, v107
  v_cvt_pk_bf16_f32 v105, v106, v107
  v_mfma_f32_32x32x16_bf16 v[144:159], a[240:243], v[48:51], v[144:159]
  s_add_u32 m0, s62, 115200
  s_mov_b32 s59, 90112
  v_exp_f32 v109, v109
  v_add_f32 v249, v249, v108
  s_waitcnt lgkmcnt(2)
  v_mfma_f32_32x32x16_bf16 v[112:127], a[244:247], v[212:215], v[112:127]
  buffer_load_dwordx4 v245, s[36:39], s59 offen offset:0 nt lds
  ds_read_b64_tr_b16 a[224:225], v241 offset:16512
  v_exp_f32 v110, v110
  v_mfma_f32_32x32x16_bf16 v[128:143], a[244:247], v[20:23], v[128:143]
  ds_read_b64_tr_b16 a[226:227], v241 offset:20608
  v_add_f32 v249, v249, v109
  v_cvt_pk_bf16_f32 v106, v108, v109
  v_exp_f32 v111, v111
  v_add_f32 v249, v249, v110
  v_mfma_f32_32x32x16_bf16 v[144:159], a[244:247], v[52:55], v[144:159]
  v_add_f32 v249, v249, v111
  v_cvt_pk_bf16_f32 v107, v110, v111
  s_waitcnt lgkmcnt(3)
  v_mfma_f32_32x32x16_bf16 v[112:127], a[248:251], v[216:219], v[112:127]
  ds_read_b64_tr_b16 a[228:229], v242 offset:16512
  v_mfma_f32_32x32x16_bf16 v[128:143], a[248:251], v[24:27], v[128:143]
  ds_read_b64_tr_b16 a[230:231], v242 offset:20608
  v_mfma_f32_32x32x16_bf16 v[144:159], a[248:251], v[56:59], v[144:159]
  s_waitcnt lgkmcnt(4)
  v_mfma_f32_32x32x16_bf16 v[112:127], a[252:255], v[220:223], v[112:127]
  ds_read_b64_tr_b16 a[232:233], v241 offset:17536
  v_mfma_f32_32x32x16_bf16 v[128:143], a[252:255], v[28:31], v[128:143]
  buffer_load_dwordx4 v246, s[36:39], s59 offen offset:1024 nt lds
  ds_read_b64_tr_b16 a[234:235], v241 offset:21632
  v_mfma_f32_32x32x16_bf16 v[144:159], a[252:255], v[60:63], v[144:159]
  s_waitcnt lgkmcnt(4)
  v_mfma_f32_32x32x16_bf16 a[0:15], a[224:227], v[64:67], a[0:15]
  ds_read_b64_tr_b16 a[236:237], v242 offset:17536
  v_mfma_f32_32x32x16_bf16 a[16:31], a[224:227], v[80:83], a[16:31]
  ds_read_b64_tr_b16 a[238:239], v242 offset:21632
  s_nop 1
  v_exp_f32 v112, v112
  v_exp_f32 v113, v113
  v_add_f32 v247, v247, v112
  v_mfma_f32_32x32x16_bf16 a[32:47], a[224:227], v[96:99], a[32:47]
  v_exp_f32 v114, v114
  v_add_f32 v247, v247, v113
  v_cvt_pk_bf16_f32 v112, v112, v113
  s_waitcnt lgkmcnt(4)
  v_mfma_f32_32x32x16_bf16 a[48:63], a[228:231], v[64:67], a[48:63]
  ds_read_b64_tr_b16 a[240:241], v241 offset:24704
  v_exp_f32 v115, v115
  v_add_f32 v247, v247, v114
  v_exp_f32 v116, v116
  v_mfma_f32_32x32x16_bf16 a[64:79], a[228:231], v[80:83], a[64:79]
  ds_read_b64_tr_b16 a[242:243], v241 offset:28800
  v_add_f32 v247, v247, v115
  v_cvt_pk_bf16_f32 v113, v114, v115
  v_exp_f32 v117, v117
  v_add_f32 v247, v247, v116
  v_mfma_f32_32x32x16_bf16 a[80:95], a[228:231], v[96:99], a[80:95]
  buffer_load_dwordx4 v245, s[40:43], s59 offen offset:2048 nt lds
  v_exp_f32 v118, v118
  s_waitcnt lgkmcnt(4)
  v_mfma_f32_32x32x16_bf16 a[96:111], a[232:235], v[64:67], a[96:111]
  ds_read_b64_tr_b16 a[244:245], v242 offset:24704
  v_add_f32 v247, v247, v117
  v_cvt_pk_bf16_f32 v114, v116, v117
  v_exp_f32 v119, v119
  v_add_f32 v247, v247, v118
  v_mfma_f32_32x32x16_bf16 a[112:127], a[232:235], v[80:83], a[112:127]
  ds_read_b64_tr_b16 a[246:247], v242 offset:28800
  v_exp_f32 v128, v128
  v_add_f32 v247, v247, v119
  v_cvt_pk_bf16_f32 v115, v118, v119
  v_mfma_f32_32x32x16_bf16 a[128:143], a[232:235], v[96:99], a[128:143]
  v_exp_f32 v129, v129
  v_add_f32 v248, v248, v128
  v_exp_f32 v130, v130
  s_waitcnt lgkmcnt(4)
  v_mfma_f32_32x32x16_bf16 a[144:159], a[236:239], v[64:67], a[144:159]
  ds_read_b64_tr_b16 a[248:249], v241 offset:25728
  v_add_f32 v248, v248, v129
  v_cvt_pk_bf16_f32 v128, v128, v129
  v_exp_f32 v131, v131
  v_add_f32 v248, v248, v130
  v_mfma_f32_32x32x16_bf16 a[160:175], a[236:239], v[80:83], a[160:175]
  ds_read_b64_tr_b16 a[250:251], v241 offset:29824
  v_exp_f32 v132, v132
  v_add_f32 v248, v248, v131
  v_cvt_pk_bf16_f32 v129, v130, v131
  v_mfma_f32_32x32x16_bf16 a[176:191], a[236:239], v[96:99], a[176:191]
  v_exp_f32 v133, v133
  v_add_f32 v248, v248, v132
  v_exp_f32 v134, v134
  s_waitcnt lgkmcnt(4)
  v_mfma_f32_32x32x16_bf16 a[0:15], a[240:243], v[72:75], a[0:15]
  buffer_load_dwordx4 v246, s[40:43], s59 offen offset:3072 nt lds
  ds_read_b64_tr_b16 a[252:253], v242 offset:25728
  v_add_f32 v248, v248, v133
  v_cvt_pk_bf16_f32 v130, v132, v133
  v_mfma_f32_32x32x16_bf16 a[16:31], a[240:243], v[88:91], a[16:31]
  ds_read_b64_tr_b16 a[254:255], v242 offset:29824
  v_exp_f32 v135, v135
  v_add_f32 v248, v248, v134
  v_exp_f32 v144, v144
  v_mfma_f32_32x32x16_bf16 a[32:47], a[240:243], v[104:107], a[32:47]
  v_subrev_u32 v240, 131584, v240
  v_add_f32 v248, v248, v135
  v_cvt_pk_bf16_f32 v131, v134, v135
  v_exp_f32 v145, v145
  s_waitcnt lgkmcnt(4)
  v_mfma_f32_32x32x16_bf16 a[48:63], a[244:247], v[72:75], a[48:63]
  v_add_f32 v249, v249, v144
  v_exp_f32 v146, v146
  v_add_f32 v249, v249, v145
  v_cvt_pk_bf16_f32 v144, v144, v145
  v_mfma_f32_32x32x16_bf16 a[64:79], a[244:247], v[88:91], a[64:79]
  s_waitcnt lgkmcnt(0)
  s_waitcnt vmcnt(12)
  s_barrier
  v_exp_f32 v147, v147
  v_add_f32 v249, v249, v146
  v_mfma_f32_32x32x16_bf16 a[80:95], a[244:247], v[104:107], a[80:95]
  v_exp_f32 v148, v148
  v_add_f32 v249, v249, v147
  v_cvt_pk_bf16_f32 v145, v146, v147
  v_mfma_f32_32x32x16_bf16 a[96:111], a[248:251], v[72:75], a[96:111]
  ds_read_b128 a[224:227], v240 offset:0
  s_add_u32 m0, s61, 65792
  s_mov_b32 s59, 98304
  v_exp_f32 v149, v149
  v_add_f32 v249, v249, v148
  v_mfma_f32_32x32x16_bf16 a[112:127], a[248:251], v[88:91], a[112:127]
  buffer_load_dwordx4 v243, s[28:31], s59 offen offset:0 nt lds
  v_exp_f32 v150, v150
  v_add_f32 v249, v249, v149
  v_mfma_f32_32x32x16_bf16 a[128:143], a[248:251], v[104:107], a[128:143]
  ds_read_b128 a[228:231], v240 offset:32
  v_cvt_pk_bf16_f32 v146, v148, v149
  v_exp_f32 v151, v151
  v_add_f32 v249, v249, v150
  v_mfma_f32_32x32x16_bf16 a[144:159], a[252:255], v[72:75], a[144:159]
  v_exp_f32 v120, v120
  v_add_f32 v249, v249, v151
  v_cvt_pk_bf16_f32 v147, v150, v151
  v_exp_f32 v121, v121
  v_mfma_f32_32x32x16_bf16 a[160:175], a[252:255], v[88:91], a[160:175]
  ds_read_b128 a[232:235], v240 offset:64
  v_add_f32 v247, v247, v120
  v_exp_f32 v122, v122
  v_add_f32 v247, v247, v121
  v_cvt_pk_bf16_f32 v120, v120, v121
  v_mfma_f32_32x32x16_bf16 a[176:191], a[252:255], v[104:107], a[176:191]
  v_exp_f32 v123, v123
  v_add_f32 v247, v247, v122
  v_exp_f32 v124, v124
  s_waitcnt lgkmcnt(2)
  v_mfma_f32_32x32x16_bf16 v[64:79], a[224:227], v[192:195], v[224:239]
  v_add_f32 v247, v247, v123
  v_cvt_pk_bf16_f32 v121, v122, v123
  v_exp_f32 v125, v125
  v_add_f32 v247, v247, v124
  v_mfma_f32_32x32x16_bf16 v[80:95], a[224:227], v[0:3], v[160:175]
  ds_read_b128 a[236:239], v240 offset:96
  v_exp_f32 v126, v126
  v_add_f32 v247, v247, v125
  v_cvt_pk_bf16_f32 v122, v124, v125
  v_mfma_f32_32x32x16_bf16 v[96:111], a[224:227], v[32:35], v[176:191]
  buffer_load_dwordx4 v244, s[28:31], s59 offen offset:1024 nt lds
  v_mbcnt_lo_u32_b32 v252, -1, 0
  s_waitcnt lgkmcnt(2)
  v_mfma_f32_32x32x16_bf16 v[64:79], a[228:231], v[196:199], v[64:79]
  v_mbcnt_hi_u32_b32 v252, -1, v252
  v_exp_f32 v127, v127
  v_add_f32 v247, v247, v126
  v_exp_f32 v136, v136
  v_mfma_f32_32x32x16_bf16 v[80:95], a[228:231], v[4:7], v[80:95]
  ds_read_b128 a[240:243], v240 offset:1024
  s_and_b32 s71, s49, 3
  v_add_f32 v247, v247, v127
  v_cvt_pk_bf16_f32 v123, v126, v127
  v_exp_f32 v137, v137
  v_mfma_f32_32x32x16_bf16 v[96:111], a[228:231], v[36:39], v[96:111]
  s_andn2_b32 s70, s49, 3
  v_add_f32 v248, v248, v136
  v_exp_f32 v138, v138
  v_add_f32 v248, v248, v137
  s_waitcnt lgkmcnt(2)
  v_mfma_f32_32x32x16_bf16 v[64:79], a[232:235], v[200:203], v[64:79]
  s_lshl_b32 s67, s71, 8
  v_cvt_pk_bf16_f32 v136, v136, v137
  v_exp_f32 v139, v139
  v_add_f32 v248, v248, v138
  v_mfma_f32_32x32x16_bf16 v[80:95], a[232:235], v[8:11], v[80:95]
  ds_read_b128 a[244:247], v240 offset:1056
  s_lshl_b32 s68, s3, 13
  v_exp_f32 v140, v140
  v_add_f32 v248, v248, v139
  v_cvt_pk_bf16_f32 v137, v138, v139
  v_mfma_f32_32x32x16_bf16 v[96:111], a[232:235], v[40:43], v[96:111]
  s_add_u32 s69, s68, 129024
  v_exp_f32 v141, v141
  v_add_f32 v248, v248, v140
  s_waitcnt lgkmcnt(2)
  v_mfma_f32_32x32x16_bf16 v[64:79], a[236:239], v[204:207], v[64:79]
  buffer_load_dwordx4 v243, s[32:35], s59 offen offset:2048 nt lds
  v_lshrrev_b32 v253, 3, v252
  v_exp_f32 v142, v142
  v_mfma_f32_32x32x16_bf16 v[80:95], a[236:239], v[12:15], v[80:95]
  ds_read_b128 a[248:251], v240 offset:1088
  v_and_b32 v254, 7, v252
  v_add_f32 v248, v248, v141
  v_cvt_pk_bf16_f32 v138, v140, v141
  v_exp_f32 v143, v143
  v_mfma_f32_32x32x16_bf16 v[96:111], a[236:239], v[44:47], v[96:111]
  v_bfe_u32 v251, v252, 4, 1
  v_add_f32 v248, v248, v142
  v_exp_f32 v152, v152
  v_add_f32 v248, v248, v143
  s_waitcnt lgkmcnt(2)
  v_mfma_f32_32x32x16_bf16 v[64:79], a[240:243], v[208:211], v[64:79]
  v_lshlrev_b32 v251, 2, v251
  v_cvt_pk_bf16_f32 v139, v142, v143
  v_exp_f32 v153, v153
  v_add_f32 v249, v249, v152
  v_mfma_f32_32x32x16_bf16 v[80:95], a[240:243], v[16:19], v[80:95]
  ds_read_b128 a[252:255], v240 offset:1120
  v_xor_b32 v254, v254, v251
  v_exp_f32 v154, v154
  v_add_f32 v249, v249, v153
  v_cvt_pk_bf16_f32 v152, v152, v153
  v_mfma_f32_32x32x16_bf16 v[96:111], a[240:243], v[48:51], v[96:111]
  v_lshlrev_b32 v254, 4, v254
  v_exp_f32 v155, v155
  v_add_f32 v249, v249, v154
  s_waitcnt lgkmcnt(2)
  v_mfma_f32_32x32x16_bf16 v[64:79], a[244:247], v[212:215], v[64:79]
  ds_read_b64_tr_b16 a[224:225], v241 offset:49408
  v_lshl_add_u32 v254, v253, 10, v254
  v_exp_f32 v156, v156
  v_add_f32 v249, v249, v155
  v_cvt_pk_bf16_f32 v153, v154, v155
  v_mfma_f32_32x32x16_bf16 v[80:95], a[244:247], v[20:23], v[80:95]
  buffer_load_dwordx4 v244, s[32:35], s59 offen offset:3072 nt lds
  ds_read_b64_tr_b16 a[226:227], v241 offset:53504
  v_add_u32 v250, s68, v254
  v_mfma_f32_32x32x16_bf16 v[96:111], a[244:247], v[52:55], v[96:111]
  v_add_u32 v251, s69, v254
  v_exp_f32 v157, v157
  v_add_f32 v249, v249, v156
  s_waitcnt lgkmcnt(3)
  v_mfma_f32_32x32x16_bf16 v[64:79], a[248:251], v[216:219], v[64:79]
  ds_read_b64_tr_b16 a[228:229], v242 offset:49408
  s_add_u32 s69, s71, 0
  v_exp_f32 v158, v158
  v_add_f32 v249, v249, v157
  v_cvt_pk_bf16_f32 v154, v156, v157
  v_mfma_f32_32x32x16_bf16 v[80:95], a[248:251], v[24:27], v[80:95]
  ds_read_b64_tr_b16 a[230:231], v242 offset:53504
  s_and_b32 s69, s69, 3
  v_exp_f32 v159, v159
  v_add_f32 v249, v249, v158
  v_add_f32 v249, v249, v159
  v_mfma_f32_32x32x16_bf16 v[96:111], a[248:251], v[56:59], v[96:111]
  s_add_u32 s69, s69, s70
  v_cvt_pk_bf16_f32 v155, v158, v159
  s_waitcnt lgkmcnt(4)
  v_mfma_f32_32x32x16_bf16 v[64:79], a[252:255], v[220:223], v[64:79]
  ds_read_b64_tr_b16 a[232:233], v241 offset:50432
  s_lshl_b32 s50, s69, 18
  v_mfma_f32_32x32x16_bf16 v[80:95], a[252:255], v[28:31], v[80:95]
  ds_read_b64_tr_b16 a[234:235], v241 offset:54528
  s_add_u32 m0, s62, 16512
  s_mov_b32 s59, 98304
  s_add_u32 s50, s50, s67
  v_mfma_f32_32x32x16_bf16 v[96:111], a[252:255], v[60:63], v[96:111]
  buffer_load_dwordx4 v245, s[36:39], s59 offen offset:0 nt lds
  s_add_u32 s69, s71, 1
  s_waitcnt lgkmcnt(4)
  v_mfma_f32_32x32x16_bf16 a[0:15], a[224:227], v[112:115], a[0:15]
  ds_read_b64_tr_b16 a[236:237], v242 offset:50432
  s_and_b32 s69, s69, 3
  v_mfma_f32_32x32x16_bf16 a[16:31], a[224:227], v[128:131], a[16:31]
  ds_read_b64_tr_b16 a[238:239], v242 offset:54528
  s_add_u32 s69, s69, s70
  v_exp_f32 v64, v64
  v_exp_f32 v65, v65
  v_mfma_f32_32x32x16_bf16 a[32:47], a[224:227], v[144:147], a[32:47]
  s_lshl_b32 s56, s69, 18
  v_add_f32 v247, v247, v64
  v_exp_f32 v66, v66
  v_add_f32 v247, v247, v65
  s_waitcnt lgkmcnt(4)
  v_mfma_f32_32x32x16_bf16 a[48:63], a[228:231], v[112:115], a[48:63]
  ds_read_b64_tr_b16 a[240:241], v241 offset:57600
  s_add_u32 s56, s56, s67
  v_cvt_pk_bf16_f32 v64, v64, v65
  v_exp_f32 v67, v67
  v_add_f32 v247, v247, v66
  v_mfma_f32_32x32x16_bf16 a[64:79], a[228:231], v[128:131], a[64:79]
  ds_read_b64_tr_b16 a[242:243], v241 offset:61696
  s_add_u32 s69, s71, 2
  v_exp_f32 v68, v68
  v_add_f32 v247, v247, v67
  v_cvt_pk_bf16_f32 v65, v66, v67
  v_mfma_f32_32x32x16_bf16 a[80:95], a[228:231], v[144:147], a[80:95]
  s_and_b32 s69, s69, 3
  v_exp_f32 v69, v69
  v_add_f32 v247, v247, v68
  s_waitcnt lgkmcnt(4)
  v_mfma_f32_32x32x16_bf16 a[96:111], a[232:235], v[112:115], a[96:111]
  buffer_load_dwordx4 v246, s[36:39], s59 offen offset:1024 nt lds
  ds_read_b64_tr_b16 a[244:245], v242 offset:57600
  s_add_u32 s69, s69, s70
  v_mfma_f32_32x32x16_bf16 a[112:127], a[232:235], v[128:131], a[112:127]
  ds_read_b64_tr_b16 a[246:247], v242 offset:61696
  s_lshl_b32 s57, s69, 18
  v_exp_f32 v70, v70
  v_add_f32 v247, v247, v69
  v_cvt_pk_bf16_f32 v66, v68, v69
  v_mfma_f32_32x32x16_bf16 a[128:143], a[232:235], v[144:147], a[128:143]
  s_add_u32 s57, s57, s67
  v_exp_f32 v71, v71
  v_add_f32 v247, v247, v70
  s_waitcnt lgkmcnt(4)
  v_mfma_f32_32x32x16_bf16 a[144:159], a[236:239], v[112:115], a[144:159]
  ds_read_b64_tr_b16 a[248:249], v241 offset:58624
  s_add_u32 s69, s71, 3
  v_exp_f32 v80, v80
  v_add_f32 v247, v247, v71
  v_cvt_pk_bf16_f32 v67, v70, v71
  v_mfma_f32_32x32x16_bf16 a[160:175], a[236:239], v[128:131], a[160:175]
  ds_read_b64_tr_b16 a[250:251], v241 offset:62720
  s_and_b32 s69, s69, 3
  v_exp_f32 v81, v81
  v_add_f32 v248, v248, v80
  v_mfma_f32_32x32x16_bf16 a[176:191], a[236:239], v[144:147], a[176:191]
  s_add_u32 s69, s69, s70
  v_exp_f32 v82, v82
  v_add_f32 v248, v248, v81
  v_cvt_pk_bf16_f32 v80, v80, v81
  s_waitcnt lgkmcnt(4)
  v_mfma_f32_32x32x16_bf16 a[0:15], a[240:243], v[120:123], a[0:15]
  ds_read_b64_tr_b16 a[252:253], v242 offset:58624
  s_lshl_b32 s58, s69, 18
  v_exp_f32 v83, v83
  v_add_f32 v248, v248, v82
  v_mfma_f32_32x32x16_bf16 a[16:31], a[240:243], v[136:139], a[16:31]
  buffer_load_dwordx4 v245, s[40:43], s59 offen offset:2048 nt lds
  ds_read_b64_tr_b16 a[254:255], v242 offset:62720
  s_add_u32 s58, s58, s67
  v_mfma_f32_32x32x16_bf16 a[32:47], a[240:243], v[152:155], a[32:47]
  v_exp_f32 v84, v84
  v_add_f32 v248, v248, v83
  v_cvt_pk_bf16_f32 v81, v82, v83
  s_waitcnt lgkmcnt(4)
  v_mfma_f32_32x32x16_bf16 a[48:63], a[244:247], v[120:123], a[48:63]
  v_exp_f32 v85, v85
  v_add_f32 v248, v248, v84
  v_exp_f32 v86, v86
  v_add_f32 v248, v248, v85
  v_mfma_f32_32x32x16_bf16 a[64:79], a[244:247], v[136:139], a[64:79]
  s_waitcnt lgkmcnt(0)
  s_waitcnt vmcnt(11)
  s_barrier
  v_cvt_pk_bf16_f32 v82, v84, v85
  v_exp_f32 v87, v87
  v_add_f32 v248, v248, v86
  v_mfma_f32_32x32x16_bf16 a[80:95], a[244:247], v[152:155], a[80:95]
  v_exp_f32 v96, v96
  v_add_f32 v248, v248, v87
  v_cvt_pk_bf16_f32 v83, v86, v87
  v_mfma_f32_32x32x16_bf16 a[96:111], a[248:251], v[120:123], a[96:111]
  ds_read_b128 a[224:227], v240 offset:32896
  v_exp_f32 v97, v97
  v_add_f32 v249, v249, v96
  v_exp_f32 v98, v98
  v_mfma_f32_32x32x16_bf16 a[112:127], a[248:251], v[136:139], a[112:127]
  v_add_f32 v249, v249, v97
  v_cvt_pk_bf16_f32 v96, v96, v97
  v_exp_f32 v99, v99
  v_add_f32 v249, v249, v98
  v_mfma_f32_32x32x16_bf16 a[128:143], a[248:251], v[152:155], a[128:143]
  buffer_load_dwordx4 v246, s[40:43], s59 offen offset:3072 nt lds
  ds_read_b128 a[228:231], v240 offset:32928
  v_mfma_f32_32x32x16_bf16 a[144:159], a[252:255], v[120:123], a[144:159]
  v_exp_f32 v100, v100
  v_add_f32 v249, v249, v99
  v_cvt_pk_bf16_f32 v97, v98, v99
  v_exp_f32 v101, v101
  v_mfma_f32_32x32x16_bf16 a[160:175], a[252:255], v[136:139], a[160:175]
  ds_read_b128 a[232:235], v240 offset:32960
  v_add_f32 v249, v249, v100
  v_exp_f32 v102, v102
  v_add_f32 v249, v249, v101
  v_cvt_pk_bf16_f32 v98, v100, v101
  v_mfma_f32_32x32x16_bf16 a[176:191], a[252:255], v[152:155], a[176:191]
  v_exp_f32 v103, v103
  v_add_f32 v249, v249, v102
  v_exp_f32 v72, v72
  s_waitcnt lgkmcnt(2)
  v_mfma_f32_32x32x16_bf16 v[112:127], a[224:227], v[192:195], v[224:239]
  v_add_f32 v249, v249, v103
  v_cvt_pk_bf16_f32 v99, v102, v103
  v_exp_f32 v73, v73
  v_add_f32 v247, v247, v72
  v_mfma_f32_32x32x16_bf16 v[128:143], a[224:227], v[0:3], v[160:175]
  ds_read_b128 a[236:239], v240 offset:32992
  v_exp_f32 v74, v74
  v_add_f32 v247, v247, v73
  v_cvt_pk_bf16_f32 v72, v72, v73
  v_mfma_f32_32x32x16_bf16 v[144:159], a[224:227], v[32:35], v[176:191]
  s_add_u32 m0, s61, 98688
  s_mov_b32 s59, 106496
  v_exp_f32 v75, v75
  v_add_f32 v247, v247, v74
  s_waitcnt lgkmcnt(2)
  v_mfma_f32_32x32x16_bf16 v[112:127], a[228:231], v[196:199], v[112:127]
  buffer_load_dwordx4 v243, s[28:31], s59 offen offset:0 nt lds
  v_exp_f32 v76, v76
  v_add_f32 v247, v247, v75
  v_mfma_f32_32x32x16_bf16 v[128:143], a[228:231], v[4:7], v[128:143]
  ds_read_b128 a[240:243], v240 offset:33920
  v_cvt_pk_bf16_f32 v73, v74, v75
  v_exp_f32 v77, v77
  v_add_f32 v247, v247, v76
  v_mfma_f32_32x32x16_bf16 v[144:159], a[228:231], v[36:39], v[144:159]
  v_exp_f32 v78, v78
  v_add_f32 v247, v247, v77
  v_cvt_pk_bf16_f32 v74, v76, v77
  s_waitcnt lgkmcnt(2)
  v_mfma_f32_32x32x16_bf16 v[112:127], a[232:235], v[200:203], v[112:127]
  v_exp_f32 v79, v79
  v_add_f32 v247, v247, v78
  v_exp_f32 v88, v88
  v_add_f32 v247, v247, v79
  v_mfma_f32_32x32x16_bf16 v[128:143], a[232:235], v[8:11], v[128:143]
  ds_read_b128 a[244:247], v240 offset:33952
  v_cvt_pk_bf16_f32 v75, v78, v79
  v_exp_f32 v89, v89
  v_add_f32 v248, v248, v88
  v_mfma_f32_32x32x16_bf16 v[144:159], a[232:235], v[40:43], v[144:159]
  v_exp_f32 v90, v90
  v_add_f32 v248, v248, v89
  v_cvt_pk_bf16_f32 v88, v88, v89
  s_waitcnt lgkmcnt(2)
  v_mfma_f32_32x32x16_bf16 v[112:127], a[236:239], v[204:207], v[112:127]
  v_exp_f32 v91, v91
  v_add_f32 v248, v248, v90
  v_exp_f32 v92, v92
  v_add_f32 v248, v248, v91
  v_mfma_f32_32x32x16_bf16 v[128:143], a[236:239], v[12:15], v[128:143]
  buffer_load_dwordx4 v244, s[28:31], s59 offen offset:1024 nt lds
  ds_read_b128 a[248:251], v240 offset:33984
  v_add_u32 v241, 65792, v241
  v_add_u32 v242, 65792, v242
  v_mfma_f32_32x32x16_bf16 v[144:159], a[236:239], v[44:47], v[144:159]
  v_cvt_pk_bf16_f32 v89, v90, v91
  v_exp_f32 v93, v93
  v_add_f32 v248, v248, v92
  s_waitcnt lgkmcnt(2)
  v_mfma_f32_32x32x16_bf16 v[112:127], a[240:243], v[208:211], v[112:127]
  v_exp_f32 v94, v94
  v_add_f32 v248, v248, v93
  v_cvt_pk_bf16_f32 v90, v92, v93
  v_exp_f32 v95, v95
  v_mfma_f32_32x32x16_bf16 v[128:143], a[240:243], v[16:19], v[128:143]
  ds_read_b128 a[252:255], v240 offset:34016
  v_add_f32 v248, v248, v94
  v_exp_f32 v104, v104
  v_add_f32 v248, v248, v95
  v_cvt_pk_bf16_f32 v91, v94, v95
  v_mfma_f32_32x32x16_bf16 v[144:159], a[240:243], v[48:51], v[144:159]
  v_exp_f32 v105, v105
  v_add_f32 v249, v249, v104
  v_exp_f32 v106, v106
  s_waitcnt lgkmcnt(2)
  v_mfma_f32_32x32x16_bf16 v[112:127], a[244:247], v[212:215], v[112:127]
  ds_read_b64_tr_b16 a[224:225], v241 offset:16512
  v_add_f32 v249, v249, v105
  v_cvt_pk_bf16_f32 v104, v104, v105
  v_exp_f32 v107, v107
  v_add_f32 v249, v249, v106
  v_mfma_f32_32x32x16_bf16 v[128:143], a[244:247], v[20:23], v[128:143]
  ds_read_b64_tr_b16 a[226:227], v241 offset:20608
  v_exp_f32 v108, v108
  v_add_f32 v249, v249, v107
  v_cvt_pk_bf16_f32 v105, v106, v107
  v_mfma_f32_32x32x16_bf16 v[144:159], a[244:247], v[52:55], v[144:159]
  buffer_load_dwordx4 v243, s[32:35], s59 offen offset:2048 nt lds
  v_exp_f32 v109, v109
  s_waitcnt lgkmcnt(3)
  v_mfma_f32_32x32x16_bf16 v[112:127], a[248:251], v[216:219], v[112:127]
  ds_read_b64_tr_b16 a[228:229], v242 offset:16512
  v_add_f32 v249, v249, v108
  v_exp_f32 v110, v110
  v_add_f32 v249, v249, v109
  v_cvt_pk_bf16_f32 v106, v108, v109
  v_mfma_f32_32x32x16_bf16 v[128:143], a[248:251], v[24:27], v[128:143]
  ds_read_b64_tr_b16 a[230:231], v242 offset:20608
  v_exp_f32 v111, v111
  v_add_f32 v249, v249, v110
  v_add_f32 v249, v249, v111
  v_cvt_pk_bf16_f32 v107, v110, v111
  v_mfma_f32_32x32x16_bf16 v[144:159], a[248:251], v[56:59], v[144:159]
  s_lshl_b32 s68, s48, 1
  s_and_b32 s69, s3, 1
  s_add_u32 s68, s68, s69
  s_lshl_b32 s68, s68, 5
  s_lshr_b32 s69, s3, 1
  s_waitcnt lgkmcnt(4)
  v_mfma_f32_32x32x16_bf16 v[112:127], a[252:255], v[220:223], v[112:127]
  ds_read_b64_tr_b16 a[232:233], v241 offset:17536
  s_add_u32 s68, s68, s69
  s_lshl_b32 s69, s70, 1
  s_add_u32 s68, s68, s69
  s_lshl_b32 s15, 15, s70
  s_lshl_b32 s16, 0x1111, s71
  v_mfma_f32_32x32x16_bf16 v[128:143], a[252:255], v[28:31], v[128:143]
  ds_read_b64_tr_b16 a[234:235], v241 offset:21632
  s_add_u32 s69, s71, 0
  s_and_b32 s69, s69, 3
  s_lshl_b32 s69, s69, 1
  s_add_u32 s69, s69, s68
  s_mul_i32 s63, s69, 24576
  v_mfma_f32_32x32x16_bf16 v[144:159], a[252:255], v[60:63], v[144:159]
  s_add_u32 s69, s71, 1
  s_and_b32 s69, s69, 3
  s_lshl_b32 s69, s69, 1
  s_add_u32 s69, s69, s68
  s_mul_i32 s64, s69, 24576
  s_waitcnt lgkmcnt(4)
  v_mfma_f32_32x32x16_bf16 a[0:15], a[224:227], v[64:67], a[0:15]
  buffer_load_dwordx4 v244, s[32:35], s59 offen offset:3072 nt lds
  ds_read_b64_tr_b16 a[236:237], v242 offset:17536
  s_add_u32 s69, s71, 2
  s_and_b32 s69, s69, 3
  v_mfma_f32_32x32x16_bf16 a[16:31], a[224:227], v[80:83], a[16:31]
  ds_read_b64_tr_b16 a[238:239], v242 offset:21632
  v_exp_f32 v112, v112
  v_exp_f32 v113, v113
  v_add_f32 v247, v247, v112
  v_mfma_f32_32x32x16_bf16 a[32:47], a[224:227], v[96:99], a[32:47]
  v_exp_f32 v114, v114
  v_add_f32 v247, v247, v113
  v_cvt_pk_bf16_f32 v112, v112, v113
  s_waitcnt lgkmcnt(4)
  v_mfma_f32_32x32x16_bf16 a[48:63], a[228:231], v[64:67], a[48:63]
  ds_read_b64_tr_b16 a[240:241], v241 offset:24704
  v_exp_f32 v115, v115
  v_add_f32 v247, v247, v114
  v_exp_f32 v116, v116
  v_mfma_f32_32x32x16_bf16 a[64:79], a[228:231], v[80:83], a[64:79]
  ds_read_b64_tr_b16 a[242:243], v241 offset:28800
  v_add_f32 v247, v247, v115
  v_cvt_pk_bf16_f32 v113, v114, v115
  v_exp_f32 v117, v117
  v_add_f32 v247, v247, v116
  v_mfma_f32_32x32x16_bf16 a[80:95], a[228:231], v[96:99], a[80:95]
  v_exp_f32 v118, v118
  v_add_f32 v247, v247, v117
  v_cvt_pk_bf16_f32 v114, v116, v117
  s_waitcnt lgkmcnt(4)
  v_mfma_f32_32x32x16_bf16 a[96:111], a[232:235], v[64:67], a[96:111]
  ds_read_b64_tr_b16 a[244:245], v242 offset:24704
  s_add_u32 m0, s62, 49408
  s_mov_b32 s59, 106496
  v_exp_f32 v119, v119
  v_add_f32 v247, v247, v118
  v_mfma_f32_32x32x16_bf16 a[112:127], a[232:235], v[80:83], a[112:127]
  buffer_load_dwordx4 v245, s[36:39], s59 offen offset:0 nt lds
  ds_read_b64_tr_b16 a[246:247], v242 offset:28800
  v_exp_f32 v128, v128
  v_mfma_f32_32x32x16_bf16 a[128:143], a[232:235], v[96:99], a[128:143]
  v_add_f32 v247, v247, v119
  v_cvt_pk_bf16_f32 v115, v118, v119
  v_exp_f32 v129, v129
  v_add_f32 v248, v248, v128
  s_waitcnt lgkmcnt(4)
  v_mfma_f32_32x32x16_bf16 a[144:159], a[236:239], v[64:67], a[144:159]
  ds_read_b64_tr_b16 a[248:249], v241 offset:25728
  v_exp_f32 v130, v130
  v_add_f32 v248, v248, v129
  v_cvt_pk_bf16_f32 v128, v128, v129
  v_mfma_f32_32x32x16_bf16 a[160:175], a[236:239], v[80:83], a[160:175]
  ds_read_b64_tr_b16 a[250:251], v241 offset:29824
  v_exp_f32 v131, v131
  v_add_f32 v248, v248, v130
  v_exp_f32 v132, v132
  v_mfma_f32_32x32x16_bf16 a[176:191], a[236:239], v[96:99], a[176:191]
  v_add_f32 v248, v248, v131
  v_cvt_pk_bf16_f32 v129, v130, v131
  v_exp_f32 v133, v133
  v_add_f32 v248, v248, v132
  s_waitcnt lgkmcnt(4)
  v_mfma_f32_32x32x16_bf16 a[0:15], a[240:243], v[72:75], a[0:15]
  ds_read_b64_tr_b16 a[252:253], v242 offset:25728
  v_exp_f32 v134, v134
  v_add_f32 v248, v248, v133
  v_cvt_pk_bf16_f32 v130, v132, v133
  v_mfma_f32_32x32x16_bf16 a[16:31], a[240:243], v[88:91], a[16:31]
  ds_read_b64_tr_b16 a[254:255], v242 offset:29824
  v_exp_f32 v135, v135
  v_add_f32 v248, v248, v134
  v_exp_f32 v144, v144
  v_mfma_f32_32x32x16_bf16 a[32:47], a[240:243], v[104:107], a[32:47]
  buffer_load_dwordx4 v246, s[36:39], s59 offen offset:1024 nt lds
  v_add_u32 v240, 65792, v240
  v_add_f32 v248, v248, v135
  s_waitcnt lgkmcnt(4)
  v_mfma_f32_32x32x16_bf16 a[48:63], a[244:247], v[72:75], a[48:63]
  v_cvt_pk_bf16_f32 v131, v134, v135
  v_exp_f32 v145, v145
  v_add_f32 v249, v249, v144
  v_exp_f32 v146, v146
  v_mfma_f32_32x32x16_bf16 a[64:79], a[244:247], v[88:91], a[64:79]
  s_waitcnt lgkmcnt(0)
  s_waitcnt vmcnt(10)
  s_barrier
  v_add_f32 v249, v249, v145
  v_cvt_pk_bf16_f32 v144, v144, v145
  v_exp_f32 v147, v147
  v_mfma_f32_32x32x16_bf16 a[80:95], a[244:247], v[104:107], a[80:95]
  v_add_f32 v249, v249, v146
  v_exp_f32 v148, v148
  v_add_f32 v249, v249, v147
  v_cvt_pk_bf16_f32 v145, v146, v147
  v_mfma_f32_32x32x16_bf16 a[96:111], a[248:251], v[72:75], a[96:111]
  ds_read_b128 a[224:227], v240 offset:0
  v_exp_f32 v149, v149
  v_add_f32 v249, v249, v148
  v_exp_f32 v150, v150
  v_mfma_f32_32x32x16_bf16 a[112:127], a[248:251], v[88:91], a[112:127]
  v_add_f32 v249, v249, v149
  v_cvt_pk_bf16_f32 v146, v148, v149
  v_exp_f32 v151, v151
  v_add_f32 v249, v249, v150
  v_mfma_f32_32x32x16_bf16 a[128:143], a[248:251], v[104:107], a[128:143]
  ds_read_b128 a[228:231], v240 offset:32
  v_exp_f32 v120, v120
  v_add_f32 v249, v249, v151
  v_cvt_pk_bf16_f32 v147, v150, v151
  v_mfma_f32_32x32x16_bf16 a[144:159], a[252:255], v[72:75], a[144:159]
  buffer_load_dwordx4 v245, s[40:43], s59 offen offset:2048 nt lds
  v_exp_f32 v121, v121
  v_add_f32 v247, v247, v120
  v_mfma_f32_32x32x16_bf16 a[160:175], a[252:255], v[88:91], a[160:175]
  ds_read_b128 a[232:235], v240 offset:64
  v_exp_f32 v122, v122
  v_add_f32 v247, v247, v121
  v_cvt_pk_bf16_f32 v120, v120, v121
  v_mfma_f32_32x32x16_bf16 a[176:191], a[252:255], v[104:107], a[176:191]
  v_exp_f32 v123, v123
  v_add_f32 v247, v247, v122
  v_exp_f32 v124, v124
  s_waitcnt lgkmcnt(2)
  v_mfma_f32_32x32x16_bf16 v[64:79], a[224:227], v[192:195], v[224:239]
  v_add_f32 v247, v247, v123
  v_cvt_pk_bf16_f32 v121, v122, v123
  v_exp_f32 v125, v125
  v_add_f32 v247, v247, v124
  v_mfma_f32_32x32x16_bf16 v[80:95], a[224:227], v[0:3], v[160:175]
  ds_read_b128 a[236:239], v240 offset:96
  v_exp_f32 v126, v126
  v_add_f32 v247, v247, v125
  v_cvt_pk_bf16_f32 v122, v124, v125
  v_mfma_f32_32x32x16_bf16 v[96:111], a[224:227], v[32:35], v[176:191]
  v_exp_f32 v127, v127
  v_add_f32 v247, v247, v126
  v_exp_f32 v136, v136
  s_waitcnt lgkmcnt(2)
  v_mfma_f32_32x32x16_bf16 v[64:79], a[228:231], v[196:199], v[64:79]
  v_add_f32 v247, v247, v127
  v_cvt_pk_bf16_f32 v123, v126, v127
  v_exp_f32 v137, v137
  v_add_f32 v248, v248, v136
  v_mfma_f32_32x32x16_bf16 v[80:95], a[228:231], v[4:7], v[80:95]
  buffer_load_dwordx4 v246, s[40:43], s59 offen offset:3072 nt lds
  ds_read_b128 a[240:243], v240 offset:1024
  v_exp_f32 v138, v138
  v_mfma_f32_32x32x16_bf16 v[96:111], a[228:231], v[36:39], v[96:111]
  v_add_f32 v248, v248, v137
  v_cvt_pk_bf16_f32 v136, v136, v137
  v_exp_f32 v139, v139
  v_add_f32 v248, v248, v138
  s_waitcnt lgkmcnt(2)
  v_mfma_f32_32x32x16_bf16 v[64:79], a[232:235], v[200:203], v[64:79]
  v_exp_f32 v140, v140
  v_add_f32 v248, v248, v139
  v_cvt_pk_bf16_f32 v137, v138, v139
  v_exp_f32 v141, v141
  v_mfma_f32_32x32x16_bf16 v[80:95], a[232:235], v[8:11], v[80:95]
  ds_read_b128 a[244:247], v240 offset:1056
  v_add_f32 v248, v248, v140
  v_exp_f32 v142, v142
  v_add_f32 v248, v248, v141
  v_cvt_pk_bf16_f32 v138, v140, v141
  v_mfma_f32_32x32x16_bf16 v[96:111], a[232:235], v[40:43], v[96:111]
  v_exp_f32 v143, v143
  v_add_f32 v248, v248, v142
  v_exp_f32 v152, v152
  s_waitcnt lgkmcnt(2)
  v_mfma_f32_32x32x16_bf16 v[64:79], a[236:239], v[204:207], v[64:79]
  v_add_f32 v248, v248, v143
  v_cvt_pk_bf16_f32 v139, v142, v143
  v_exp_f32 v153, v153
  v_add_f32 v249, v249, v152
  v_mfma_f32_32x32x16_bf16 v[80:95], a[236:239], v[12:15], v[80:95]
  ds_read_b128 a[248:251], v240 offset:1088
  s_add_u32 m0, s61, 131584
  s_mov_b32 s59, 114688
  v_exp_f32 v154, v154
  v_add_f32 v249, v249, v153
  v_mfma_f32_32x32x16_bf16 v[96:111], a[236:239], v[44:47], v[96:111]
  buffer_load_dwordx4 v243, s[28:31], s59 offen offset:0 nt lds
  v_cvt_pk_bf16_f32 v152, v152, v153
  s_waitcnt lgkmcnt(2)
  v_mfma_f32_32x32x16_bf16 v[64:79], a[240:243], v[208:211], v[64:79]
  v_exp_f32 v155, v155
  v_add_f32 v249, v249, v154
  v_exp_f32 v156, v156
  v_add_f32 v249, v249, v155
  v_mfma_f32_32x32x16_bf16 v[80:95], a[240:243], v[16:19], v[80:95]
  ds_read_b128 a[252:255], v240 offset:1120
  v_cvt_pk_bf16_f32 v153, v154, v155
  v_exp_f32 v157, v157
  v_add_f32 v249, v249, v156
  v_mfma_f32_32x32x16_bf16 v[96:111], a[240:243], v[48:51], v[96:111]
  v_exp_f32 v158, v158
  v_add_f32 v249, v249, v157
  v_cvt_pk_bf16_f32 v154, v156, v157
  s_waitcnt lgkmcnt(2)
  v_mfma_f32_32x32x16_bf16 v[64:79], a[244:247], v[212:215], v[64:79]
  ds_read_b64_tr_b16 a[224:225], v241 offset:49408
  v_exp_f32 v159, v159
  v_add_f32 v249, v249, v158
  v_add_f32 v249, v249, v159
  v_cvt_pk_bf16_f32 v155, v158, v159
  v_mfma_f32_32x32x16_bf16 v[80:95], a[244:247], v[20:23], v[80:95]
  ds_read_b64_tr_b16 a[226:227], v241 offset:53504
  s_lshl_b32 s69, s69, 1
  s_add_u32 s69, s69, s68
  s_mul_i32 s65, s69, 24576
  s_add_u32 s69, s71, 3
  s_and_b32 s69, s69, 3
  v_mfma_f32_32x32x16_bf16 v[96:111], a[244:247], v[52:55], v[96:111]
  s_lshl_b32 s69, s69, 1
  s_add_u32 s69, s69, s68
  s_mul_i32 s70, s69, 24576
  v_bfe_u32 v253, v252, 2, 2
  v_lshlrev_b32 v253, 7, v253
  s_waitcnt lgkmcnt(3)
  v_mfma_f32_32x32x16_bf16 v[64:79], a[248:251], v[216:219], v[64:79]
  buffer_load_dwordx4 v244, s[28:31], s59 offen offset:1024 nt lds
  ds_read_b64_tr_b16 a[228:229], v242 offset:49408
  v_lshrrev_b32 v254, 5, v252
  v_lshl_add_u32 v253, v254, 9, v253
  v_mfma_f32_32x32x16_bf16 v[80:95], a[248:251], v[24:27], v[80:95]
  ds_read_b64_tr_b16 a[230:231], v242 offset:53504
  v_bfe_u32 v254, v252, 3, 1
  v_lshl_add_u32 v253, v254, 6, v253
  v_bfe_u32 v254, v252, 4, 1
  v_lshl_add_u32 v253, v254, 5, v253
  v_and_b32 v254, 1, v252
  v_mfma_f32_32x32x16_bf16 v[96:111], a[248:251], v[56:59], v[96:111]
  v_lshl_add_u32 v253, v254, 4, v253
  v_bfe_u32 v254, v252, 1, 1
  v_lshl_add_u32 v253, v254, 3, v253
  s_lshr_b32 s69, s3, 1
  s_lshl_b32 s69, s69, 11
  s_waitcnt lgkmcnt(4)
  v_mfma_f32_32x32x16_bf16 v[64:79], a[252:255], v[220:223], v[64:79]
  ds_read_b64_tr_b16 a[232:233], v241 offset:50432
  v_add_u32 v253, s69, v253
  s_lshl_b32 s69, s49, 2
  s_add_u32 s52, s53, s69
  v_lshrrev_b32 v254, 4, v252
  v_add_u32 v254, s3, v254
  v_mfma_f32_32x32x16_bf16 v[80:95], a[252:255], v[28:31], v[80:95]
  ds_read_b64_tr_b16 a[234:235], v241 offset:54528
  v_min_u32 v254, 1, v254
  v_lshlrev_b32 v254, 31, v254
  v_lshl_add_u32 v254, v252, 2, v254
  v_lshlrev_b32 v252, 4, v252
  v_mfma_f32_32x32x16_bf16 v[96:111], a[252:255], v[60:63], v[96:111]
  s_waitcnt lgkmcnt(4)
  v_mfma_f32_32x32x16_bf16 a[0:15], a[224:227], v[112:115], a[0:15]
  ds_read_b64_tr_b16 a[236:237], v242 offset:50432
  v_mfma_f32_32x32x16_bf16 a[16:31], a[224:227], v[128:131], a[16:31]
  buffer_load_dwordx4 v243, s[32:35], s59 offen offset:2048 nt lds
  ds_read_b64_tr_b16 a[238:239], v242 offset:54528
  v_exp_f32 v64, v64
  v_mfma_f32_32x32x16_bf16 a[32:47], a[224:227], v[144:147], a[32:47]
  v_exp_f32 v65, v65
  v_add_f32 v247, v247, v64
  v_exp_f32 v66, v66
  s_waitcnt lgkmcnt(4)
  v_mfma_f32_32x32x16_bf16 a[48:63], a[228:231], v[112:115], a[48:63]
  ds_read_b64_tr_b16 a[240:241], v241 offset:57600
  v_add_f32 v247, v247, v65
  v_cvt_pk_bf16_f32 v64, v64, v65
  v_exp_f32 v67, v67
  v_add_f32 v247, v247, v66
  v_mfma_f32_32x32x16_bf16 a[64:79], a[228:231], v[128:131], a[64:79]
  ds_read_b64_tr_b16 a[242:243], v241 offset:61696
  v_exp_f32 v68, v68
  v_add_f32 v247, v247, v67
  v_cvt_pk_bf16_f32 v65, v66, v67
  v_mfma_f32_32x32x16_bf16 a[80:95], a[228:231], v[144:147], a[80:95]
  v_exp_f32 v69, v69
  v_add_f32 v247, v247, v68
  v_exp_f32 v70, v70
  s_waitcnt lgkmcnt(4)
  v_mfma_f32_32x32x16_bf16 a[96:111], a[232:235], v[112:115], a[96:111]
  ds_read_b64_tr_b16 a[244:245], v242 offset:57600
  v_add_f32 v247, v247, v69
  v_cvt_pk_bf16_f32 v66, v68, v69
  v_exp_f32 v71, v71
  v_add_f32 v247, v247, v70
  v_mfma_f32_32x32x16_bf16 a[112:127], a[232:235], v[128:131], a[112:127]
  ds_read_b64_tr_b16 a[246:247], v242 offset:61696
  v_exp_f32 v80, v80
  v_add_f32 v247, v247, v71
  v_cvt_pk_bf16_f32 v67, v70, v71
  v_mfma_f32_32x32x16_bf16 a[128:143], a[232:235], v[144:147], a[128:143]
  buffer_load_dwordx4 v244, s[32:35], s59 offen offset:3072 nt lds
  v_exp_f32 v81, v81
  s_waitcnt lgkmcnt(4)
  v_mfma_f32_32x32x16_bf16 a[144:159], a[236:239], v[112:115], a[144:159]
  ds_read_b64_tr_b16 a[248:249], v241 offset:58624
  v_add_f32 v248, v248, v80
  v_exp_f32 v82, v82
  v_add_f32 v248, v248, v81
  v_cvt_pk_bf16_f32 v80, v80, v81
  v_mfma_f32_32x32x16_bf16 a[160:175], a[236:239], v[128:131], a[160:175]
  ds_read_b64_tr_b16 a[250:251], v241 offset:62720
  v_exp_f32 v83, v83
  v_add_f32 v248, v248, v82
  v_exp_f32 v84, v84
  v_mfma_f32_32x32x16_bf16 a[176:191], a[236:239], v[144:147], a[176:191]
  v_add_f32 v248, v248, v83
  v_cvt_pk_bf16_f32 v81, v82, v83
  v_exp_f32 v85, v85
  v_add_f32 v248, v248, v84
  s_waitcnt lgkmcnt(4)
  v_mfma_f32_32x32x16_bf16 a[0:15], a[240:243], v[120:123], a[0:15]
  ds_read_b64_tr_b16 a[252:253], v242 offset:58624
  v_exp_f32 v86, v86
  v_add_f32 v248, v248, v85
  v_cvt_pk_bf16_f32 v82, v84, v85
  v_mfma_f32_32x32x16_bf16 a[16:31], a[240:243], v[136:139], a[16:31]
  ds_read_b64_tr_b16 a[254:255], v242 offset:62720
  v_exp_f32 v87, v87
  v_add_f32 v248, v248, v86
  v_exp_f32 v96, v96
  v_mfma_f32_32x32x16_bf16 a[32:47], a[240:243], v[152:155], a[32:47]
  s_add_u32 m0, s62, 82304
  s_mov_b32 s59, 114688
  v_add_f32 v248, v248, v87
  v_cvt_pk_bf16_f32 v83, v86, v87
  s_waitcnt lgkmcnt(4)
  v_mfma_f32_32x32x16_bf16 a[48:63], a[244:247], v[120:123], a[48:63]
  buffer_load_dwordx4 v245, s[36:39], s59 offen offset:0 nt lds
  v_exp_f32 v97, v97
  v_add_f32 v249, v249, v96
  v_mfma_f32_32x32x16_bf16 a[64:79], a[244:247], v[136:139], a[64:79]
  s_waitcnt lgkmcnt(0)
  s_waitcnt vmcnt(9)
  s_barrier
  v_exp_f32 v98, v98
  v_add_f32 v249, v249, v97
  v_cvt_pk_bf16_f32 v96, v96, v97
  v_mfma_f32_32x32x16_bf16 a[80:95], a[244:247], v[152:155], a[80:95]
  v_exp_f32 v99, v99
  v_add_f32 v249, v249, v98
  v_exp_f32 v100, v100
  v_mfma_f32_32x32x16_bf16 a[96:111], a[248:251], v[120:123], a[96:111]
  ds_read_b128 a[224:227], v240 offset:32896
  v_add_f32 v249, v249, v99
  v_cvt_pk_bf16_f32 v97, v98, v99
  v_exp_f32 v101, v101
  v_add_f32 v249, v249, v100
  v_mfma_f32_32x32x16_bf16 a[112:127], a[248:251], v[136:139], a[112:127]
  v_exp_f32 v102, v102
  v_add_f32 v249, v249, v101
  v_cvt_pk_bf16_f32 v98, v100, v101
  v_exp_f32 v103, v103
  v_mfma_f32_32x32x16_bf16 a[128:143], a[248:251], v[152:155], a[128:143]
  ds_read_b128 a[228:231], v240 offset:32928
  v_add_f32 v249, v249, v102
  v_exp_f32 v72, v72
  v_add_f32 v249, v249, v103
  v_mfma_f32_32x32x16_bf16 a[144:159], a[252:255], v[120:123], a[144:159]
  v_cvt_pk_bf16_f32 v99, v102, v103
  v_exp_f32 v73, v73
  v_add_f32 v247, v247, v72
  v_exp_f32 v74, v74
  v_mfma_f32_32x32x16_bf16 a[160:175], a[252:255], v[136:139], a[160:175]
  buffer_load_dwordx4 v246, s[36:39], s59 offen offset:1024 nt lds
  ds_read_b128 a[232:235], v240 offset:32960
  v_add_f32 v247, v247, v73
  v_cvt_pk_bf16_f32 v72, v72, v73
  v_mfma_f32_32x32x16_bf16 a[176:191], a[252:255], v[152:155], a[176:191]
  v_exp_f32 v75, v75
  v_add_f32 v247, v247, v74
  v_exp_f32 v76, v76
  s_waitcnt lgkmcnt(2)
  v_mfma_f32_32x32x16_bf16 v[112:127], a[224:227], v[192:195], v[224:239]
  v_add_f32 v247, v247, v75
  v_cvt_pk_bf16_f32 v73, v74, v75
  v_exp_f32 v77, v77
  v_add_f32 v247, v247, v76
  v_mfma_f32_32x32x16_bf16 v[128:143], a[224:227], v[0:3], v[160:175]
  ds_read_b128 a[236:239], v240 offset:32992
  v_exp_f32 v78, v78
  v_add_f32 v247, v247, v77
  v_cvt_pk_bf16_f32 v74, v76, v77
  v_mfma_f32_32x32x16_bf16 v[144:159], a[224:227], v[32:35], v[176:191]
  v_exp_f32 v79, v79
  v_add_f32 v247, v247, v78
  v_exp_f32 v88, v88
  s_waitcnt lgkmcnt(2)
  v_mfma_f32_32x32x16_bf16 v[112:127], a[228:231], v[196:199], v[112:127]
  v_add_f32 v247, v247, v79
  v_cvt_pk_bf16_f32 v75, v78, v79
  v_exp_f32 v89, v89
  v_add_f32 v248, v248, v88
  v_mfma_f32_32x32x16_bf16 v[128:143], a[228:231], v[4:7], v[128:143]
  ds_read_b128 a[240:243], v240 offset:33920
  v_exp_f32 v90, v90
  v_add_f32 v248, v248, v89
  v_cvt_pk_bf16_f32 v88, v88, v89
  v_mfma_f32_32x32x16_bf16 v[144:159], a[228:231], v[36:39], v[144:159]
  buffer_load_dwordx4 v245, s[40:43], s59 offen offset:2048 nt lds
  v_exp_f32 v91, v91
  s_waitcnt lgkmcnt(2)
  v_mfma_f32_32x32x16_bf16 v[112:127], a[232:235], v[200:203], v[112:127]
  v_add_f32 v248, v248, v90
  v_exp_f32 v92, v92
  v_add_f32 v248, v248, v91
  v_cvt_pk_bf16_f32 v89, v90, v91
  v_mfma_f32_32x32x16_bf16 v[128:143], a[232:235], v[8:11], v[128:143]
  ds_read_b128 a[244:247], v240 offset:33952
  v_exp_f32 v93, v93
  v_add_f32 v248, v248, v92
  v_exp_f32 v94, v94
  v_mfma_f32_32x32x16_bf16 v[144:159], a[232:235], v[40:43], v[144:159]
  v_add_f32 v248, v248, v93
  v_cvt_pk_bf16_f32 v90, v92, v93
  v_exp_f32 v95, v95
  v_add_f32 v248, v248, v94
  s_waitcnt lgkmcnt(2)
  v_mfma_f32_32x32x16_bf16 v[112:127], a[236:239], v[204:207], v[112:127]
  v_exp_f32 v104, v104
  v_add_f32 v248, v248, v95
  v_cvt_pk_bf16_f32 v91, v94, v95
  v_exp_f32 v105, v105
  v_mfma_f32_32x32x16_bf16 v[128:143], a[236:239], v[12:15], v[128:143]
  ds_read_b128 a[248:251], v240 offset:33984
  v_subrev_u32 v241, 65792, v241
  v_subrev_u32 v242, 65792, v242
  v_add_f32 v249, v249, v104
  v_exp_f32 v106, v106
  v_mfma_f32_32x32x16_bf16 v[144:159], a[236:239], v[44:47], v[144:159]
  v_add_f32 v249, v249, v105
  v_cvt_pk_bf16_f32 v104, v104, v105
  v_exp_f32 v107, v107
  v_add_f32 v249, v249, v106
  s_waitcnt lgkmcnt(2)
  v_mfma_f32_32x32x16_bf16 v[112:127], a[240:243], v[208:211], v[112:127]
  buffer_load_dwordx4 v246, s[40:43], s59 offen offset:3072 nt lds
  v_exp_f32 v108, v108
  v_add_f32 v249, v249, v107
  v_mfma_f32_32x32x16_bf16 v[128:143], a[240:243], v[16:19], v[128:143]
  ds_read_b128 a[252:255], v240 offset:34016
  v_cvt_pk_bf16_f32 v105, v106, v107
  v_exp_f32 v109, v109
  v_add_f32 v249, v249, v108
  v_mfma_f32_32x32x16_bf16 v[144:159], a[240:243], v[48:51], v[144:159]
  v_exp_f32 v110, v110
  v_add_f32 v249, v249, v109
  v_cvt_pk_bf16_f32 v106, v108, v109
  s_waitcnt lgkmcnt(2)
  v_mfma_f32_32x32x16_bf16 v[112:127], a[244:247], v[212:215], v[112:127]
  ds_read_b64_tr_b16 a[224:225], v241 offset:16512
  v_exp_f32 v111, v111
  v_add_f32 v249, v249, v110
  v_add_f32 v249, v249, v111
  v_cvt_pk_bf16_f32 v107, v110, v111
  v_mfma_f32_32x32x16_bf16 v[128:143], a[244:247], v[20:23], v[128:143]
  ds_read_b64_tr_b16 a[226:227], v241 offset:20608
  v_mfma_f32_32x32x16_bf16 v[144:159], a[244:247], v[52:55], v[144:159]
  s_add_u32 m0, s61, 0
  s_mov_b32 s59, 122880
  s_waitcnt lgkmcnt(3)
  v_mfma_f32_32x32x16_bf16 v[112:127], a[248:251], v[216:219], v[112:127]
  buffer_load_dwordx4 v243, s[28:31], s59 offen offset:0 nt lds
  ds_read_b64_tr_b16 a[228:229], v242 offset:16512
  v_mfma_f32_32x32x16_bf16 v[128:143], a[248:251], v[24:27], v[128:143]
  ds_read_b64_tr_b16 a[230:231], v242 offset:20608
  v_mfma_f32_32x32x16_bf16 v[144:159], a[248:251], v[56:59], v[144:159]
  s_waitcnt lgkmcnt(4)
  v_mfma_f32_32x32x16_bf16 v[112:127], a[252:255], v[220:223], v[112:127]
  ds_read_b64_tr_b16 a[232:233], v241 offset:17536
  v_mfma_f32_32x32x16_bf16 v[128:143], a[252:255], v[28:31], v[128:143]
  ds_read_b64_tr_b16 a[234:235], v241 offset:21632
  v_mfma_f32_32x32x16_bf16 v[144:159], a[252:255], v[60:63], v[144:159]
  s_waitcnt lgkmcnt(4)
  v_mfma_f32_32x32x16_bf16 a[0:15], a[224:227], v[64:67], a[0:15]
  ds_read_b64_tr_b16 a[236:237], v242 offset:17536
  v_mfma_f32_32x32x16_bf16 a[16:31], a[224:227], v[80:83], a[16:31]
  buffer_load_dwordx4 v244, s[28:31], s59 offen offset:1024 nt lds
  ds_read_b64_tr_b16 a[238:239], v242 offset:21632
  s_nop 1
  v_exp_f32 v112, v112
  v_mfma_f32_32x32x16_bf16 a[32:47], a[224:227], v[96:99], a[32:47]
  v_exp_f32 v113, v113
  v_add_f32 v247, v247, v112
  v_exp_f32 v114, v114
  s_waitcnt lgkmcnt(4)
  v_mfma_f32_32x32x16_bf16 a[48:63], a[228:231], v[64:67], a[48:63]
  ds_read_b64_tr_b16 a[240:241], v241 offset:24704
  v_add_f32 v247, v247, v113
  v_cvt_pk_bf16_f32 v112, v112, v113
  v_exp_f32 v115, v115
  v_add_f32 v247, v247, v114
  v_mfma_f32_32x32x16_bf16 a[64:79], a[228:231], v[80:83], a[64:79]
  ds_read_b64_tr_b16 a[242:243], v241 offset:28800
  v_exp_f32 v116, v116
  v_add_f32 v247, v247, v115
  v_cvt_pk_bf16_f32 v113, v114, v115
  v_mfma_f32_32x32x16_bf16 a[80:95], a[228:231], v[96:99], a[80:95]
  v_exp_f32 v117, v117
  v_add_f32 v247, v247, v116
  v_exp_f32 v118, v118
  s_waitcnt lgkmcnt(4)
  v_mfma_f32_32x32x16_bf16 a[96:111], a[232:235], v[64:67], a[96:111]
  ds_read_b64_tr_b16 a[244:245], v242 offset:24704
  v_add_f32 v247, v247, v117
  v_cvt_pk_bf16_f32 v114, v116, v117
  v_exp_f32 v119, v119
  v_add_f32 v247, v247, v118
  v_mfma_f32_32x32x16_bf16 a[112:127], a[232:235], v[80:83], a[112:127]
  ds_read_b64_tr_b16 a[246:247], v242 offset:28800
  v_exp_f32 v128, v128
  v_add_f32 v247, v247, v119
  v_cvt_pk_bf16_f32 v115, v118, v119
  v_mfma_f32_32x32x16_bf16 a[128:143], a[232:235], v[96:99], a[128:143]
  buffer_load_dwordx4 v243, s[32:35], s59 offen offset:2048 nt lds
  v_exp_f32 v129, v129
  s_waitcnt lgkmcnt(4)
  v_mfma_f32_32x32x16_bf16 a[144:159], a[236:239], v[64:67], a[144:159]
  ds_read_b64_tr_b16 a[248:249], v241 offset:25728
  v_add_f32 v248, v248, v128
  v_exp_f32 v130, v130
  v_add_f32 v248, v248, v129
  v_cvt_pk_bf16_f32 v128, v128, v129
  v_mfma_f32_32x32x16_bf16 a[160:175], a[236:239], v[80:83], a[160:175]
  ds_read_b64_tr_b16 a[250:251], v241 offset:29824
  v_exp_f32 v131, v131
  v_add_f32 v248, v248, v130
  v_exp_f32 v132, v132
  v_mfma_f32_32x32x16_bf16 a[176:191], a[236:239], v[96:99], a[176:191]
  v_add_f32 v248, v248, v131
  v_cvt_pk_bf16_f32 v129, v130, v131
  v_exp_f32 v133, v133
  v_add_f32 v248, v248, v132
  s_waitcnt lgkmcnt(4)
  v_mfma_f32_32x32x16_bf16 a[0:15], a[240:243], v[72:75], a[0:15]
  ds_read_b64_tr_b16 a[252:253], v242 offset:25728
  v_exp_f32 v134, v134
  v_add_f32 v248, v248, v133
  v_cvt_pk_bf16_f32 v130, v132, v133
  v_mfma_f32_32x32x16_bf16 a[16:31], a[240:243], v[88:91], a[16:31]
  ds_read_b64_tr_b16 a[254:255], v242 offset:29824
  v_exp_f32 v135, v135
  v_add_f32 v248, v248, v134
  v_exp_f32 v144, v144
  v_mfma_f32_32x32x16_bf16 a[32:47], a[240:243], v[104:107], a[32:47]
  buffer_load_dwordx4 v244, s[32:35], s59 offen offset:3072 nt lds
  v_add_u32 v240, 65792, v240
  v_add_f32 v248, v248, v135
  s_waitcnt lgkmcnt(4)
  v_mfma_f32_32x32x16_bf16 a[48:63], a[244:247], v[72:75], a[48:63]
  v_cvt_pk_bf16_f32 v131, v134, v135
  v_exp_f32 v145, v145
  v_add_f32 v249, v249, v144
  v_exp_f32 v146, v146
  v_mfma_f32_32x32x16_bf16 a[64:79], a[244:247], v[88:91], a[64:79]
  s_waitcnt lgkmcnt(0)
  s_waitcnt vmcnt(8)
  s_barrier
  v_add_f32 v249, v249, v145
  v_cvt_pk_bf16_f32 v144, v144, v145
  v_exp_f32 v147, v147
  v_mfma_f32_32x32x16_bf16 a[80:95], a[244:247], v[104:107], a[80:95]
  v_add_f32 v249, v249, v146
  v_exp_f32 v148, v148
  v_add_f32 v249, v249, v147
  v_cvt_pk_bf16_f32 v145, v146, v147
  v_mfma_f32_32x32x16_bf16 a[96:111], a[248:251], v[72:75], a[96:111]
  ds_read_b128 a[224:227], v240 offset:0
  v_exp_f32 v149, v149
  v_add_f32 v249, v249, v148
  v_exp_f32 v150, v150
  v_mfma_f32_32x32x16_bf16 a[112:127], a[248:251], v[88:91], a[112:127]
  v_add_f32 v249, v249, v149
  v_cvt_pk_bf16_f32 v146, v148, v149
  v_exp_f32 v151, v151
  v_add_f32 v249, v249, v150
  v_mfma_f32_32x32x16_bf16 a[128:143], a[248:251], v[104:107], a[128:143]
  ds_read_b128 a[228:231], v240 offset:32
  s_add_u32 m0, s62, 115200
  s_mov_b32 s59, 122880
  v_exp_f32 v120, v120
  v_mfma_f32_32x32x16_bf16 a[144:159], a[252:255], v[72:75], a[144:159]
  buffer_load_dwordx4 v245, s[36:39], s59 offen offset:0 nt lds
  v_add_f32 v249, v249, v151
  v_cvt_pk_bf16_f32 v147, v150, v151
  v_mfma_f32_32x32x16_bf16 a[160:175], a[252:255], v[88:91], a[160:175]
  ds_read_b128 a[232:235], v240 offset:64
  v_exp_f32 v121, v121
  v_add_f32 v247, v247, v120
  v_exp_f32 v122, v122
  v_mfma_f32_32x32x16_bf16 a[176:191], a[252:255], v[104:107], a[176:191]
  v_add_f32 v247, v247, v121
  v_cvt_pk_bf16_f32 v120, v120, v121
  v_exp_f32 v123, v123
  v_add_f32 v247, v247, v122
  s_waitcnt lgkmcnt(2)
  v_mfma_f32_32x32x16_bf16 v[64:79], a[224:227], v[192:195], v[224:239]
  v_exp_f32 v124, v124
  v_add_f32 v247, v247, v123
  v_cvt_pk_bf16_f32 v121, v122, v123
  v_exp_f32 v125, v125
  v_mfma_f32_32x32x16_bf16 v[80:95], a[224:227], v[0:3], v[160:175]
  ds_read_b128 a[236:239], v240 offset:96
  v_add_f32 v247, v247, v124
  v_exp_f32 v126, v126
  v_add_f32 v247, v247, v125
  v_cvt_pk_bf16_f32 v122, v124, v125
  v_mfma_f32_32x32x16_bf16 v[96:111], a[224:227], v[32:35], v[176:191]
  v_exp_f32 v127, v127
  v_add_f32 v247, v247, v126
  v_exp_f32 v136, v136
  s_waitcnt lgkmcnt(2)
  v_mfma_f32_32x32x16_bf16 v[64:79], a[228:231], v[196:199], v[64:79]
  buffer_load_dwordx4 v246, s[36:39], s59 offen offset:1024 nt lds
  v_add_f32 v247, v247, v127
  v_cvt_pk_bf16_f32 v123, v126, v127
  v_mfma_f32_32x32x16_bf16 v[80:95], a[228:231], v[4:7], v[80:95]
  ds_read_b128 a[240:243], v240 offset:1024
  v_exp_f32 v137, v137
  v_add_f32 v248, v248, v136
  v_exp_f32 v138, v138
  v_mfma_f32_32x32x16_bf16 v[96:111], a[228:231], v[36:39], v[96:111]
  v_add_f32 v248, v248, v137
  v_cvt_pk_bf16_f32 v136, v136, v137
  v_exp_f32 v139, v139
  v_add_f32 v248, v248, v138
  s_waitcnt lgkmcnt(2)
  v_mfma_f32_32x32x16_bf16 v[64:79], a[232:235], v[200:203], v[64:79]
  v_exp_f32 v140, v140
  v_add_f32 v248, v248, v139
  v_cvt_pk_bf16_f32 v137, v138, v139
  v_exp_f32 v141, v141
  v_mfma_f32_32x32x16_bf16 v[80:95], a[232:235], v[8:11], v[80:95]
  ds_read_b128 a[244:247], v240 offset:1056
  v_add_f32 v248, v248, v140
  v_exp_f32 v142, v142
  v_add_f32 v248, v248, v141
  v_cvt_pk_bf16_f32 v138, v140, v141
  v_mfma_f32_32x32x16_bf16 v[96:111], a[232:235], v[40:43], v[96:111]
  v_exp_f32 v143, v143
  v_add_f32 v248, v248, v142
  v_exp_f32 v152, v152
  s_waitcnt lgkmcnt(2)
  v_mfma_f32_32x32x16_bf16 v[64:79], a[236:239], v[204:207], v[64:79]
  v_add_f32 v248, v248, v143
  v_cvt_pk_bf16_f32 v139, v142, v143
  v_exp_f32 v153, v153
  v_add_f32 v249, v249, v152
  v_mfma_f32_32x32x16_bf16 v[80:95], a[236:239], v[12:15], v[80:95]
  buffer_load_dwordx4 v245, s[40:43], s59 offen offset:2048 nt lds
  ds_read_b128 a[248:251], v240 offset:1088
  v_exp_f32 v154, v154
  v_mfma_f32_32x32x16_bf16 v[96:111], a[236:239], v[44:47], v[96:111]
  v_add_f32 v249, v249, v153
  v_cvt_pk_bf16_f32 v152, v152, v153
  v_exp_f32 v155, v155
  v_add_f32 v249, v249, v154
  s_waitcnt lgkmcnt(2)
  v_mfma_f32_32x32x16_bf16 v[64:79], a[240:243], v[208:211], v[64:79]
  v_exp_f32 v156, v156
  v_add_f32 v249, v249, v155
  v_cvt_pk_bf16_f32 v153, v154, v155
  v_exp_f32 v157, v157
  v_mfma_f32_32x32x16_bf16 v[80:95], a[240:243], v[16:19], v[80:95]
  ds_read_b128 a[252:255], v240 offset:1120
  v_add_f32 v249, v249, v156
  v_exp_f32 v158, v158
  v_add_f32 v249, v249, v157
  v_cvt_pk_bf16_f32 v154, v156, v157
  v_mfma_f32_32x32x16_bf16 v[96:111], a[240:243], v[48:51], v[96:111]
  v_exp_f32 v159, v159
  v_add_f32 v249, v249, v158
  v_add_f32 v249, v249, v159
  v_cvt_pk_bf16_f32 v155, v158, v159
  s_waitcnt lgkmcnt(2)
  v_mfma_f32_32x32x16_bf16 v[64:79], a[244:247], v[212:215], v[64:79]
  ds_read_b64_tr_b16 a[224:225], v241 offset:49408
  v_mfma_f32_32x32x16_bf16 v[80:95], a[244:247], v[20:23], v[80:95]
  buffer_load_dwordx4 v246, s[40:43], s59 offen offset:3072 nt lds
  ds_read_b64_tr_b16 a[226:227], v241 offset:53504
  v_mfma_f32_32x32x16_bf16 v[96:111], a[244:247], v[52:55], v[96:111]
  s_add_u32 m0, s62, 32896
  s_add_u32 s59, s50, 1024
  s_waitcnt lgkmcnt(3)
  v_mfma_f32_32x32x16_bf16 v[64:79], a[248:251], v[216:219], v[64:79]
  buffer_load_dwordx4 v250, s[8:11], s59 offen offset:0 lds
  ds_read_b64_tr_b16 a[228:229], v242 offset:49408
  v_mfma_f32_32x32x16_bf16 v[80:95], a[248:251], v[24:27], v[80:95]
  ds_read_b64_tr_b16 a[230:231], v242 offset:53504
  v_mfma_f32_32x32x16_bf16 v[96:111], a[248:251], v[56:59], v[96:111]
  s_add_u32 s59, s50, 128
  s_waitcnt lgkmcnt(4)
  v_mfma_f32_32x32x16_bf16 v[64:79], a[252:255], v[220:223], v[64:79]
  buffer_load_dwordx4 v250, s[8:11], s59 offen offset:1024 lds
  ds_read_b64_tr_b16 a[232:233], v241 offset:50432
  v_mfma_f32_32x32x16_bf16 v[80:95], a[252:255], v[28:31], v[80:95]
  ds_read_b64_tr_b16 a[234:235], v241 offset:54528
  v_mfma_f32_32x32x16_bf16 v[96:111], a[252:255], v[60:63], v[96:111]
  s_add_u32 s59, s50, 1152
  s_waitcnt lgkmcnt(4)
  v_mfma_f32_32x32x16_bf16 a[0:15], a[224:227], v[112:115], a[0:15]
  buffer_load_dwordx4 v251, s[8:11], s59 offen offset:2048 lds
  ds_read_b64_tr_b16 a[236:237], v242 offset:50432
  v_mfma_f32_32x32x16_bf16 a[16:31], a[224:227], v[128:131], a[16:31]
  ds_read_b64_tr_b16 a[238:239], v242 offset:54528
  v_exp_f32 v64, v64
  v_exp_f32 v65, v65
  v_add_f32 v247, v247, v64
  v_mfma_f32_32x32x16_bf16 a[32:47], a[224:227], v[144:147], a[32:47]
  s_add_u32 s59, s50, 0
  v_exp_f32 v66, v66
  v_add_f32 v247, v247, v65
  v_cvt_pk_bf16_f32 v64, v64, v65
  s_waitcnt lgkmcnt(4)
  v_mfma_f32_32x32x16_bf16 a[48:63], a[228:231], v[112:115], a[48:63]
  buffer_load_dwordx4 v251, s[8:11], s59 offen offset:3072 lds
  ds_read_b64_tr_b16 a[240:241], v241 offset:57600
  v_exp_f32 v67, v67
  v_mfma_f32_32x32x16_bf16 a[64:79], a[228:231], v[128:131], a[64:79]
  ds_read_b64_tr_b16 a[242:243], v241 offset:61696
  v_add_f32 v247, v247, v66
  v_exp_f32 v68, v68
  v_add_f32 v247, v247, v67
  v_cvt_pk_bf16_f32 v65, v66, v67
  v_mfma_f32_32x32x16_bf16 a[80:95], a[228:231], v[144:147], a[80:95]
  s_add_u32 m0, s62, 65792
  s_add_u32 s59, s50, 33792
  v_exp_f32 v69, v69
  v_add_f32 v247, v247, v68
  s_waitcnt lgkmcnt(4)
  v_mfma_f32_32x32x16_bf16 a[96:111], a[232:235], v[112:115], a[96:111]
  buffer_load_dwordx4 v250, s[8:11], s59 offen offset:0 lds
  ds_read_b64_tr_b16 a[244:245], v242 offset:57600
  v_exp_f32 v70, v70
  v_mfma_f32_32x32x16_bf16 a[112:127], a[232:235], v[128:131], a[112:127]
  ds_read_b64_tr_b16 a[246:247], v242 offset:61696
  v_add_f32 v247, v247, v69
  v_cvt_pk_bf16_f32 v66, v68, v69
  v_exp_f32 v71, v71
  v_add_f32 v247, v247, v70
  v_mfma_f32_32x32x16_bf16 a[128:143], a[232:235], v[144:147], a[128:143]
  s_add_u32 s59, s50, 32896
  v_exp_f32 v80, v80
  v_add_f32 v247, v247, v71
  v_cvt_pk_bf16_f32 v67, v70, v71
  s_waitcnt lgkmcnt(4)
  v_mfma_f32_32x32x16_bf16 a[144:159], a[236:239], v[112:115], a[144:159]
  buffer_load_dwordx4 v250, s[8:11], s59 offen offset:1024 lds
  ds_read_b64_tr_b16 a[248:249], v241 offset:58624
  v_exp_f32 v81, v81
  v_mfma_f32_32x32x16_bf16 a[160:175], a[236:239], v[128:131], a[160:175]
  ds_read_b64_tr_b16 a[250:251], v241 offset:62720
  v_add_f32 v248, v248, v80
  v_exp_f32 v82, v82
  v_add_f32 v248, v248, v81
  v_cvt_pk_bf16_f32 v80, v80, v81
  v_mfma_f32_32x32x16_bf16 a[176:191], a[236:239], v[144:147], a[176:191]
  s_add_u32 s59, s50, 33920
  v_exp_f32 v83, v83
  v_add_f32 v248, v248, v82
  s_waitcnt lgkmcnt(4)
  v_mfma_f32_32x32x16_bf16 a[0:15], a[240:243], v[120:123], a[0:15]
  buffer_load_dwordx4 v251, s[8:11], s59 offen offset:2048 lds
  ds_read_b64_tr_b16 a[252:253], v242 offset:58624
  v_exp_f32 v84, v84
  v_mfma_f32_32x32x16_bf16 a[16:31], a[240:243], v[136:139], a[16:31]
  ds_read_b64_tr_b16 a[254:255], v242 offset:62720
  v_add_f32 v248, v248, v83
  v_cvt_pk_bf16_f32 v81, v82, v83
  v_exp_f32 v85, v85
  v_add_f32 v248, v248, v84
  v_mfma_f32_32x32x16_bf16 a[32:47], a[240:243], v[152:155], a[32:47]
  v_subrev_u32 v240, 131584, v240
  s_add_u32 s59, s50, 32768
  v_exp_f32 v86, v86
  v_add_f32 v248, v248, v85
  s_waitcnt lgkmcnt(4)
  v_mfma_f32_32x32x16_bf16 a[48:63], a[244:247], v[120:123], a[48:63]
  buffer_load_dwordx4 v251, s[8:11], s59 offen offset:3072 lds
  v_cvt_pk_bf16_f32 v82, v84, v85
  v_exp_f32 v87, v87
  v_mfma_f32_32x32x16_bf16 a[64:79], a[244:247], v[136:139], a[64:79]
  s_waitcnt lgkmcnt(0)
  s_waitcnt vmcnt(12)
  s_barrier
  v_add_f32 v248, v248, v86
  v_exp_f32 v96, v96
  v_add_f32 v248, v248, v87
  v_mfma_f32_32x32x16_bf16 a[80:95], a[244:247], v[152:155], a[80:95]
  s_add_u32 m0, s62, 98688
  s_add_u32 s59, s50, 66560
  v_cvt_pk_bf16_f32 v83, v86, v87
  v_exp_f32 v97, v97
  v_mfma_f32_32x32x16_bf16 a[96:111], a[248:251], v[120:123], a[96:111]
  buffer_load_dwordx4 v250, s[8:11], s59 offen offset:0 lds
  ds_read_b128 a[224:227], v240 offset:0
  v_add_f32 v249, v249, v96
  v_mfma_f32_32x32x16_bf16 a[112:127], a[248:251], v[136:139], a[112:127]
  v_exp_f32 v98, v98
  v_add_f32 v249, v249, v97
  v_cvt_pk_bf16_f32 v96, v96, v97
  v_exp_f32 v99, v99
  v_mfma_f32_32x32x16_bf16 a[128:143], a[248:251], v[152:155], a[128:143]
  ds_read_b128 a[228:231], v240 offset:32
  s_add_u32 s59, s50, 65664
  v_add_f32 v249, v249, v98
  v_exp_f32 v100, v100
  v_mfma_f32_32x32x16_bf16 a[144:159], a[252:255], v[120:123], a[144:159]
  buffer_load_dwordx4 v250, s[8:11], s59 offen offset:1024 lds
  v_add_f32 v249, v249, v99
  v_cvt_pk_bf16_f32 v97, v98, v99
  v_mfma_f32_32x32x16_bf16 a[160:175], a[252:255], v[136:139], a[160:175]
  ds_read_b128 a[232:235], v240 offset:64
  v_exp_f32 v101, v101
  v_add_f32 v249, v249, v100
  v_exp_f32 v102, v102
  v_mfma_f32_32x32x16_bf16 a[176:191], a[252:255], v[152:155], a[176:191]
  s_add_u32 s59, s50, 66688
  v_add_f32 v249, v249, v101
  v_cvt_pk_bf16_f32 v98, v100, v101
  v_exp_f32 v103, v103
  s_waitcnt lgkmcnt(2)
  v_mfma_f32_32x32x16_bf16 v[112:127], a[224:227], v[192:195], v[224:239]
  buffer_load_dwordx4 v251, s[8:11], s59 offen offset:2048 lds
  v_add_f32 v249, v249, v102
  v_exp_f32 v72, v72
  v_mfma_f32_32x32x16_bf16 v[128:143], a[224:227], v[0:3], v[160:175]
  ds_read_b128 a[236:239], v240 offset:96
  v_add_f32 v249, v249, v103
  v_cvt_pk_bf16_f32 v99, v102, v103
  v_exp_f32 v73, v73
  v_add_f32 v247, v247, v72
  v_mfma_f32_32x32x16_bf16 v[144:159], a[224:227], v[32:35], v[176:191]
  s_add_u32 s59, s50, 65536
  v_exp_f32 v74, v74
  v_add_f32 v247, v247, v73
  v_cvt_pk_bf16_f32 v72, v72, v73
  s_waitcnt lgkmcnt(2)
  v_mfma_f32_32x32x16_bf16 v[112:127], a[228:231], v[196:199], v[112:127]
  buffer_load_dwordx4 v251, s[8:11], s59 offen offset:3072 lds
  v_exp_f32 v75, v75
  v_add_f32 v247, v247, v74
  v_mfma_f32_32x32x16_bf16 v[128:143], a[228:231], v[4:7], v[128:143]
  ds_read_b128 a[240:243], v240 offset:1024
  v_exp_f32 v76, v76
  v_add_f32 v247, v247, v75
  v_cvt_pk_bf16_f32 v73, v74, v75
  v_mfma_f32_32x32x16_bf16 v[144:159], a[228:231], v[36:39], v[144:159]
  s_add_u32 m0, s62, 16512
  s_add_u32 s59, s50, 99328
  v_exp_f32 v77, v77
  v_add_f32 v247, v247, v76
  s_waitcnt lgkmcnt(2)
  v_mfma_f32_32x32x16_bf16 v[112:127], a[232:235], v[200:203], v[112:127]
  buffer_load_dwordx4 v250, s[8:11], s59 offen offset:0 lds
  v_exp_f32 v78, v78
  v_add_f32 v247, v247, v77
  v_mfma_f32_32x32x16_bf16 v[128:143], a[232:235], v[8:11], v[128:143]
  ds_read_b128 a[244:247], v240 offset:1056
  v_cvt_pk_bf16_f32 v74, v76, v77
  v_exp_f32 v79, v79
  v_add_f32 v247, v247, v78
  v_mfma_f32_32x32x16_bf16 v[144:159], a[232:235], v[40:43], v[144:159]
  s_add_u32 s59, s50, 98432
  v_exp_f32 v88, v88
  v_add_f32 v247, v247, v79
  v_cvt_pk_bf16_f32 v75, v78, v79
  s_waitcnt lgkmcnt(2)
  v_mfma_f32_32x32x16_bf16 v[112:127], a[236:239], v[204:207], v[112:127]
  buffer_load_dwordx4 v250, s[8:11], s59 offen offset:1024 lds
  v_exp_f32 v89, v89
  v_add_f32 v248, v248, v88
  v_mfma_f32_32x32x16_bf16 v[128:143], a[236:239], v[12:15], v[128:143]
  ds_read_b128 a[248:251], v240 offset:1088
  v_add_u32 v241, 65792, v241
  v_add_u32 v242, 65792, v242
  v_exp_f32 v90, v90
  v_add_f32 v248, v248, v89
  v_mfma_f32_32x32x16_bf16 v[144:159], a[236:239], v[44:47], v[144:159]
  s_add_u32 s59, s50, 99456
  v_cvt_pk_bf16_f32 v88, v88, v89
  v_exp_f32 v91, v91
  v_add_f32 v248, v248, v90
  s_waitcnt lgkmcnt(2)
  v_mfma_f32_32x32x16_bf16 v[112:127], a[240:243], v[208:211], v[112:127]
  buffer_load_dwordx4 v251, s[8:11], s59 offen offset:2048 lds
  v_exp_f32 v92, v92
  v_add_f32 v248, v248, v91
  v_mfma_f32_32x32x16_bf16 v[128:143], a[240:243], v[16:19], v[128:143]
  ds_read_b128 a[252:255], v240 offset:1120
  v_cvt_pk_bf16_f32 v89, v90, v91
  v_exp_f32 v93, v93
  v_add_f32 v248, v248, v92
  v_mfma_f32_32x32x16_bf16 v[144:159], a[240:243], v[48:51], v[144:159]
  s_add_u32 s59, s50, 98304
  v_exp_f32 v94, v94
  v_add_f32 v248, v248, v93
  v_cvt_pk_bf16_f32 v90, v92, v93
  s_waitcnt lgkmcnt(2)
  v_mfma_f32_32x32x16_bf16 v[112:127], a[244:247], v[212:215], v[112:127]
  buffer_load_dwordx4 v251, s[8:11], s59 offen offset:3072 lds
  ds_read_b64_tr_b16 a[224:225], v241 offset:16512
  v_exp_f32 v95, v95
  v_mfma_f32_32x32x16_bf16 v[128:143], a[244:247], v[20:23], v[128:143]
  ds_read_b64_tr_b16 a[226:227], v241 offset:20608
  v_add_f32 v248, v248, v94
  v_exp_f32 v104, v104
  v_add_f32 v248, v248, v95
  v_cvt_pk_bf16_f32 v91, v94, v95
  v_mfma_f32_32x32x16_bf16 v[144:159], a[244:247], v[52:55], v[144:159]
  s_add_u32 m0, s62, 131584
  s_add_u32 s59, s56, 1024
  v_exp_f32 v105, v105
  v_add_f32 v249, v249, v104
  s_waitcnt lgkmcnt(3)
  v_mfma_f32_32x32x16_bf16 v[112:127], a[248:251], v[216:219], v[112:127]
  buffer_load_dwordx4 v250, s[8:11], s59 offen offset:0 lds
  ds_read_b64_tr_b16 a[228:229], v242 offset:16512
  v_exp_f32 v106, v106
  v_mfma_f32_32x32x16_bf16 v[128:143], a[248:251], v[24:27], v[128:143]
  ds_read_b64_tr_b16 a[230:231], v242 offset:20608
  v_add_f32 v249, v249, v105
  v_cvt_pk_bf16_f32 v104, v104, v105
  v_exp_f32 v107, v107
  v_add_f32 v249, v249, v106
  v_mfma_f32_32x32x16_bf16 v[144:159], a[248:251], v[56:59], v[144:159]
  s_add_u32 s59, s56, 128
  v_exp_f32 v108, v108
  v_add_f32 v249, v249, v107
  v_cvt_pk_bf16_f32 v105, v106, v107
  s_waitcnt lgkmcnt(4)
  v_mfma_f32_32x32x16_bf16 v[112:127], a[252:255], v[220:223], v[112:127]
  buffer_load_dwordx4 v250, s[8:11], s59 offen offset:1024 lds
  ds_read_b64_tr_b16 a[232:233], v241 offset:17536
  v_exp_f32 v109, v109
  v_mfma_f32_32x32x16_bf16 v[128:143], a[252:255], v[28:31], v[128:143]
  ds_read_b64_tr_b16 a[234:235], v241 offset:21632
  v_add_f32 v249, v249, v108
  v_exp_f32 v110, v110
  v_add_f32 v249, v249, v109
  v_cvt_pk_bf16_f32 v106, v108, v109
  v_mfma_f32_32x32x16_bf16 v[144:159], a[252:255], v[60:63], v[144:159]
  s_add_u32 s59, s56, 1152
  v_exp_f32 v111, v111
  v_add_f32 v249, v249, v110
  v_add_f32 v249, v249, v111
  s_waitcnt lgkmcnt(4)
  v_mfma_f32_32x32x16_bf16 a[0:15], a[224:227], v[64:67], a[0:15]
  buffer_load_dwordx4 v251, s[8:11], s59 offen offset:2048 lds
  ds_read_b64_tr_b16 a[236:237], v242 offset:17536
  v_cvt_pk_bf16_f32 v107, v110, v111
  v_xor_b32 v240, 64, v253
  v_mfma_f32_32x32x16_bf16 a[16:31], a[224:227], v[80:83], a[16:31]
  ds_read_b64_tr_b16 a[238:239], v242 offset:21632
  v_exp_f32 v112, v112
  v_exp_f32 v113, v113
  v_add_f32 v247, v247, v112
  v_mfma_f32_32x32x16_bf16 a[32:47], a[224:227], v[96:99], a[32:47]
  s_add_u32 s59, s56, 0
  v_exp_f32 v114, v114
  v_add_f32 v247, v247, v113
  v_cvt_pk_bf16_f32 v112, v112, v113
  s_waitcnt lgkmcnt(4)
  v_mfma_f32_32x32x16_bf16 a[48:63], a[228:231], v[64:67], a[48:63]
  buffer_load_dwordx4 v251, s[8:11], s59 offen offset:3072 lds
  ds_read_b64_tr_b16 a[240:241], v241 offset:24704
  v_exp_f32 v115, v115
  v_mfma_f32_32x32x16_bf16 a[64:79], a[228:231], v[80:83], a[64:79]
  ds_read_b64_tr_b16 a[242:243], v241 offset:28800
  v_add_f32 v247, v247, v114
  v_exp_f32 v116, v116
  v_add_f32 v247, v247, v115
  v_cvt_pk_bf16_f32 v113, v114, v115
  v_mfma_f32_32x32x16_bf16 a[80:95], a[228:231], v[96:99], a[80:95]
  s_add_u32 m0, s62, 49408
  s_add_u32 s59, s57, 1024
  v_exp_f32 v117, v117
  v_add_f32 v247, v247, v116
  s_waitcnt lgkmcnt(4)
  v_mfma_f32_32x32x16_bf16 a[96:111], a[232:235], v[64:67], a[96:111]
  buffer_load_dwordx4 v250, s[8:11], s59 offen offset:0 lds
  ds_read_b64_tr_b16 a[244:245], v242 offset:24704
  v_exp_f32 v118, v118
  v_mfma_f32_32x32x16_bf16 a[112:127], a[232:235], v[80:83], a[112:127]
  ds_read_b64_tr_b16 a[246:247], v242 offset:28800
  v_add_f32 v247, v247, v117
  v_cvt_pk_bf16_f32 v114, v116, v117
  v_exp_f32 v119, v119
  v_add_f32 v247, v247, v118
  v_mfma_f32_32x32x16_bf16 a[128:143], a[232:235], v[96:99], a[128:143]
  s_add_u32 s59, s57, 128
  v_exp_f32 v128, v128
  v_add_f32 v247, v247, v119
  v_cvt_pk_bf16_f32 v115, v118, v119
  s_waitcnt lgkmcnt(4)
  v_mfma_f32_32x32x16_bf16 a[144:159], a[236:239], v[64:67], a[144:159]
  buffer_load_dwordx4 v250, s[8:11], s59 offen offset:1024 lds
  ds_read_b64_tr_b16 a[248:249], v241 offset:25728
  v_exp_f32 v129, v129
  v_mfma_f32_32x32x16_bf16 a[160:175], a[236:239], v[80:83], a[160:175]
  ds_read_b64_tr_b16 a[250:251], v241 offset:29824
  v_add_f32 v248, v248, v128
  v_exp_f32 v130, v130
  v_add_f32 v248, v248, v129
  v_cvt_pk_bf16_f32 v128, v128, v129
  v_mfma_f32_32x32x16_bf16 a[176:191], a[236:239], v[96:99], a[176:191]
  s_add_u32 s59, s57, 1152
  v_exp_f32 v131, v131
  v_add_f32 v248, v248, v130
  s_waitcnt lgkmcnt(4)
  v_mfma_f32_32x32x16_bf16 a[0:15], a[240:243], v[72:75], a[0:15]
  buffer_load_dwordx4 v251, s[8:11], s59 offen offset:2048 lds
  ds_read_b64_tr_b16 a[252:253], v242 offset:25728
  v_exp_f32 v132, v132
  v_mfma_f32_32x32x16_bf16 a[16:31], a[240:243], v[88:91], a[16:31]
  ds_read_b64_tr_b16 a[254:255], v242 offset:29824
  v_add_f32 v248, v248, v131
  v_cvt_pk_bf16_f32 v129, v130, v131
  v_exp_f32 v133, v133
  v_add_f32 v248, v248, v132
  v_mfma_f32_32x32x16_bf16 a[32:47], a[240:243], v[104:107], a[32:47]
  s_add_u32 s59, s57, 0
  v_exp_f32 v134, v134
  v_add_f32 v248, v248, v133
  v_cvt_pk_bf16_f32 v130, v132, v133
  s_waitcnt lgkmcnt(4)
  v_mfma_f32_32x32x16_bf16 a[48:63], a[244:247], v[72:75], a[48:63]
  buffer_load_dwordx4 v251, s[8:11], s59 offen offset:3072 lds
  v_exp_f32 v135, v135
  v_add_f32 v248, v248, v134
  v_mfma_f32_32x32x16_bf16 a[64:79], a[244:247], v[88:91], a[64:79]
  s_waitcnt lgkmcnt(0)
  s_waitcnt vmcnt(24)
  s_barrier
  v_exp_f32 v144, v144
  v_add_f32 v248, v248, v135
  v_cvt_pk_bf16_f32 v131, v134, v135
  v_mfma_f32_32x32x16_bf16 a[80:95], a[244:247], v[104:107], a[80:95]
  v_exp_f32 v145, v145
  v_add_f32 v249, v249, v144
  v_exp_f32 v146, v146
  v_mfma_f32_32x32x16_bf16 a[96:111], a[248:251], v[72:75], a[96:111]
  ds_read_b64_tr_b16 a[224:225], v241 offset:49408
  v_add_f32 v249, v249, v145
  v_cvt_pk_bf16_f32 v144, v144, v145
  v_exp_f32 v147, v147
  v_add_f32 v249, v249, v146
  v_mfma_f32_32x32x16_bf16 a[112:127], a[248:251], v[88:91], a[112:127]
  ds_read_b64_tr_b16 a[226:227], v241 offset:53504
  v_exp_f32 v148, v148
  v_add_f32 v249, v249, v147
  v_cvt_pk_bf16_f32 v145, v146, v147
  v_mfma_f32_32x32x16_bf16 a[128:143], a[248:251], v[104:107], a[128:143]
  ds_read_b64_tr_b16 a[228:229], v242 offset:49408
  v_exp_f32 v149, v149
  v_add_f32 v249, v249, v148
  v_mfma_f32_32x32x16_bf16 a[144:159], a[252:255], v[72:75], a[144:159]
  ds_read_b64_tr_b16 a[230:231], v242 offset:53504
  v_exp_f32 v150, v150
  v_add_f32 v249, v249, v149
  v_cvt_pk_bf16_f32 v146, v148, v149
  v_mfma_f32_32x32x16_bf16 a[160:175], a[252:255], v[88:91], a[160:175]
  ds_read_b64_tr_b16 a[232:233], v241 offset:50432
  v_exp_f32 v151, v151
  v_add_f32 v249, v249, v150
  v_exp_f32 v120, v120
  v_mfma_f32_32x32x16_bf16 a[176:191], a[252:255], v[104:107], a[176:191]
  ds_read_b64_tr_b16 a[234:235], v241 offset:54528
  v_add_f32 v249, v249, v151
  v_cvt_pk_bf16_f32 v147, v150, v151
  v_exp_f32 v121, v121
  s_waitcnt lgkmcnt(4)
  v_mfma_f32_32x32x16_bf16 a[0:15], a[224:227], v[112:115], a[0:15]
  ds_read_b64_tr_b16 a[236:237], v242 offset:50432
  v_add_f32 v247, v247, v120
  v_exp_f32 v122, v122
  v_add_f32 v247, v247, v121
  v_cvt_pk_bf16_f32 v120, v120, v121
  v_mfma_f32_32x32x16_bf16 a[16:31], a[224:227], v[128:131], a[16:31]
  ds_read_b64_tr_b16 a[238:239], v242 offset:54528
  v_exp_f32 v123, v123
  v_add_f32 v247, v247, v122
  v_exp_f32 v124, v124
  v_mfma_f32_32x32x16_bf16 a[32:47], a[224:227], v[144:147], a[32:47]
  v_add_f32 v247, v247, v123
  v_cvt_pk_bf16_f32 v121, v122, v123
  v_exp_f32 v125, v125
  v_add_f32 v247, v247, v124
  s_waitcnt lgkmcnt(4)
  v_mfma_f32_32x32x16_bf16 a[48:63], a[228:231], v[112:115], a[48:63]
  ds_read_b64_tr_b16 a[240:241], v241 offset:57600
  v_exp_f32 v126, v126
  v_add_f32 v247, v247, v125
  v_cvt_pk_bf16_f32 v122, v124, v125
  v_mfma_f32_32x32x16_bf16 a[64:79], a[228:231], v[128:131], a[64:79]
  ds_read_b64_tr_b16 a[242:243], v241 offset:61696
  v_exp_f32 v127, v127
  v_add_f32 v247, v247, v126
  v_exp_f32 v136, v136
  v_mfma_f32_32x32x16_bf16 a[80:95], a[228:231], v[144:147], a[80:95]
  v_add_f32 v247, v247, v127
  v_cvt_pk_bf16_f32 v123, v126, v127
  v_exp_f32 v137, v137
  v_add_f32 v248, v248, v136
  s_waitcnt lgkmcnt(4)
  v_mfma_f32_32x32x16_bf16 a[96:111], a[232:235], v[112:115], a[96:111]
  ds_read_b64_tr_b16 a[244:245], v242 offset:57600
  v_exp_f32 v138, v138
  v_add_f32 v248, v248, v137
  v_cvt_pk_bf16_f32 v136, v136, v137
  v_mfma_f32_32x32x16_bf16 a[112:127], a[232:235], v[128:131], a[112:127]
  ds_read_b64_tr_b16 a[246:247], v242 offset:61696
  v_exp_f32 v139, v139
  v_add_f32 v248, v248, v138
  v_exp_f32 v140, v140
  v_mfma_f32_32x32x16_bf16 a[128:143], a[232:235], v[144:147], a[128:143]
  v_add_f32 v248, v248, v139
  v_cvt_pk_bf16_f32 v137, v138, v139
  v_exp_f32 v141, v141
  v_add_f32 v248, v248, v140
  s_waitcnt lgkmcnt(4)
  v_mfma_f32_32x32x16_bf16 a[144:159], a[236:239], v[112:115], a[144:159]
  ds_read_b64_tr_b16 a[248:249], v241 offset:58624
  v_exp_f32 v142, v142
  v_add_f32 v248, v248, v141
  v_cvt_pk_bf16_f32 v138, v140, v141
  v_mfma_f32_32x32x16_bf16 a[160:175], a[236:239], v[128:131], a[160:175]
  ds_read_b64_tr_b16 a[250:251], v241 offset:62720
  v_exp_f32 v143, v143
  v_add_u32 v243, 65792, v253
  v_add_u32 v244, 65792, v240
  v_add_u32 v245, 131584, v253
  v_add_u32 v246, 131584, v240
  v_mfma_f32_32x32x16_bf16 a[176:191], a[236:239], v[144:147], a[176:191]
  v_add_f32 v248, v248, v142
  v_exp_f32 v152, v152
  v_add_f32 v248, v248, v143
  v_cvt_pk_bf16_f32 v139, v142, v143
  v_exp_f32 v153, v153
  v_add_f32 v249, v249, v152
  v_exp_f32 v154, v154
  v_add_f32 v249, v249, v153
  v_cvt_pk_bf16_f32 v152, v152, v153
  v_exp_f32 v155, v155
  v_add_f32 v249, v249, v154
  v_exp_f32 v156, v156
  v_add_f32 v249, v249, v155
  v_cvt_pk_bf16_f32 v153, v154, v155
  v_exp_f32 v157, v157
  v_add_f32 v249, v249, v156
  v_exp_f32 v158, v158
  v_add_f32 v249, v249, v157
  v_cvt_pk_bf16_f32 v154, v156, v157
  v_exp_f32 v159, v159
  s_waitcnt lgkmcnt(4)
  v_mfma_f32_32x32x16_bf16 a[0:15], a[240:243], v[120:123], a[0:15]
  ds_read_b64_tr_b16 a[252:253], v242 offset:58624
  v_add_f32 v249, v249, v158
  v_add_f32 v249, v249, v159
  v_cvt_pk_bf16_f32 v155, v158, v159
  v_mov_b32 v232, v247
  v_mov_b32 v233, v248
  v_mfma_f32_32x32x16_bf16 a[16:31], a[240:243], v[136:139], a[16:31]
  ds_read_b64_tr_b16 a[254:255], v242 offset:62720
  v_mov_b32 v234, v249
  v_permlane32_swap_b32 v232, v247
  v_permlane32_swap_b32 v233, v248
  v_permlane32_swap_b32 v234, v249
  v_add_f32 v247, v247, v232
  v_mfma_f32_32x32x16_bf16 a[32:47], a[240:243], v[152:155], a[32:47]
  v_add_f32 v248, v248, v233
  v_add_f32 v249, v249, v234
  v_rcp_f32 v224, v247
  s_waitcnt lgkmcnt(4)
  v_mfma_f32_32x32x16_bf16 a[48:63], a[244:247], v[120:123], a[48:63]
  v_rcp_f32 v226, v248
  v_rcp_f32 v228, v249
  v_mov_b32 v225, v224
  v_mov_b32 v227, v226
  v_mfma_f32_32x32x16_bf16 a[64:79], a[244:247], v[136:139], a[64:79]
  v_mov_b32 v229, v228
  s_mov_b32 s17, 0x53800000
  v_add_f32 v233, v247, v248
  v_add_f32 v233, v233, v249
  v_cmp_nge_f32 vcc, s17, v233
  v_mov_b32 v234, 148096
  s_lshl_b32 s14, s3, 2
  s_cmp_lg_u64 vcc, 0
  s_cselect_b32 s17, 1, 0
  v_add_u32 v235, s14, v234
  v_mov_b32 v236, s17
  ds_write_b32 v235, v236
  v_mfma_f32_32x32x16_bf16 a[80:95], a[244:247], v[152:155], a[80:95]
  v_accvgpr_read_b32 v64, a0
  v_accvgpr_read_b32 v65, a1
  v_accvgpr_read_b32 v66, a2
  v_accvgpr_read_b32 v67, a3
  v_accvgpr_read_b32 v68, a4
  s_waitcnt lgkmcnt(3)
  v_mfma_f32_32x32x16_bf16 a[96:111], a[248:251], v[120:123], a[96:111]
  s_waitcnt lgkmcnt(0)
  s_waitcnt vmcnt(8)
  s_barrier
  ds_read_b128 v[236:239], v234
  v_accvgpr_read_b32 v69, a5
  v_accvgpr_read_b32 v70, a6
  v_accvgpr_read_b32 v71, a7
  v_mfma_f32_32x32x16_bf16 a[112:127], a[248:251], v[136:139], a[112:127]
  ds_read_b64_tr_b16 a[224:225], v253 offset:32896
  ds_read_b64_tr_b16 a[226:227], v253 offset:36992
  v_pk_mul_f32 v[64:65], v[64:65], v[224:225]
  v_pk_mul_f32 v[66:67], v[66:67], v[224:225]
  v_mfma_f32_32x32x16_bf16 a[128:143], a[248:251], v[152:155], a[128:143]
  ds_read_b64_tr_b16 a[228:229], v240 offset:32896
  ds_read_b64_tr_b16 a[230:231], v240 offset:36992
  v_pk_mul_f32 v[68:69], v[68:69], v[224:225]
  v_mfma_f32_32x32x16_bf16 a[144:159], a[252:255], v[120:123], a[144:159]
  ds_read_b64_tr_b16 a[232:233], v253 offset:33920
  ds_read_b64_tr_b16 a[234:235], v253 offset:38016
  v_pk_mul_f32 v[70:71], v[70:71], v[224:225]
  v_cvt_pk_bf16_f32 v72, v64, v65
  v_cvt_pk_bf16_f32 v73, v66, v67
  v_mfma_f32_32x32x16_bf16 a[160:175], a[252:255], v[136:139], a[160:175]
  ds_read_b64_tr_b16 a[236:237], v253 offset:41088
  ds_read_b64_tr_b16 a[238:239], v253 offset:45184
  v_cvt_pk_bf16_f32 v74, v68, v69
  v_cvt_pk_bf16_f32 v75, v70, v71
  s_add_u32 s67, s63, 0
  v_mfma_f32_32x32x16_bf16 a[176:191], a[252:255], v[152:155], a[176:191]
  buffer_store_dwordx4 v[72:75], v252, s[44:47], s67 offen offset:0 sc1
  v_accvgpr_read_b32 v96, a8
  v_accvgpr_read_b32 v97, a9
  v_accvgpr_read_b32 v98, a10
  v_accvgpr_read_b32 v99, a11
  v_accvgpr_read_b32 v100, a12
  v_accvgpr_read_b32 v101, a13
  v_accvgpr_read_b32 v102, a14
  v_accvgpr_read_b32 v103, a15
  v_pk_mul_f32 v[96:97], v[96:97], v[224:225]
  v_pk_mul_f32 v[98:99], v[98:99], v[224:225]
  v_pk_mul_f32 v[100:101], v[100:101], v[224:225]
  v_pk_mul_f32 v[102:103], v[102:103], v[224:225]
  v_cvt_pk_bf16_f32 v84, v96, v97
  v_cvt_pk_bf16_f32 v85, v98, v99
  v_cvt_pk_bf16_f32 v86, v100, v101
  v_cvt_pk_bf16_f32 v87, v102, v103
  s_add_u32 s67, s63, 3072
  buffer_store_dwordx4 v[84:87], v252, s[44:47], s67 offen offset:0 sc1
  v_accvgpr_read_b32 v64, a16
  v_accvgpr_read_b32 v65, a17
  v_accvgpr_read_b32 v66, a18
  v_accvgpr_read_b32 v67, a19
  v_accvgpr_read_b32 v68, a20
  v_accvgpr_read_b32 v69, a21
  v_accvgpr_read_b32 v70, a22
  v_accvgpr_read_b32 v71, a23
  v_pk_mul_f32 v[64:65], v[64:65], v[226:227]
  v_pk_mul_f32 v[66:67], v[66:67], v[226:227]
  v_pk_mul_f32 v[68:69], v[68:69], v[226:227]
  v_pk_mul_f32 v[70:71], v[70:71], v[226:227]
  v_cvt_pk_bf16_f32 v76, v64, v65
  v_cvt_pk_bf16_f32 v77, v66, v67
  v_cvt_pk_bf16_f32 v78, v68, v69
  v_cvt_pk_bf16_f32 v79, v70, v71
  s_add_u32 s67, s63, 0
  buffer_store_dwordx4 v[76:79], v252, s[44:47], s67 offen offset:1024 sc1
  v_accvgpr_read_b32 v96, a24
  v_accvgpr_read_b32 v97, a25
  v_accvgpr_read_b32 v98, a26
  v_accvgpr_read_b32 v99, a27
  v_accvgpr_read_b32 v100, a28
  v_accvgpr_read_b32 v101, a29
  v_accvgpr_read_b32 v102, a30
  v_accvgpr_read_b32 v103, a31
  v_pk_mul_f32 v[96:97], v[96:97], v[226:227]
  v_pk_mul_f32 v[98:99], v[98:99], v[226:227]
  v_pk_mul_f32 v[100:101], v[100:101], v[226:227]
  v_pk_mul_f32 v[102:103], v[102:103], v[226:227]
  v_cvt_pk_bf16_f32 v88, v96, v97
  v_cvt_pk_bf16_f32 v89, v98, v99
  v_cvt_pk_bf16_f32 v90, v100, v101
  v_cvt_pk_bf16_f32 v91, v102, v103
  s_add_u32 s67, s63, 3072
  buffer_store_dwordx4 v[88:91], v252, s[44:47], s67 offen offset:1024 sc1
  v_accvgpr_read_b32 v64, a32
  v_accvgpr_read_b32 v65, a33
  v_accvgpr_read_b32 v66, a34
  v_accvgpr_read_b32 v67, a35
  v_accvgpr_read_b32 v68, a36
  v_accvgpr_read_b32 v69, a37
  v_accvgpr_read_b32 v70, a38
  v_accvgpr_read_b32 v71, a39
  v_pk_mul_f32 v[64:65], v[64:65], v[228:229]
  v_pk_mul_f32 v[66:67], v[66:67], v[228:229]
  v_pk_mul_f32 v[68:69], v[68:69], v[228:229]
  v_pk_mul_f32 v[70:71], v[70:71], v[228:229]
  v_cvt_pk_bf16_f32 v80, v64, v65
  v_cvt_pk_bf16_f32 v81, v66, v67
  v_cvt_pk_bf16_f32 v82, v68, v69
  v_cvt_pk_bf16_f32 v83, v70, v71
  s_add_u32 s67, s63, 0
  buffer_store_dwordx4 v[80:83], v252, s[44:47], s67 offen offset:2048 sc1
  v_accvgpr_read_b32 v96, a40
  v_accvgpr_read_b32 v97, a41
  v_accvgpr_read_b32 v98, a42
  v_accvgpr_read_b32 v99, a43
  v_accvgpr_read_b32 v100, a44
  v_accvgpr_read_b32 v101, a45
  v_accvgpr_read_b32 v102, a46
  v_accvgpr_read_b32 v103, a47
  v_pk_mul_f32 v[96:97], v[96:97], v[228:229]
  v_pk_mul_f32 v[98:99], v[98:99], v[228:229]
  v_pk_mul_f32 v[100:101], v[100:101], v[228:229]
  v_pk_mul_f32 v[102:103], v[102:103], v[228:229]
  v_cvt_pk_bf16_f32 v92, v96, v97
  v_cvt_pk_bf16_f32 v93, v98, v99
  v_cvt_pk_bf16_f32 v94, v100, v101
  v_cvt_pk_bf16_f32 v95, v102, v103
  s_add_u32 s67, s63, 3072
  buffer_store_dwordx4 v[92:95], v252, s[44:47], s67 offen offset:2048 sc1
  s_waitcnt lgkmcnt(8)
  v_or3_b32 v236, v236, v237, v238
  v_or_b32 v236, v236, v239
  s_nop 0
  v_readfirstlane_b32 s66, v236
  s_nop 1
  s_cmp_lg_u32 s66, 0
  s_cbranch_scc1 L1_slow
L1_norm:
  s_waitcnt lgkmcnt(6)
  v_mfma_f32_32x32x16_bf16 v[120:135], a[224:227], v[72:75], 0
  ds_read_b64_tr_b16 a[240:241], v240 offset:41088
  v_accvgpr_read_b32 v216, a48
  v_accvgpr_read_b32 v217, a49
  v_accvgpr_read_b32 v218, a50
  v_accvgpr_read_b32 v219, a51
  v_accvgpr_read_b32 v220, a52
  v_accvgpr_read_b32 v221, a53
  v_accvgpr_read_b32 v222, a54
  v_mfma_f32_32x32x16_bf16 v[136:151], a[224:227], v[76:79], 0
  ds_read_b64_tr_b16 a[242:243], v240 offset:45184
  v_accvgpr_read_b32 v223, a55
  v_pk_mul_f32 v[216:217], v[216:217], v[224:225]
  v_pk_mul_f32 v[218:219], v[218:219], v[224:225]
  v_pk_mul_f32 v[220:221], v[220:221], v[224:225]
  v_mfma_f32_32x32x16_bf16 v[152:167], a[224:227], v[80:83], 0
  v_pk_mul_f32 v[222:223], v[222:223], v[224:225]
  v_cvt_pk_bf16_f32 v96, v216, v217
  v_cvt_pk_bf16_f32 v97, v218, v219
  v_cvt_pk_bf16_f32 v98, v220, v221
  v_cvt_pk_bf16_f32 v99, v222, v223
  s_add_u32 s67, s63, 6144
  s_waitcnt lgkmcnt(6)
  v_mfma_f32_32x32x16_bf16 v[168:183], a[228:231], v[72:75], 0
  ds_read_b64_tr_b16 a[244:245], v253 offset:42112
  buffer_store_dwordx4 v[96:99], v252, s[44:47], s67 offen offset:0 sc1
  v_accvgpr_read_b32 v230, a56
  v_accvgpr_read_b32 v231, a57
  v_accvgpr_read_b32 v232, a58
  v_accvgpr_read_b32 v233, a59
  v_mfma_f32_32x32x16_bf16 v[184:199], a[228:231], v[76:79], 0
  ds_read_b64_tr_b16 a[246:247], v253 offset:46208
  v_accvgpr_read_b32 v234, a60
  v_accvgpr_read_b32 v235, a61
  v_accvgpr_read_b32 v236, a62
  v_accvgpr_read_b32 v237, a63
  v_pk_mul_f32 v[230:231], v[230:231], v[224:225]
  v_mfma_f32_32x32x16_bf16 v[200:215], a[228:231], v[80:83], 0
  v_pk_mul_f32 v[232:233], v[232:233], v[224:225]
  v_pk_mul_f32 v[234:235], v[234:235], v[224:225]
  v_pk_mul_f32 v[236:237], v[236:237], v[224:225]
  v_cvt_pk_bf16_f32 v108, v230, v231
  v_cvt_pk_bf16_f32 v109, v232, v233
  s_waitcnt lgkmcnt(6)
  v_mfma_f32_32x32x16_bf16 a[0:15], a[232:235], v[72:75], 0
  ds_read_b64_tr_b16 a[248:249], v240 offset:33920
  v_cvt_pk_bf16_f32 v110, v234, v235
  v_cvt_pk_bf16_f32 v111, v236, v237
  s_add_u32 s67, s63, 9216
  buffer_store_dwordx4 v[108:111], v252, s[44:47], s67 offen offset:0 sc1
  v_accvgpr_read_b32 v216, a64
  v_mfma_f32_32x32x16_bf16 a[16:31], a[232:235], v[76:79], 0
  ds_read_b64_tr_b16 a[250:251], v240 offset:38016
  v_accvgpr_read_b32 v217, a65
  v_accvgpr_read_b32 v218, a66
  v_accvgpr_read_b32 v219, a67
  v_accvgpr_read_b32 v220, a68
  v_accvgpr_read_b32 v221, a69
  v_accvgpr_read_b32 v222, a70
  v_accvgpr_read_b32 v223, a71
  v_mfma_f32_32x32x16_bf16 a[32:47], a[232:235], v[80:83], 0
  v_pk_mul_f32 v[216:217], v[216:217], v[226:227]
  v_pk_mul_f32 v[218:219], v[218:219], v[226:227]
  v_pk_mul_f32 v[220:221], v[220:221], v[226:227]
  v_pk_mul_f32 v[222:223], v[222:223], v[226:227]
  s_waitcnt lgkmcnt(6)
  v_mfma_f32_32x32x16_bf16 v[120:135], a[236:239], v[84:87], v[120:135]
  ds_read_b64_tr_b16 a[252:253], v240 offset:42112
  v_cvt_pk_bf16_f32 v100, v216, v217
  v_cvt_pk_bf16_f32 v101, v218, v219
  v_cvt_pk_bf16_f32 v102, v220, v221
  v_cvt_pk_bf16_f32 v103, v222, v223
  s_add_u32 s67, s63, 6144
  v_mfma_f32_32x32x16_bf16 v[136:151], a[236:239], v[88:91], v[136:151]
  ds_read_b64_tr_b16 a[254:255], v240 offset:46208
  buffer_store_dwordx4 v[100:103], v252, s[44:47], s67 offen offset:1024 sc1
  v_accvgpr_read_b32 v230, a72
  v_accvgpr_read_b32 v231, a73
  v_accvgpr_read_b32 v232, a74
  v_accvgpr_read_b32 v233, a75
  v_mfma_f32_32x32x16_bf16 v[152:167], a[236:239], v[92:95], v[152:167]
  v_accvgpr_read_b32 v234, a76
  v_accvgpr_read_b32 v235, a77
  v_accvgpr_read_b32 v236, a78
  v_accvgpr_read_b32 v237, a79
  v_pk_mul_f32 v[230:231], v[230:231], v[226:227]
  v_pk_mul_f32 v[232:233], v[232:233], v[226:227]
  s_waitcnt lgkmcnt(6)
  v_mfma_f32_32x32x16_bf16 v[168:183], a[240:243], v[84:87], v[168:183]
  v_pk_mul_f32 v[234:235], v[234:235], v[226:227]
  v_pk_mul_f32 v[236:237], v[236:237], v[226:227]
  v_cvt_pk_bf16_f32 v112, v230, v231
  v_cvt_pk_bf16_f32 v113, v232, v233
  v_cvt_pk_bf16_f32 v114, v234, v235
  v_cvt_pk_bf16_f32 v115, v236, v237
  v_mfma_f32_32x32x16_bf16 v[184:199], a[240:243], v[88:91], v[184:199]
  s_add_u32 s67, s63, 9216
  buffer_store_dwordx4 v[112:115], v252, s[44:47], s67 offen offset:1024 sc1
  v_accvgpr_read_b32 v216, a80
  v_accvgpr_read_b32 v217, a81
  v_accvgpr_read_b32 v218, a82
  v_accvgpr_read_b32 v219, a83
  v_mfma_f32_32x32x16_bf16 v[200:215], a[240:243], v[92:95], v[200:215]
  ds_read_b64_tr_b16 a[224:225], v243 offset:0
  v_accvgpr_read_b32 v220, a84
  v_accvgpr_read_b32 v221, a85
  v_accvgpr_read_b32 v222, a86
  v_accvgpr_read_b32 v223, a87
  v_pk_mul_f32 v[216:217], v[216:217], v[228:229]
  s_waitcnt lgkmcnt(5)
  v_mfma_f32_32x32x16_bf16 a[0:15], a[244:247], v[84:87], a[0:15]
  ds_read_b64_tr_b16 a[226:227], v243 offset:4096
  v_pk_mul_f32 v[218:219], v[218:219], v[228:229]
  v_pk_mul_f32 v[220:221], v[220:221], v[228:229]
  v_pk_mul_f32 v[222:223], v[222:223], v[228:229]
  v_cvt_pk_bf16_f32 v104, v216, v217
  v_mfma_f32_32x32x16_bf16 a[16:31], a[244:247], v[88:91], a[16:31]
  v_cvt_pk_bf16_f32 v105, v218, v219
  v_cvt_pk_bf16_f32 v106, v220, v221
  v_cvt_pk_bf16_f32 v107, v222, v223
  s_add_u32 s67, s63, 6144
  buffer_store_dwordx4 v[104:107], v252, s[44:47], s67 offen offset:2048 sc1
  v_accvgpr_read_b32 v230, a88
  v_accvgpr_read_b32 v231, a89
  v_accvgpr_read_b32 v232, a90
  v_accvgpr_read_b32 v233, a91
  v_accvgpr_read_b32 v234, a92
  v_accvgpr_read_b32 v235, a93
  v_accvgpr_read_b32 v236, a94
  v_accvgpr_read_b32 v237, a95
  v_pk_mul_f32 v[230:231], v[230:231], v[228:229]
  v_pk_mul_f32 v[232:233], v[232:233], v[228:229]
  v_pk_mul_f32 v[234:235], v[234:235], v[228:229]
  v_pk_mul_f32 v[236:237], v[236:237], v[228:229]
  v_cvt_pk_bf16_f32 v116, v230, v231
  v_cvt_pk_bf16_f32 v117, v232, v233
  v_cvt_pk_bf16_f32 v118, v234, v235
  v_cvt_pk_bf16_f32 v119, v236, v237
  s_add_u32 s67, s63, 9216
  buffer_store_dwordx4 v[116:119], v252, s[44:47], s67 offen offset:2048 sc1
  v_mfma_f32_32x32x16_bf16 a[32:47], a[244:247], v[92:95], a[32:47]
  ds_read_b64_tr_b16 a[228:229], v244 offset:0
  v_accvgpr_read_b32 v216, a96
  v_accvgpr_read_b32 v217, a97
  v_accvgpr_read_b32 v218, a98
  v_accvgpr_read_b32 v219, a99
  v_accvgpr_read_b32 v220, a100
  v_accvgpr_read_b32 v221, a101
  v_accvgpr_read_b32 v222, a102
  s_waitcnt lgkmcnt(5)
  v_mfma_f32_32x32x16_bf16 a[48:63], a[248:251], v[72:75], 0
  ds_read_b64_tr_b16 a[230:231], v244 offset:4096
  v_accvgpr_read_b32 v223, a103
  v_pk_mul_f32 v[216:217], v[216:217], v[224:225]
  v_pk_mul_f32 v[218:219], v[218:219], v[224:225]
  v_pk_mul_f32 v[220:221], v[220:221], v[224:225]
  v_mfma_f32_32x32x16_bf16 a[64:79], a[248:251], v[76:79], 0
  v_pk_mul_f32 v[222:223], v[222:223], v[224:225]
  v_cvt_pk_bf16_f32 v0, v216, v217
  v_cvt_pk_bf16_f32 v1, v218, v219
  v_cvt_pk_bf16_f32 v2, v220, v221
  v_cvt_pk_bf16_f32 v3, v222, v223
  s_add_u32 s67, s63, 12288
  v_mfma_f32_32x32x16_bf16 a[80:95], a[248:251], v[80:83], 0
  ds_read_b64_tr_b16 a[232:233], v243 offset:1024
  buffer_store_dwordx4 v[0:3], v252, s[44:47], s67 offen offset:0 sc1
  v_accvgpr_read_b32 v230, a104
  v_accvgpr_read_b32 v231, a105
  v_accvgpr_read_b32 v232, a106
  v_accvgpr_read_b32 v233, a107
  s_waitcnt lgkmcnt(5)
  v_mfma_f32_32x32x16_bf16 a[48:63], a[252:255], v[84:87], a[48:63]
  ds_read_b64_tr_b16 a[234:235], v243 offset:5120
  v_accvgpr_read_b32 v234, a108
  v_accvgpr_read_b32 v235, a109
  v_accvgpr_read_b32 v236, a110
  v_accvgpr_read_b32 v237, a111
  v_pk_mul_f32 v[230:231], v[230:231], v[224:225]
  v_mfma_f32_32x32x16_bf16 a[64:79], a[252:255], v[88:91], a[64:79]
  v_pk_mul_f32 v[232:233], v[232:233], v[224:225]
  v_pk_mul_f32 v[234:235], v[234:235], v[224:225]
  v_pk_mul_f32 v[236:237], v[236:237], v[224:225]
  v_cvt_pk_bf16_f32 v12, v230, v231
  v_cvt_pk_bf16_f32 v13, v232, v233
  v_mfma_f32_32x32x16_bf16 a[80:95], a[252:255], v[92:95], a[80:95]
  ds_read_b64_tr_b16 a[236:237], v244 offset:1024
  ds_read_b64_tr_b16 a[238:239], v244 offset:5120
  v_cvt_pk_bf16_f32 v14, v234, v235
  v_cvt_pk_bf16_f32 v15, v236, v237
  s_add_u32 s67, s63, 15360
  buffer_store_dwordx4 v[12:15], v252, s[44:47], s67 offen offset:0 sc1
  s_waitcnt lgkmcnt(6)
  v_mfma_f32_32x32x16_bf16 v[120:135], a[224:227], v[96:99], v[120:135]
  ds_read_b64_tr_b16 a[240:241], v243 offset:8192
  v_accvgpr_read_b32 v216, a112
  v_accvgpr_read_b32 v217, a113
  v_accvgpr_read_b32 v218, a114
  v_accvgpr_read_b32 v219, a115
  v_accvgpr_read_b32 v220, a116
  v_accvgpr_read_b32 v221, a117
  v_accvgpr_read_b32 v222, a118
  v_mfma_f32_32x32x16_bf16 v[136:151], a[224:227], v[100:103], v[136:151]
  ds_read_b64_tr_b16 a[242:243], v243 offset:12288
  v_accvgpr_read_b32 v223, a119
  v_pk_mul_f32 v[216:217], v[216:217], v[226:227]
  v_pk_mul_f32 v[218:219], v[218:219], v[226:227]
  v_pk_mul_f32 v[220:221], v[220:221], v[226:227]
  v_mfma_f32_32x32x16_bf16 v[152:167], a[224:227], v[104:107], v[152:167]
  v_pk_mul_f32 v[222:223], v[222:223], v[226:227]
  v_cvt_pk_bf16_f32 v4, v216, v217
  v_cvt_pk_bf16_f32 v5, v218, v219
  v_cvt_pk_bf16_f32 v6, v220, v221
  v_cvt_pk_bf16_f32 v7, v222, v223
  s_add_u32 s67, s63, 12288
  s_waitcnt lgkmcnt(6)
  v_mfma_f32_32x32x16_bf16 v[168:183], a[228:231], v[96:99], v[168:183]
  ds_read_b64_tr_b16 a[244:245], v244 offset:8192
  buffer_store_dwordx4 v[4:7], v252, s[44:47], s67 offen offset:1024 sc1
  v_accvgpr_read_b32 v230, a120
  v_accvgpr_read_b32 v231, a121
  v_accvgpr_read_b32 v232, a122
  v_accvgpr_read_b32 v233, a123
  v_mfma_f32_32x32x16_bf16 v[184:199], a[228:231], v[100:103], v[184:199]
  ds_read_b64_tr_b16 a[246:247], v244 offset:12288
  v_accvgpr_read_b32 v234, a124
  v_accvgpr_read_b32 v235, a125
  v_accvgpr_read_b32 v236, a126
  v_accvgpr_read_b32 v237, a127
  v_pk_mul_f32 v[230:231], v[230:231], v[226:227]
  v_mfma_f32_32x32x16_bf16 v[200:215], a[228:231], v[104:107], v[200:215]
  v_pk_mul_f32 v[232:233], v[232:233], v[226:227]
  v_pk_mul_f32 v[234:235], v[234:235], v[226:227]
  v_pk_mul_f32 v[236:237], v[236:237], v[226:227]
  v_cvt_pk_bf16_f32 v16, v230, v231
  v_cvt_pk_bf16_f32 v17, v232, v233
  s_waitcnt lgkmcnt(6)
  v_mfma_f32_32x32x16_bf16 a[0:15], a[232:235], v[96:99], a[0:15]
  ds_read_b64_tr_b16 a[248:249], v243 offset:9216
  v_cvt_pk_bf16_f32 v18, v234, v235
  v_cvt_pk_bf16_f32 v19, v236, v237
  s_add_u32 s67, s63, 15360
  buffer_store_dwordx4 v[16:19], v252, s[44:47], s67 offen offset:1024 sc1
  v_accvgpr_read_b32 v216, a128
  v_mfma_f32_32x32x16_bf16 a[16:31], a[232:235], v[100:103], a[16:31]
  ds_read_b64_tr_b16 a[250:251], v243 offset:13312
  v_accvgpr_read_b32 v217, a129
  v_accvgpr_read_b32 v218, a130
  v_accvgpr_read_b32 v219, a131
  v_accvgpr_read_b32 v220, a132
  v_accvgpr_read_b32 v221, a133
  v_accvgpr_read_b32 v222, a134
  v_accvgpr_read_b32 v223, a135
  v_mfma_f32_32x32x16_bf16 a[32:47], a[232:235], v[104:107], a[32:47]
  v_pk_mul_f32 v[216:217], v[216:217], v[228:229]
  v_pk_mul_f32 v[218:219], v[218:219], v[228:229]
  v_pk_mul_f32 v[220:221], v[220:221], v[228:229]
  v_pk_mul_f32 v[222:223], v[222:223], v[228:229]
  s_waitcnt lgkmcnt(6)
  v_mfma_f32_32x32x16_bf16 a[48:63], a[236:239], v[96:99], a[48:63]
  ds_read_b64_tr_b16 a[252:253], v244 offset:9216
  v_cvt_pk_bf16_f32 v8, v216, v217
  v_cvt_pk_bf16_f32 v9, v218, v219
  v_cvt_pk_bf16_f32 v10, v220, v221
  v_cvt_pk_bf16_f32 v11, v222, v223
  s_add_u32 s67, s63, 12288
  v_mfma_f32_32x32x16_bf16 a[64:79], a[236:239], v[100:103], a[64:79]
  ds_read_b64_tr_b16 a[254:255], v244 offset:13312
  buffer_store_dwordx4 v[8:11], v252, s[44:47], s67 offen offset:2048 sc1
  v_accvgpr_read_b32 v230, a136
  v_accvgpr_read_b32 v231, a137
  v_accvgpr_read_b32 v232, a138
  v_accvgpr_read_b32 v233, a139
  v_mfma_f32_32x32x16_bf16 a[80:95], a[236:239], v[104:107], a[80:95]
  v_accvgpr_read_b32 v234, a140
  v_accvgpr_read_b32 v235, a141
  v_accvgpr_read_b32 v236, a142
  v_accvgpr_read_b32 v237, a143
  v_pk_mul_f32 v[230:231], v[230:231], v[228:229]
  v_pk_mul_f32 v[232:233], v[232:233], v[228:229]
  s_waitcnt lgkmcnt(6)
  v_mfma_f32_32x32x16_bf16 v[120:135], a[240:243], v[108:111], v[120:135]
  v_pk_mul_f32 v[234:235], v[234:235], v[228:229]
  v_pk_mul_f32 v[236:237], v[236:237], v[228:229]
  v_cvt_pk_bf16_f32 v20, v230, v231
  v_cvt_pk_bf16_f32 v21, v232, v233
  v_cvt_pk_bf16_f32 v22, v234, v235
  v_cvt_pk_bf16_f32 v23, v236, v237
  v_mfma_f32_32x32x16_bf16 v[136:151], a[240:243], v[112:115], v[136:151]
  s_add_u32 s67, s63, 15360
  buffer_store_dwordx4 v[20:23], v252, s[44:47], s67 offen offset:2048 sc1
  v_accvgpr_read_b32 v216, a144
  v_accvgpr_read_b32 v217, a145
  v_accvgpr_read_b32 v218, a146
  v_accvgpr_read_b32 v219, a147
  v_mfma_f32_32x32x16_bf16 v[152:167], a[240:243], v[116:119], v[152:167]
  ds_read_b64_tr_b16 a[224:225], v243 offset:32896
  v_accvgpr_read_b32 v220, a148
  v_accvgpr_read_b32 v221, a149
  v_accvgpr_read_b32 v222, a150
  v_accvgpr_read_b32 v223, a151
  v_pk_mul_f32 v[216:217], v[216:217], v[224:225]
  s_waitcnt lgkmcnt(5)
  v_mfma_f32_32x32x16_bf16 v[168:183], a[244:247], v[108:111], v[168:183]
  ds_read_b64_tr_b16 a[226:227], v243 offset:36992
  v_pk_mul_f32 v[218:219], v[218:219], v[224:225]
  v_pk_mul_f32 v[220:221], v[220:221], v[224:225]
  v_pk_mul_f32 v[222:223], v[222:223], v[224:225]
  v_cvt_pk_bf16_f32 v24, v216, v217
  v_mfma_f32_32x32x16_bf16 v[184:199], a[244:247], v[112:115], v[184:199]
  s_waitcnt vmcnt(6)
  s_barrier
  s_or_b32 s66, s13, 0x20
  v_mov_b32 v242, s66
  buffer_store_dword v242, v255, s[4:7], s52 offen sc1
  v_cvt_pk_bf16_f32 v25, v218, v219
  v_cvt_pk_bf16_f32 v26, v220, v221
  v_mfma_f32_32x32x16_bf16 v[200:215], a[244:247], v[116:119], v[200:215]
  ds_read_b64_tr_b16 a[228:229], v244 offset:32896
  v_cvt_pk_bf16_f32 v27, v222, v223
  v_accvgpr_read_b32 v230, a152
  v_accvgpr_read_b32 v231, a153
  v_accvgpr_read_b32 v232, a154
  v_accvgpr_read_b32 v233, a155
  v_accvgpr_read_b32 v234, a156
  v_accvgpr_read_b32 v235, a157
  s_waitcnt lgkmcnt(5)
  v_mfma_f32_32x32x16_bf16 a[0:15], a[248:251], v[108:111], a[0:15]
  ds_read_b64_tr_b16 a[230:231], v244 offset:36992
  v_accvgpr_read_b32 v236, a158
  v_accvgpr_read_b32 v237, a159
  v_pk_mul_f32 v[230:231], v[230:231], v[224:225]
  v_pk_mul_f32 v[232:233], v[232:233], v[224:225]
  v_mfma_f32_32x32x16_bf16 a[16:31], a[248:251], v[112:115], a[16:31]
  v_pk_mul_f32 v[234:235], v[234:235], v[224:225]
  v_pk_mul_f32 v[236:237], v[236:237], v[224:225]
  v_cvt_pk_bf16_f32 v36, v230, v231
  v_cvt_pk_bf16_f32 v37, v232, v233
  v_cvt_pk_bf16_f32 v38, v234, v235
  v_cvt_pk_bf16_f32 v39, v236, v237
  v_mfma_f32_32x32x16_bf16 a[32:47], a[248:251], v[116:119], a[32:47]
  ds_read_b64_tr_b16 a[232:233], v243 offset:33920
  v_accvgpr_read_b32 v216, a160
  v_accvgpr_read_b32 v217, a161
  v_accvgpr_read_b32 v218, a162
  v_accvgpr_read_b32 v219, a163
  v_accvgpr_read_b32 v220, a164
  v_accvgpr_read_b32 v221, a165
  v_accvgpr_read_b32 v222, a166
  s_waitcnt lgkmcnt(5)
  v_mfma_f32_32x32x16_bf16 a[48:63], a[252:255], v[108:111], a[48:63]
  ds_read_b64_tr_b16 a[234:235], v243 offset:38016
  v_accvgpr_read_b32 v223, a167
  v_pk_mul_f32 v[216:217], v[216:217], v[226:227]
  v_pk_mul_f32 v[218:219], v[218:219], v[226:227]
  v_pk_mul_f32 v[220:221], v[220:221], v[226:227]
  v_mfma_f32_32x32x16_bf16 a[64:79], a[252:255], v[112:115], a[64:79]
  v_pk_mul_f32 v[222:223], v[222:223], v[226:227]
  v_cvt_pk_bf16_f32 v28, v216, v217
  v_cvt_pk_bf16_f32 v29, v218, v219
  v_cvt_pk_bf16_f32 v30, v220, v221
  v_cvt_pk_bf16_f32 v31, v222, v223
  v_accvgpr_read_b32 v230, a168
  v_accvgpr_read_b32 v231, a169
  v_mfma_f32_32x32x16_bf16 a[80:95], a[252:255], v[116:119], a[80:95]
  ds_read_b64_tr_b16 a[236:237], v244 offset:33920
  ds_read_b64_tr_b16 a[238:239], v244 offset:38016
  v_accvgpr_read_b32 v232, a170
  v_accvgpr_read_b32 v233, a171
  v_accvgpr_read_b32 v234, a172
  v_accvgpr_read_b32 v235, a173
  v_accvgpr_read_b32 v236, a174
  v_accvgpr_read_b32 v237, a175
  s_waitcnt lgkmcnt(6)
  v_mfma_f32_32x32x16_bf16 v[120:135], a[224:227], v[0:3], v[120:135]
  ds_read_b64_tr_b16 a[240:241], v243 offset:41088
  v_pk_mul_f32 v[230:231], v[230:231], v[226:227]
  v_pk_mul_f32 v[232:233], v[232:233], v[226:227]
  v_pk_mul_f32 v[234:235], v[234:235], v[226:227]
  v_mfma_f32_32x32x16_bf16 v[136:151], a[224:227], v[4:7], v[136:151]
  ds_read_b64_tr_b16 a[242:243], v243 offset:45184
  v_pk_mul_f32 v[236:237], v[236:237], v[226:227]
  v_cvt_pk_bf16_f32 v40, v230, v231
  v_cvt_pk_bf16_f32 v41, v232, v233
  v_cvt_pk_bf16_f32 v42, v234, v235
  v_cvt_pk_bf16_f32 v43, v236, v237
  v_accvgpr_read_b32 v216, a176
  v_mfma_f32_32x32x16_bf16 v[152:167], a[224:227], v[8:11], v[152:167]
  v_accvgpr_read_b32 v217, a177
  v_accvgpr_read_b32 v218, a178
  v_accvgpr_read_b32 v219, a179
  v_accvgpr_read_b32 v220, a180
  v_accvgpr_read_b32 v221, a181
  v_accvgpr_read_b32 v222, a182
  v_accvgpr_read_b32 v223, a183
  s_waitcnt lgkmcnt(6)
  v_mfma_f32_32x32x16_bf16 v[168:183], a[228:231], v[0:3], v[168:183]
  ds_read_b64_tr_b16 a[244:245], v244 offset:41088
  v_pk_mul_f32 v[216:217], v[216:217], v[228:229]
  v_pk_mul_f32 v[218:219], v[218:219], v[228:229]
  v_pk_mul_f32 v[220:221], v[220:221], v[228:229]
  v_mfma_f32_32x32x16_bf16 v[184:199], a[228:231], v[4:7], v[184:199]
  ds_read_b64_tr_b16 a[246:247], v244 offset:45184
  v_pk_mul_f32 v[222:223], v[222:223], v[228:229]
  v_cvt_pk_bf16_f32 v32, v216, v217
  v_cvt_pk_bf16_f32 v33, v218, v219
  v_cvt_pk_bf16_f32 v34, v220, v221
  v_cvt_pk_bf16_f32 v35, v222, v223
  v_accvgpr_read_b32 v230, a184
  v_mfma_f32_32x32x16_bf16 v[200:215], a[228:231], v[8:11], v[200:215]
  v_accvgpr_read_b32 v231, a185
  v_accvgpr_read_b32 v232, a186
  v_accvgpr_read_b32 v233, a187
  v_accvgpr_read_b32 v234, a188
  v_accvgpr_read_b32 v235, a189
  v_accvgpr_read_b32 v236, a190
  v_accvgpr_read_b32 v237, a191
  s_waitcnt lgkmcnt(6)
  v_mfma_f32_32x32x16_bf16 a[0:15], a[232:235], v[0:3], a[0:15]
  ds_read_b64_tr_b16 a[248:249], v243 offset:42112
  v_pk_mul_f32 v[230:231], v[230:231], v[228:229]
  v_pk_mul_f32 v[232:233], v[232:233], v[228:229]
  v_pk_mul_f32 v[234:235], v[234:235], v[228:229]
  v_mfma_f32_32x32x16_bf16 a[16:31], a[232:235], v[4:7], a[16:31]
  ds_read_b64_tr_b16 a[250:251], v243 offset:46208
  v_pk_mul_f32 v[236:237], v[236:237], v[228:229]
  v_cvt_pk_bf16_f32 v44, v230, v231
  v_cvt_pk_bf16_f32 v45, v232, v233
  v_cvt_pk_bf16_f32 v46, v234, v235
  v_cvt_pk_bf16_f32 v47, v236, v237
  v_mfma_f32_32x32x16_bf16 a[32:47], a[232:235], v[8:11], a[32:47]
  s_waitcnt lgkmcnt(6)
  v_mfma_f32_32x32x16_bf16 a[48:63], a[236:239], v[0:3], a[48:63]
  ds_read_b64_tr_b16 a[252:253], v244 offset:42112
  v_mfma_f32_32x32x16_bf16 a[64:79], a[236:239], v[4:7], a[64:79]
  ds_read_b64_tr_b16 a[254:255], v244 offset:46208
  s_add_u32 m0, s62, 0
  s_add_u32 s59, s58, 1024
  v_mfma_f32_32x32x16_bf16 a[80:95], a[236:239], v[8:11], a[80:95]
  buffer_load_dwordx4 v250, s[8:11], s59 offen offset:0 lds
  s_waitcnt lgkmcnt(6)
  v_mfma_f32_32x32x16_bf16 v[120:135], a[240:243], v[12:15], v[120:135]
  buffer_load_dword v241, v254, s[4:7], s53 offen sc1
  s_add_u32 s59, s58, 128
  v_mfma_f32_32x32x16_bf16 v[136:151], a[240:243], v[16:19], v[136:151]
  buffer_load_dwordx4 v250, s[8:11], s59 offen offset:1024 lds
  v_mfma_f32_32x32x16_bf16 v[152:167], a[240:243], v[20:23], v[152:167]
  ds_read_b64_tr_b16 a[224:225], v253 offset:16512
  s_add_u32 s59, s58, 1152
  s_waitcnt lgkmcnt(5)
  v_mfma_f32_32x32x16_bf16 v[168:183], a[244:247], v[12:15], v[168:183]
  buffer_load_dwordx4 v251, s[8:11], s59 offen offset:2048 lds
  ds_read_b64_tr_b16 a[226:227], v253 offset:20608
  v_mfma_f32_32x32x16_bf16 v[184:199], a[244:247], v[16:19], v[184:199]
  s_add_u32 s59, s58, 0
  v_mfma_f32_32x32x16_bf16 v[200:215], a[244:247], v[20:23], v[200:215]
  buffer_load_dwordx4 v251, s[8:11], s59 offen offset:3072 lds
  ds_read_b64_tr_b16 a[228:229], v240 offset:16512
  s_waitcnt lgkmcnt(5)
  v_mfma_f32_32x32x16_bf16 a[0:15], a[248:251], v[12:15], a[0:15]
  ds_read_b64_tr_b16 a[230:231], v240 offset:20608
  s_add_u32 m0, s62, 82304
  s_add_u32 s59, s56, 33792
  v_mfma_f32_32x32x16_bf16 a[16:31], a[248:251], v[16:19], a[16:31]
  buffer_load_dwordx4 v250, s[8:11], s59 offen offset:0 lds
  v_mfma_f32_32x32x16_bf16 a[32:47], a[248:251], v[20:23], a[32:47]
  ds_read_b64_tr_b16 a[232:233], v253 offset:17536
  s_add_u32 s59, s56, 32896
  s_waitcnt lgkmcnt(5)
  v_mfma_f32_32x32x16_bf16 a[48:63], a[252:255], v[12:15], a[48:63]
  buffer_load_dwordx4 v250, s[8:11], s59 offen offset:1024 lds
  ds_read_b64_tr_b16 a[234:235], v253 offset:21632
  v_mfma_f32_32x32x16_bf16 a[64:79], a[252:255], v[16:19], a[64:79]
  s_add_u32 s59, s56, 33920
  v_mfma_f32_32x32x16_bf16 a[80:95], a[252:255], v[20:23], a[80:95]
  buffer_load_dwordx4 v251, s[8:11], s59 offen offset:2048 lds
  ds_read_b64_tr_b16 a[236:237], v240 offset:17536
  ds_read_b64_tr_b16 a[238:239], v240 offset:21632
  s_mov_b32 s51, 0
  s_cmp_lg_u32 s3, 0
  s_cbranch_scc1 L1_goa
  L1_polla:
  s_waitcnt vmcnt(0)
  v_xor_b32 v241, s13, v241
  v_and_b32 v241, 0xffffff3f, v241
  v_cmp_eq_u32 vcc, 32, v241
  s_nop 3
  s_and_b32 s68, vcc_lo, s15
  s_cmp_eq_u32 s68, s15
  s_cbranch_scc1 L1_goa
  s_sleep 1
  buffer_load_dword v241, v254, s[4:7], s53 offen sc1
  s_add_u32 s51, s51, 1
  s_cmp_lt_u32 s51, 0x40000
  s_cbranch_scc1 L1_polla
  L1_goa:
  s_barrier
  s_waitcnt lgkmcnt(6)
  v_mfma_f32_32x32x16_bf16 v[120:135], a[224:227], v[24:27], v[120:135]
  ds_read_b64_tr_b16 a[240:241], v253 offset:24704
  s_add_u32 s59, s56, 32768
  v_mfma_f32_32x32x16_bf16 v[136:151], a[224:227], v[28:31], v[136:151]
  buffer_load_dwordx4 v251, s[8:11], s59 offen offset:3072 lds
  ds_read_b64_tr_b16 a[242:243], v253 offset:28800
  s_add_u32 s60, s64, 0
  v_mfma_f32_32x32x16_bf16 v[152:167], a[224:227], v[32:35], v[152:167]
  buffer_load_dwordx4 v[48:51], v252, s[44:47], s60 offen offset:0 sc1
  s_add_u32 m0, s62, 115200
  s_add_u32 s59, s57, 33792
  s_waitcnt lgkmcnt(6)
  v_mfma_f32_32x32x16_bf16 v[168:183], a[228:231], v[24:27], v[168:183]
  buffer_load_dwordx4 v250, s[8:11], s59 offen offset:0 lds
  ds_read_b64_tr_b16 a[244:245], v240 offset:24704
  v_mfma_f32_32x32x16_bf16 v[184:199], a[228:231], v[28:31], v[184:199]
  buffer_load_dwordx4 v[52:55], v252, s[44:47], s60 offen offset:1024 sc1
  ds_read_b64_tr_b16 a[246:247], v240 offset:28800
  s_add_u32 s59, s57, 32896
  v_mfma_f32_32x32x16_bf16 v[200:215], a[228:231], v[32:35], v[200:215]
  buffer_load_dwordx4 v250, s[8:11], s59 offen offset:1024 lds
  s_waitcnt lgkmcnt(6)
  v_mfma_f32_32x32x16_bf16 a[0:15], a[232:235], v[24:27], a[0:15]
  buffer_load_dwordx4 v[56:59], v252, s[44:47], s60 offen offset:2048 sc1
  ds_read_b64_tr_b16 a[248:249], v253 offset:25728
  s_add_u32 s59, s57, 33920
  v_mfma_f32_32x32x16_bf16 a[16:31], a[232:235], v[28:31], a[16:31]
  buffer_load_dwordx4 v251, s[8:11], s59 offen offset:2048 lds
  ds_read_b64_tr_b16 a[250:251], v253 offset:29824
  s_add_u32 s60, s64, 3072
  v_mfma_f32_32x32x16_bf16 a[32:47], a[232:235], v[32:35], a[32:47]
  buffer_load_dwordx4 v[60:63], v252, s[44:47], s60 offen offset:0 sc1
  s_add_u32 s59, s57, 32768
  s_waitcnt lgkmcnt(6)
  v_mfma_f32_32x32x16_bf16 a[48:63], a[236:239], v[24:27], a[48:63]
  buffer_load_dwordx4 v251, s[8:11], s59 offen offset:3072 lds
  ds_read_b64_tr_b16 a[252:253], v240 offset:25728
  v_mfma_f32_32x32x16_bf16 a[64:79], a[236:239], v[28:31], a[64:79]
  buffer_load_dwordx4 v[64:67], v252, s[44:47], s60 offen offset:1024 sc1
  ds_read_b64_tr_b16 a[254:255], v240 offset:29824
  v_mfma_f32_32x32x16_bf16 a[80:95], a[236:239], v[32:35], a[80:95]
  buffer_load_dwordx4 v[68:71], v252, s[44:47], s60 offen offset:2048 sc1
  s_add_u32 s60, s65, 0
  s_waitcnt lgkmcnt(6)
  v_mfma_f32_32x32x16_bf16 v[120:135], a[240:243], v[36:39], v[120:135]
  buffer_load_dwordx4 v[72:75], v252, s[44:47], s60 offen offset:0 sc1
  v_mfma_f32_32x32x16_bf16 v[136:151], a[240:243], v[40:43], v[136:151]
  buffer_load_dwordx4 v[76:79], v252, s[44:47], s60 offen offset:1024 sc1
  s_waitcnt lgkmcnt(0)
  s_barrier
  v_mfma_f32_32x32x16_bf16 v[152:167], a[240:243], v[44:47], v[152:167]
  buffer_load_dwordx4 v[80:83], v252, s[44:47], s60 offen offset:2048 sc1
  ds_read_b64_tr_b16 a[224:225], v245 offset:0
  s_add_u32 s60, s65, 3072
  v_mfma_f32_32x32x16_bf16 v[168:183], a[244:247], v[36:39], v[168:183]
  buffer_load_dwordx4 v[84:87], v252, s[44:47], s60 offen offset:0 sc1
  ds_read_b64_tr_b16 a[226:227], v245 offset:4096
  s_add_u32 m0, s62, 32896
  s_add_u32 s59, s58, 33792
  v_mfma_f32_32x32x16_bf16 v[184:199], a[244:247], v[40:43], v[184:199]
  buffer_load_dwordx4 v250, s[8:11], s59 offen offset:0 lds
  v_mfma_f32_32x32x16_bf16 v[200:215], a[244:247], v[44:47], v[200:215]
  buffer_load_dwordx4 v[88:91], v252, s[44:47], s60 offen offset:1024 sc1
  ds_read_b64_tr_b16 a[228:229], v246 offset:0
  v_mfma_f32_32x32x16_bf16 a[0:15], a[248:251], v[36:39], a[0:15]
  buffer_load_dwordx4 v[92:95], v252, s[44:47], s60 offen offset:2048 sc1
  ds_read_b64_tr_b16 a[230:231], v246 offset:4096
  s_add_u32 s67, s63, 18432
  v_mfma_f32_32x32x16_bf16 a[16:31], a[248:251], v[40:43], a[16:31]
  buffer_store_dwordx4 v[24:27], v252, s[44:47], s67 offen offset:0 sc1
  v_mfma_f32_32x32x16_bf16 a[32:47], a[248:251], v[44:47], a[32:47]
  ds_read_b64_tr_b16 a[232:233], v245 offset:1024
  s_add_u32 s67, s63, 21504
  v_mfma_f32_32x32x16_bf16 a[48:63], a[252:255], v[36:39], a[48:63]
  buffer_store_dwordx4 v[36:39], v252, s[44:47], s67 offen offset:0 sc1
  ds_read_b64_tr_b16 a[234:235], v245 offset:5120
  s_add_u32 s59, s58, 32896
  v_mfma_f32_32x32x16_bf16 a[64:79], a[252:255], v[40:43], a[64:79]
  buffer_load_dwordx4 v250, s[8:11], s59 offen offset:1024 lds
  s_add_u32 s67, s63, 18432
  v_mfma_f32_32x32x16_bf16 a[80:95], a[252:255], v[44:47], a[80:95]
  buffer_store_dwordx4 v[28:31], v252, s[44:47], s67 offen offset:1024 sc1
  ds_read_b64_tr_b16 a[236:237], v246 offset:1024
  ds_read_b64_tr_b16 a[238:239], v246 offset:5120
  s_waitcnt vmcnt(20) lgkmcnt(6)
  v_mfma_f32_32x32x16_bf16 v[120:135], a[224:227], v[48:51], v[120:135]
  ds_read_b64_tr_b16 a[240:241], v245 offset:8192
  s_add_u32 s67, s63, 21504
  s_waitcnt vmcnt(18)
  v_mfma_f32_32x32x16_bf16 v[136:151], a[224:227], v[52:55], v[136:151]
  buffer_store_dwordx4 v[40:43], v252, s[44:47], s67 offen offset:1024 sc1
  ds_read_b64_tr_b16 a[242:243], v245 offset:12288
  s_waitcnt vmcnt(17)
  v_mfma_f32_32x32x16_bf16 v[152:167], a[224:227], v[56:59], v[152:167]
  s_add_u32 s67, s63, 18432
  s_waitcnt lgkmcnt(6)
  v_mfma_f32_32x32x16_bf16 v[168:183], a[228:231], v[48:51], v[168:183]
  buffer_store_dwordx4 v[32:35], v252, s[44:47], s67 offen offset:2048 sc1
  ds_read_b64_tr_b16 a[244:245], v246 offset:8192
  s_add_u32 s59, s58, 33920
  v_mfma_f32_32x32x16_bf16 v[184:199], a[228:231], v[52:55], v[184:199]
  buffer_load_dwordx4 v251, s[8:11], s59 offen offset:2048 lds
  ds_read_b64_tr_b16 a[246:247], v246 offset:12288
  s_add_u32 s67, s63, 21504
  v_mfma_f32_32x32x16_bf16 v[200:215], a[228:231], v[56:59], v[200:215]
  buffer_store_dwordx4 v[44:47], v252, s[44:47], s67 offen offset:2048 sc1
  s_waitcnt lgkmcnt(6)
  v_mfma_f32_32x32x16_bf16 a[0:15], a[232:235], v[48:51], a[0:15]
  ds_read_b64_tr_b16 a[248:249], v245 offset:9216
  s_add_u32 s60, s70, 0
  v_mfma_f32_32x32x16_bf16 a[16:31], a[232:235], v[52:55], a[16:31]
  buffer_load_dwordx4 v[96:99], v252, s[44:47], s60 offen offset:0 sc1
  ds_read_b64_tr_b16 a[250:251], v245 offset:13312
  v_mfma_f32_32x32x16_bf16 a[32:47], a[232:235], v[56:59], a[32:47]
  s_waitcnt lgkmcnt(6)
  v_mfma_f32_32x32x16_bf16 a[48:63], a[236:239], v[48:51], a[48:63]
  ds_read_b64_tr_b16 a[252:253], v246 offset:9216
  s_add_u32 s59, s58, 32768
  v_mfma_f32_32x32x16_bf16 a[64:79], a[236:239], v[52:55], a[64:79]
  buffer_load_dwordx4 v251, s[8:11], s59 offen offset:3072 lds
  ds_read_b64_tr_b16 a[254:255], v246 offset:13312
  v_mfma_f32_32x32x16_bf16 a[80:95], a[236:239], v[56:59], a[80:95]
  buffer_load_dwordx4 v[100:103], v252, s[44:47], s60 offen offset:1024 sc1
  s_waitcnt vmcnt(21) lgkmcnt(6)
  v_mfma_f32_32x32x16_bf16 v[120:135], a[240:243], v[60:63], v[120:135]
  s_waitcnt vmcnt(19)
  v_mfma_f32_32x32x16_bf16 v[136:151], a[240:243], v[64:67], v[136:151]
  s_waitcnt vmcnt(18)
  v_mfma_f32_32x32x16_bf16 v[152:167], a[240:243], v[68:71], v[152:167]
  buffer_load_dwordx4 v[104:107], v252, s[44:47], s60 offen offset:2048 sc1
  ds_read_b64_tr_b16 a[224:225], v253 offset:49408
  s_waitcnt lgkmcnt(5)
  v_mfma_f32_32x32x16_bf16 v[168:183], a[244:247], v[60:63], v[168:183]
  ds_read_b64_tr_b16 a[226:227], v253 offset:53504
  s_add_u32 m0, s62, 65792
  s_add_u32 s59, s56, 66560
  v_mfma_f32_32x32x16_bf16 v[184:199], a[244:247], v[64:67], v[184:199]
  buffer_load_dwordx4 v250, s[8:11], s59 offen offset:0 lds
  s_add_u32 s60, s70, 3072
  v_mfma_f32_32x32x16_bf16 v[200:215], a[244:247], v[68:71], v[200:215]
  buffer_load_dwordx4 v[108:111], v252, s[44:47], s60 offen offset:0 sc1
  ds_read_b64_tr_b16 a[228:229], v240 offset:49408
  s_waitcnt lgkmcnt(5)
  v_mfma_f32_32x32x16_bf16 a[0:15], a[248:251], v[60:63], a[0:15]
  ds_read_b64_tr_b16 a[230:231], v240 offset:53504
  v_mfma_f32_32x32x16_bf16 a[16:31], a[248:251], v[64:67], a[16:31]
  v_mfma_f32_32x32x16_bf16 a[32:47], a[248:251], v[68:71], a[32:47]
  buffer_load_dwordx4 v[112:115], v252, s[44:47], s60 offen offset:1024 sc1
  ds_read_b64_tr_b16 a[232:233], v253 offset:50432
  s_waitcnt lgkmcnt(5)
  v_mfma_f32_32x32x16_bf16 a[48:63], a[252:255], v[60:63], a[48:63]
  ds_read_b64_tr_b16 a[234:235], v253 offset:54528
  s_add_u32 s59, s56, 65664
  v_mfma_f32_32x32x16_bf16 a[64:79], a[252:255], v[64:67], a[64:79]
  buffer_load_dwordx4 v250, s[8:11], s59 offen offset:1024 lds
  v_mfma_f32_32x32x16_bf16 a[80:95], a[252:255], v[68:71], a[80:95]
  buffer_load_dwordx4 v[116:119], v252, s[44:47], s60 offen offset:2048 sc1
  ds_read_b64_tr_b16 a[236:237], v240 offset:50432
  ds_read_b64_tr_b16 a[238:239], v240 offset:54528
  s_waitcnt vmcnt(23) lgkmcnt(6)
  v_mfma_f32_32x32x16_bf16 v[120:135], a[224:227], v[72:75], v[120:135]
  ds_read_b64_tr_b16 a[240:241], v253 offset:57600
  s_waitcnt vmcnt(22)
  v_mfma_f32_32x32x16_bf16 v[136:151], a[224:227], v[76:79], v[136:151]
  ds_read_b64_tr_b16 a[242:243], v253 offset:61696
  s_add_u32 s60, s64, 6144
  s_waitcnt vmcnt(21)
  v_mfma_f32_32x32x16_bf16 v[152:167], a[224:227], v[80:83], v[152:167]
  buffer_load_dwordx4 v[0:3], v252, s[44:47], s60 offen offset:0 sc1
  s_waitcnt lgkmcnt(6)
  v_mfma_f32_32x32x16_bf16 v[168:183], a[228:231], v[72:75], v[168:183]
  ds_read_b64_tr_b16 a[244:245], v240 offset:57600
  s_add_u32 s59, s56, 66688
  v_mfma_f32_32x32x16_bf16 v[184:199], a[228:231], v[76:79], v[184:199]
  buffer_load_dwordx4 v251, s[8:11], s59 offen offset:2048 lds
  ds_read_b64_tr_b16 a[246:247], v240 offset:61696
  v_mfma_f32_32x32x16_bf16 v[200:215], a[228:231], v[80:83], v[200:215]
  buffer_load_dwordx4 v[4:7], v252, s[44:47], s60 offen offset:1024 sc1
  s_waitcnt lgkmcnt(6)
  v_mfma_f32_32x32x16_bf16 a[0:15], a[232:235], v[72:75], a[0:15]
  ds_read_b64_tr_b16 a[248:249], v253 offset:58624
  v_mfma_f32_32x32x16_bf16 a[16:31], a[232:235], v[76:79], a[16:31]
  ds_read_b64_tr_b16 a[250:251], v253 offset:62720
  v_mfma_f32_32x32x16_bf16 a[32:47], a[232:235], v[80:83], a[32:47]
  buffer_load_dwordx4 v[8:11], v252, s[44:47], s60 offen offset:2048 sc1
  s_waitcnt lgkmcnt(6)
  v_mfma_f32_32x32x16_bf16 a[48:63], a[236:239], v[72:75], a[48:63]
  ds_read_b64_tr_b16 a[252:253], v240 offset:58624
  s_add_u32 s59, s56, 65536
  v_mfma_f32_32x32x16_bf16 a[64:79], a[236:239], v[76:79], a[64:79]
  buffer_load_dwordx4 v251, s[8:11], s59 offen offset:3072 lds
  ds_read_b64_tr_b16 a[254:255], v240 offset:62720
  s_add_u32 s60, s64, 9216
  v_mfma_f32_32x32x16_bf16 a[80:95], a[236:239], v[80:83], a[80:95]
  buffer_load_dwordx4 v[12:15], v252, s[44:47], s60 offen offset:0 sc1
  s_waitcnt vmcnt(26) lgkmcnt(6)
  v_mfma_f32_32x32x16_bf16 v[120:135], a[240:243], v[84:87], v[120:135]
  s_waitcnt vmcnt(24)
  v_mfma_f32_32x32x16_bf16 v[136:151], a[240:243], v[88:91], v[136:151]
  s_waitcnt lgkmcnt(0)
  s_waitcnt vmcnt(15)
  s_barrier
  s_or_b32 s66, s13, 0x60
  v_mov_b32 v242, s66
  buffer_store_dword v242, v255, s[4:7], s52 offen sc1
  v_mfma_f32_32x32x16_bf16 v[152:167], a[240:243], v[92:95], v[152:167]
  buffer_load_dwordx4 v[16:19], v252, s[44:47], s60 offen offset:1024 sc1
  ds_read_b64_tr_b16 a[224:225], v253 offset:0
  v_mfma_f32_32x32x16_bf16 v[168:183], a[244:247], v[84:87], v[168:183]
  ds_read_b64_tr_b16 a[226:227], v253 offset:4096
  s_add_u32 m0, s62, 98688
  s_add_u32 s59, s57, 66560
  v_mfma_f32_32x32x16_bf16 v[184:199], a[244:247], v[88:91], v[184:199]
  buffer_load_dwordx4 v250, s[8:11], s59 offen offset:0 lds
  v_mfma_f32_32x32x16_bf16 v[200:215], a[244:247], v[92:95], v[200:215]
  buffer_load_dwordx4 v[20:23], v252, s[44:47], s60 offen offset:2048 sc1
  ds_read_b64_tr_b16 a[228:229], v240 offset:0
  v_mfma_f32_32x32x16_bf16 a[0:15], a[248:251], v[84:87], a[0:15]
  ds_read_b64_tr_b16 a[230:231], v240 offset:4096
  v_mfma_f32_32x32x16_bf16 a[16:31], a[248:251], v[88:91], a[16:31]
  s_add_u32 s60, s65, 6144
  v_mfma_f32_32x32x16_bf16 a[32:47], a[248:251], v[92:95], a[32:47]
  buffer_load_dwordx4 v[24:27], v252, s[44:47], s60 offen offset:0 sc1
  ds_read_b64_tr_b16 a[232:233], v253 offset:1024
  v_mfma_f32_32x32x16_bf16 a[48:63], a[252:255], v[84:87], a[48:63]
  ds_read_b64_tr_b16 a[234:235], v253 offset:5120
  s_add_u32 s59, s57, 65664
  v_mfma_f32_32x32x16_bf16 a[64:79], a[252:255], v[88:91], a[64:79]
  buffer_load_dwordx4 v250, s[8:11], s59 offen offset:1024 lds
  v_mfma_f32_32x32x16_bf16 a[80:95], a[252:255], v[92:95], a[80:95]
  buffer_load_dwordx4 v[28:31], v252, s[44:47], s60 offen offset:1024 sc1
  ds_read_b64_tr_b16 a[236:237], v240 offset:1024
  ds_read_b64_tr_b16 a[238:239], v240 offset:5120
  s_waitcnt vmcnt(21) lgkmcnt(6)
  v_mfma_f32_32x32x16_bf16 v[120:135], a[224:227], v[96:99], v[120:135]
  ds_read_b64_tr_b16 a[240:241], v253 offset:8192
  s_waitcnt vmcnt(19)
  v_mfma_f32_32x32x16_bf16 v[136:151], a[224:227], v[100:103], v[136:151]
  ds_read_b64_tr_b16 a[242:243], v253 offset:12288
  s_waitcnt vmcnt(18)
  v_mfma_f32_32x32x16_bf16 v[152:167], a[224:227], v[104:107], v[152:167]
  buffer_load_dwordx4 v[32:35], v252, s[44:47], s60 offen offset:2048 sc1
  s_waitcnt lgkmcnt(6)
  v_mfma_f32_32x32x16_bf16 v[168:183], a[228:231], v[96:99], v[168:183]
  ds_read_b64_tr_b16 a[244:245], v240 offset:8192
  s_add_u32 s59, s57, 66688
  v_mfma_f32_32x32x16_bf16 v[184:199], a[228:231], v[100:103], v[184:199]
  buffer_load_dwordx4 v251, s[8:11], s59 offen offset:2048 lds
  ds_read_b64_tr_b16 a[246:247], v240 offset:12288
  s_add_u32 s60, s65, 9216
  v_mfma_f32_32x32x16_bf16 v[200:215], a[228:231], v[104:107], v[200:215]
  buffer_load_dwordx4 v[36:39], v252, s[44:47], s60 offen offset:0 sc1
  s_waitcnt lgkmcnt(6)
  v_mfma_f32_32x32x16_bf16 a[0:15], a[232:235], v[96:99], a[0:15]
  ds_read_b64_tr_b16 a[248:249], v253 offset:9216
  v_mfma_f32_32x32x16_bf16 a[16:31], a[232:235], v[100:103], a[16:31]
  ds_read_b64_tr_b16 a[250:251], v253 offset:13312
  v_mfma_f32_32x32x16_bf16 a[32:47], a[232:235], v[104:107], a[32:47]
  buffer_load_dwordx4 v[40:43], v252, s[44:47], s60 offen offset:1024 sc1
  s_waitcnt lgkmcnt(6)
  v_mfma_f32_32x32x16_bf16 a[48:63], a[236:239], v[96:99], a[48:63]
  ds_read_b64_tr_b16 a[252:253], v240 offset:9216
  s_add_u32 s59, s57, 65536
  v_mfma_f32_32x32x16_bf16 a[64:79], a[236:239], v[100:103], a[64:79]
  buffer_load_dwordx4 v251, s[8:11], s59 offen offset:3072 lds
  ds_read_b64_tr_b16 a[254:255], v240 offset:13312
  v_mfma_f32_32x32x16_bf16 a[80:95], a[236:239], v[104:107], a[80:95]
  buffer_load_dwordx4 v[44:47], v252, s[44:47], s60 offen offset:2048 sc1
  s_waitcnt vmcnt(22) lgkmcnt(6)
  v_mfma_f32_32x32x16_bf16 v[120:135], a[240:243], v[108:111], v[120:135]
  buffer_load_dword v241, v254, s[4:7], s53 offen sc1
  s_waitcnt vmcnt(22)
  v_mfma_f32_32x32x16_bf16 v[136:151], a[240:243], v[112:115], v[136:151]
  s_add_u32 s60, s70, 6144
  s_waitcnt vmcnt(20)
  v_mfma_f32_32x32x16_bf16 v[152:167], a[240:243], v[116:119], v[152:167]
  buffer_load_dwordx4 v[48:51], v252, s[44:47], s60 offen offset:0 sc1
  ds_read_b64_tr_b16 a[224:225], v243 offset:16512
  s_waitcnt lgkmcnt(5)
  v_mfma_f32_32x32x16_bf16 v[168:183], a[244:247], v[108:111], v[168:183]
  ds_read_b64_tr_b16 a[226:227], v243 offset:20608
  s_add_u32 m0, s62, 16512
  s_add_u32 s59, s58, 66560
  v_mfma_f32_32x32x16_bf16 v[184:199], a[244:247], v[112:115], v[184:199]
  buffer_load_dwordx4 v250, s[8:11], s59 offen offset:0 lds
  v_mfma_f32_32x32x16_bf16 v[200:215], a[244:247], v[116:119], v[200:215]
  buffer_load_dwordx4 v[52:55], v252, s[44:47], s60 offen offset:1024 sc1
  ds_read_b64_tr_b16 a[228:229], v244 offset:16512
  s_waitcnt lgkmcnt(5)
  v_mfma_f32_32x32x16_bf16 a[0:15], a[248:251], v[108:111], a[0:15]
  ds_read_b64_tr_b16 a[230:231], v244 offset:20608
  v_mfma_f32_32x32x16_bf16 a[16:31], a[248:251], v[112:115], a[16:31]
  v_mfma_f32_32x32x16_bf16 a[32:47], a[248:251], v[116:119], a[32:47]
  buffer_load_dwordx4 v[56:59], v252, s[44:47], s60 offen offset:2048 sc1
  ds_read_b64_tr_b16 a[232:233], v243 offset:17536
  s_waitcnt lgkmcnt(5)
  v_mfma_f32_32x32x16_bf16 a[48:63], a[252:255], v[108:111], a[48:63]
  ds_read_b64_tr_b16 a[234:235], v243 offset:21632
  s_add_u32 s59, s58, 65664
  v_mfma_f32_32x32x16_bf16 a[64:79], a[252:255], v[112:115], a[64:79]
  buffer_load_dwordx4 v250, s[8:11], s59 offen offset:1024 lds
  s_add_u32 s60, s70, 9216
  v_mfma_f32_32x32x16_bf16 a[80:95], a[252:255], v[116:119], a[80:95]
  buffer_load_dwordx4 v[60:63], v252, s[44:47], s60 offen offset:0 sc1
  ds_read_b64_tr_b16 a[236:237], v244 offset:17536
  ds_read_b64_tr_b16 a[238:239], v244 offset:21632
  s_mov_b32 s51, 0
  s_cmp_lg_u32 s3, 0
  s_cbranch_scc1 L1_gob
  L1_pollb:
  s_waitcnt vmcnt(0)
  v_xor_b32 v241, s13, v241
  v_and_b32 v241, 0xffffff5f, v241
  v_cmp_eq_u32 vcc, 64, v241
  s_nop 3
  s_and_b32 s68, vcc_lo, s15
  s_cmp_eq_u32 s68, s15
  s_cbranch_scc1 L1_gob
  s_sleep 1
  buffer_load_dword v241, v254, s[4:7], s53 offen sc1
  s_add_u32 s51, s51, 1
  s_cmp_lt_u32 s51, 0x40000
  s_cbranch_scc1 L1_pollb
  L1_gob:
  s_barrier
  s_waitcnt vmcnt(25) lgkmcnt(6)
  v_mfma_f32_32x32x16_bf16 v[120:135], a[224:227], v[0:3], v[120:135]
  ds_read_b64_tr_b16 a[240:241], v243 offset:24704
  s_waitcnt vmcnt(23)
  v_mfma_f32_32x32x16_bf16 v[136:151], a[224:227], v[4:7], v[136:151]
  ds_read_b64_tr_b16 a[242:243], v243 offset:28800
  s_waitcnt vmcnt(22)
  v_mfma_f32_32x32x16_bf16 v[152:167], a[224:227], v[8:11], v[152:167]
  buffer_load_dwordx4 v[64:67], v252, s[44:47], s60 offen offset:1024 sc1
  s_waitcnt lgkmcnt(6)
  v_mfma_f32_32x32x16_bf16 v[168:183], a[228:231], v[0:3], v[168:183]
  ds_read_b64_tr_b16 a[244:245], v244 offset:24704
  s_add_u32 s59, s58, 66688
  v_mfma_f32_32x32x16_bf16 v[184:199], a[228:231], v[4:7], v[184:199]
  buffer_load_dwordx4 v251, s[8:11], s59 offen offset:2048 lds
  ds_read_b64_tr_b16 a[246:247], v244 offset:28800
  v_mfma_f32_32x32x16_bf16 v[200:215], a[228:231], v[8:11], v[200:215]
  buffer_load_dwordx4 v[68:71], v252, s[44:47], s60 offen offset:2048 sc1
  s_waitcnt lgkmcnt(6)
  v_mfma_f32_32x32x16_bf16 a[0:15], a[232:235], v[0:3], a[0:15]
  ds_read_b64_tr_b16 a[248:249], v243 offset:25728
  v_mfma_f32_32x32x16_bf16 a[16:31], a[232:235], v[4:7], a[16:31]
  ds_read_b64_tr_b16 a[250:251], v243 offset:29824
  s_add_u32 s60, s64, 12288
  v_mfma_f32_32x32x16_bf16 a[32:47], a[232:235], v[8:11], a[32:47]
  buffer_load_dwordx4 v[72:75], v252, s[44:47], s60 offen offset:0 sc1
  s_waitcnt lgkmcnt(6)
  v_mfma_f32_32x32x16_bf16 a[48:63], a[236:239], v[0:3], a[48:63]
  ds_read_b64_tr_b16 a[252:253], v244 offset:25728
  s_add_u32 s59, s58, 65536
  v_mfma_f32_32x32x16_bf16 a[64:79], a[236:239], v[4:7], a[64:79]
  buffer_load_dwordx4 v251, s[8:11], s59 offen offset:3072 lds
  ds_read_b64_tr_b16 a[254:255], v244 offset:29824
  v_mfma_f32_32x32x16_bf16 a[80:95], a[236:239], v[8:11], a[80:95]
  buffer_load_dwordx4 v[76:79], v252, s[44:47], s60 offen offset:1024 sc1
  s_waitcnt vmcnt(26) lgkmcnt(6)
  v_mfma_f32_32x32x16_bf16 v[120:135], a[240:243], v[12:15], v[120:135]
  s_waitcnt vmcnt(24)
  v_mfma_f32_32x32x16_bf16 v[136:151], a[240:243], v[16:19], v[136:151]
  s_waitcnt lgkmcnt(0)
  s_barrier
  s_waitcnt vmcnt(22)
  v_mfma_f32_32x32x16_bf16 v[152:167], a[240:243], v[20:23], v[152:167]
  buffer_load_dwordx4 v[80:83], v252, s[44:47], s60 offen offset:2048 sc1
  ds_read_b64_tr_b16 a[224:225], v243 offset:49408
  v_mfma_f32_32x32x16_bf16 v[168:183], a[244:247], v[12:15], v[168:183]
  ds_read_b64_tr_b16 a[226:227], v243 offset:53504
  s_add_u32 m0, s62, 131584
  s_add_u32 s59, s56, 99328
  v_mfma_f32_32x32x16_bf16 v[184:199], a[244:247], v[16:19], v[184:199]
  buffer_load_dwordx4 v250, s[8:11], s59 offen offset:0 lds
  s_add_u32 s60, s64, 15360
  v_mfma_f32_32x32x16_bf16 v[200:215], a[244:247], v[20:23], v[200:215]
  buffer_load_dwordx4 v[84:87], v252, s[44:47], s60 offen offset:0 sc1
  ds_read_b64_tr_b16 a[228:229], v244 offset:49408
  v_mfma_f32_32x32x16_bf16 a[0:15], a[248:251], v[12:15], a[0:15]
  ds_read_b64_tr_b16 a[230:231], v244 offset:53504
  v_mfma_f32_32x32x16_bf16 a[16:31], a[248:251], v[16:19], a[16:31]
  v_mfma_f32_32x32x16_bf16 a[32:47], a[248:251], v[20:23], a[32:47]
  buffer_load_dwordx4 v[88:91], v252, s[44:47], s60 offen offset:1024 sc1
  ds_read_b64_tr_b16 a[232:233], v243 offset:50432
  v_mfma_f32_32x32x16_bf16 a[48:63], a[252:255], v[12:15], a[48:63]
  ds_read_b64_tr_b16 a[234:235], v243 offset:54528
  s_add_u32 s59, s56, 98432
  v_mfma_f32_32x32x16_bf16 a[64:79], a[252:255], v[16:19], a[64:79]
  buffer_load_dwordx4 v250, s[8:11], s59 offen offset:1024 lds
  v_mfma_f32_32x32x16_bf16 a[80:95], a[252:255], v[20:23], a[80:95]
  buffer_load_dwordx4 v[92:95], v252, s[44:47], s60 offen offset:2048 sc1
  ds_read_b64_tr_b16 a[236:237], v244 offset:50432
  ds_read_b64_tr_b16 a[238:239], v244 offset:54528
  s_waitcnt vmcnt(27) lgkmcnt(6)
  v_mfma_f32_32x32x16_bf16 v[120:135], a[224:227], v[24:27], v[120:135]
  ds_read_b64_tr_b16 a[240:241], v243 offset:57600
  s_waitcnt vmcnt(25)
  v_mfma_f32_32x32x16_bf16 v[136:151], a[224:227], v[28:31], v[136:151]
  ds_read_b64_tr_b16 a[242:243], v243 offset:61696
  s_add_u32 s60, s65, 12288
  s_waitcnt vmcnt(24)
  v_mfma_f32_32x32x16_bf16 v[152:167], a[224:227], v[32:35], v[152:167]
  buffer_load_dwordx4 v[96:99], v252, s[44:47], s60 offen offset:0 sc1
  s_waitcnt lgkmcnt(6)
  v_mfma_f32_32x32x16_bf16 v[168:183], a[228:231], v[24:27], v[168:183]
  ds_read_b64_tr_b16 a[244:245], v244 offset:57600
  s_add_u32 s59, s56, 99456
  v_mfma_f32_32x32x16_bf16 v[184:199], a[228:231], v[28:31], v[184:199]
  buffer_load_dwordx4 v251, s[8:11], s59 offen offset:2048 lds
  ds_read_b64_tr_b16 a[246:247], v244 offset:61696
  v_mfma_f32_32x32x16_bf16 v[200:215], a[228:231], v[32:35], v[200:215]
  buffer_load_dwordx4 v[100:103], v252, s[44:47], s60 offen offset:1024 sc1
  s_waitcnt lgkmcnt(6)
  v_mfma_f32_32x32x16_bf16 a[0:15], a[232:235], v[24:27], a[0:15]
  ds_read_b64_tr_b16 a[248:249], v243 offset:58624
  v_mfma_f32_32x32x16_bf16 a[16:31], a[232:235], v[28:31], a[16:31]
  ds_read_b64_tr_b16 a[250:251], v243 offset:62720
  v_mfma_f32_32x32x16_bf16 a[32:47], a[232:235], v[32:35], a[32:47]
  buffer_load_dwordx4 v[104:107], v252, s[44:47], s60 offen offset:2048 sc1
  s_waitcnt lgkmcnt(6)
  v_mfma_f32_32x32x16_bf16 a[48:63], a[236:239], v[24:27], a[48:63]
  ds_read_b64_tr_b16 a[252:253], v244 offset:58624
  s_add_u32 s59, s56, 98304
  v_mfma_f32_32x32x16_bf16 a[64:79], a[236:239], v[28:31], a[64:79]
  buffer_load_dwordx4 v251, s[8:11], s59 offen offset:3072 lds
  ds_read_b64_tr_b16 a[254:255], v244 offset:62720
  s_add_u32 s60, s65, 15360
  v_mfma_f32_32x32x16_bf16 a[80:95], a[236:239], v[32:35], a[80:95]
  buffer_load_dwordx4 v[108:111], v252, s[44:47], s60 offen offset:0 sc1
  s_waitcnt vmcnt(28) lgkmcnt(6)
  v_mfma_f32_32x32x16_bf16 v[120:135], a[240:243], v[36:39], v[120:135]
  s_waitcnt vmcnt(27)
  v_mfma_f32_32x32x16_bf16 v[136:151], a[240:243], v[40:43], v[136:151]
  s_waitcnt vmcnt(25)
  v_mfma_f32_32x32x16_bf16 v[152:167], a[240:243], v[44:47], v[152:167]
  buffer_load_dwordx4 v[112:115], v252, s[44:47], s60 offen offset:1024 sc1
  ds_read_b64_tr_b16 a[224:225], v253 offset:32896
  s_waitcnt lgkmcnt(5)
  v_mfma_f32_32x32x16_bf16 v[168:183], a[244:247], v[36:39], v[168:183]
  ds_read_b64_tr_b16 a[226:227], v253 offset:36992
  s_add_u32 m0, s62, 49408
  s_add_u32 s59, s57, 99328
  v_mfma_f32_32x32x16_bf16 v[184:199], a[244:247], v[40:43], v[184:199]
  buffer_load_dwordx4 v250, s[8:11], s59 offen offset:0 lds
  v_mfma_f32_32x32x16_bf16 v[200:215], a[244:247], v[44:47], v[200:215]
  buffer_load_dwordx4 v[116:119], v252, s[44:47], s60 offen offset:2048 sc1
  ds_read_b64_tr_b16 a[228:229], v240 offset:32896
  s_waitcnt lgkmcnt(5)
  v_mfma_f32_32x32x16_bf16 a[0:15], a[248:251], v[36:39], a[0:15]
  ds_read_b64_tr_b16 a[230:231], v240 offset:36992
  v_mfma_f32_32x32x16_bf16 a[16:31], a[248:251], v[40:43], a[16:31]
  s_add_u32 s60, s70, 12288
  v_mfma_f32_32x32x16_bf16 a[32:47], a[248:251], v[44:47], a[32:47]
  buffer_load_dwordx4 v[0:3], v252, s[44:47], s60 offen offset:0 sc1
  ds_read_b64_tr_b16 a[232:233], v253 offset:33920
  s_waitcnt lgkmcnt(5)
  v_mfma_f32_32x32x16_bf16 a[48:63], a[252:255], v[36:39], a[48:63]
  ds_read_b64_tr_b16 a[234:235], v253 offset:38016
  s_add_u32 s59, s57, 98432
  v_mfma_f32_32x32x16_bf16 a[64:79], a[252:255], v[40:43], a[64:79]
  buffer_load_dwordx4 v250, s[8:11], s59 offen offset:1024 lds
  v_mfma_f32_32x32x16_bf16 a[80:95], a[252:255], v[44:47], a[80:95]
  buffer_load_dwordx4 v[4:7], v252, s[44:47], s60 offen offset:1024 sc1
  ds_read_b64_tr_b16 a[236:237], v240 offset:33920
  ds_read_b64_tr_b16 a[238:239], v240 offset:38016
  s_waitcnt vmcnt(29) lgkmcnt(6)
  v_mfma_f32_32x32x16_bf16 v[120:135], a[224:227], v[48:51], v[120:135]
  ds_read_b64_tr_b16 a[240:241], v253 offset:41088
  s_waitcnt vmcnt(27)
  v_mfma_f32_32x32x16_bf16 v[136:151], a[224:227], v[52:55], v[136:151]
  ds_read_b64_tr_b16 a[242:243], v253 offset:45184
  s_waitcnt vmcnt(26)
  v_mfma_f32_32x32x16_bf16 v[152:167], a[224:227], v[56:59], v[152:167]
  buffer_load_dwordx4 v[8:11], v252, s[44:47], s60 offen offset:2048 sc1
  s_waitcnt lgkmcnt(6)
  v_mfma_f32_32x32x16_bf16 v[168:183], a[228:231], v[48:51], v[168:183]
  ds_read_b64_tr_b16 a[244:245], v240 offset:41088
  s_add_u32 s59, s57, 99456
  v_mfma_f32_32x32x16_bf16 v[184:199], a[228:231], v[52:55], v[184:199]
  buffer_load_dwordx4 v251, s[8:11], s59 offen offset:2048 lds
  ds_read_b64_tr_b16 a[246:247], v240 offset:45184
  s_add_u32 s60, s70, 15360
  v_mfma_f32_32x32x16_bf16 v[200:215], a[228:231], v[56:59], v[200:215]
  buffer_load_dwordx4 v[12:15], v252, s[44:47], s60 offen offset:0 sc1
  s_waitcnt lgkmcnt(6)
  v_mfma_f32_32x32x16_bf16 a[0:15], a[232:235], v[48:51], a[0:15]
  ds_read_b64_tr_b16 a[248:249], v253 offset:42112
  v_mfma_f32_32x32x16_bf16 a[16:31], a[232:235], v[52:55], a[16:31]
  ds_read_b64_tr_b16 a[250:251], v253 offset:46208
  v_mfma_f32_32x32x16_bf16 a[32:47], a[232:235], v[56:59], a[32:47]
  buffer_load_dwordx4 v[16:19], v252, s[44:47], s60 offen offset:1024 sc1
  s_waitcnt lgkmcnt(6)
  v_mfma_f32_32x32x16_bf16 a[48:63], a[236:239], v[48:51], a[48:63]
  ds_read_b64_tr_b16 a[252:253], v240 offset:42112
  s_add_u32 s59, s57, 98304
  v_mfma_f32_32x32x16_bf16 a[64:79], a[236:239], v[52:55], a[64:79]
  buffer_load_dwordx4 v251, s[8:11], s59 offen offset:3072 lds
  ds_read_b64_tr_b16 a[254:255], v240 offset:46208
  v_mfma_f32_32x32x16_bf16 a[80:95], a[236:239], v[56:59], a[80:95]
  buffer_load_dwordx4 v[20:23], v252, s[44:47], s60 offen offset:2048 sc1
  s_waitcnt vmcnt(30) lgkmcnt(6)
  v_mfma_f32_32x32x16_bf16 v[120:135], a[240:243], v[60:63], v[120:135]
  s_waitcnt vmcnt(29)
  v_mfma_f32_32x32x16_bf16 v[136:151], a[240:243], v[64:67], v[136:151]
  s_waitcnt lgkmcnt(0)
  s_barrier
  s_add_u32 s60, s64, 18432
  s_waitcnt vmcnt(27)
  v_mfma_f32_32x32x16_bf16 v[152:167], a[240:243], v[68:71], v[152:167]
  buffer_load_dwordx4 v[24:27], v252, s[44:47], s60 offen offset:0 sc1
  ds_read_b64_tr_b16 a[224:225], v243 offset:0
  v_mfma_f32_32x32x16_bf16 v[168:183], a[244:247], v[60:63], v[168:183]
  ds_read_b64_tr_b16 a[226:227], v243 offset:4096
  s_add_u32 m0, s62, 0
  s_add_u32 s59, s58, 99328
  v_mfma_f32_32x32x16_bf16 v[184:199], a[244:247], v[64:67], v[184:199]
  buffer_load_dwordx4 v250, s[8:11], s59 offen offset:0 lds
  v_mfma_f32_32x32x16_bf16 v[200:215], a[244:247], v[68:71], v[200:215]
  buffer_load_dwordx4 v[28:31], v252, s[44:47], s60 offen offset:1024 sc1
  ds_read_b64_tr_b16 a[228:229], v244 offset:0
  v_mfma_f32_32x32x16_bf16 a[0:15], a[248:251], v[60:63], a[0:15]
  ds_read_b64_tr_b16 a[230:231], v244 offset:4096
  v_mfma_f32_32x32x16_bf16 a[16:31], a[248:251], v[64:67], a[16:31]
  v_mfma_f32_32x32x16_bf16 a[32:47], a[248:251], v[68:71], a[32:47]
  buffer_load_dwordx4 v[32:35], v252, s[44:47], s60 offen offset:2048 sc1
  ds_read_b64_tr_b16 a[232:233], v243 offset:1024
  v_mfma_f32_32x32x16_bf16 a[48:63], a[252:255], v[60:63], a[48:63]
  ds_read_b64_tr_b16 a[234:235], v243 offset:5120
  s_add_u32 s59, s58, 98432
  v_mfma_f32_32x32x16_bf16 a[64:79], a[252:255], v[64:67], a[64:79]
  buffer_load_dwordx4 v250, s[8:11], s59 offen offset:1024 lds
  s_add_u32 s60, s64, 21504
  v_mfma_f32_32x32x16_bf16 a[80:95], a[252:255], v[68:71], a[80:95]
  buffer_load_dwordx4 v[36:39], v252, s[44:47], s60 offen offset:0 sc1
  ds_read_b64_tr_b16 a[236:237], v244 offset:1024
  ds_read_b64_tr_b16 a[238:239], v244 offset:5120
  s_waitcnt vmcnt(32) lgkmcnt(6)
  v_mfma_f32_32x32x16_bf16 v[120:135], a[224:227], v[72:75], v[120:135]
  ds_read_b64_tr_b16 a[240:241], v243 offset:8192
  s_waitcnt vmcnt(30)
  v_mfma_f32_32x32x16_bf16 v[136:151], a[224:227], v[76:79], v[136:151]
  ds_read_b64_tr_b16 a[242:243], v243 offset:12288
  s_waitcnt vmcnt(29)
  v_mfma_f32_32x32x16_bf16 v[152:167], a[224:227], v[80:83], v[152:167]
  buffer_load_dwordx4 v[40:43], v252, s[44:47], s60 offen offset:1024 sc1
  s_waitcnt lgkmcnt(6)
  v_mfma_f32_32x32x16_bf16 v[168:183], a[228:231], v[72:75], v[168:183]
  ds_read_b64_tr_b16 a[244:245], v244 offset:8192
  s_add_u32 s59, s58, 99456
  v_mfma_f32_32x32x16_bf16 v[184:199], a[228:231], v[76:79], v[184:199]
  buffer_load_dwordx4 v251, s[8:11], s59 offen offset:2048 lds
  ds_read_b64_tr_b16 a[246:247], v244 offset:12288
  v_mfma_f32_32x32x16_bf16 v[200:215], a[228:231], v[80:83], v[200:215]
  buffer_load_dwordx4 v[44:47], v252, s[44:47], s60 offen offset:2048 sc1
  s_waitcnt lgkmcnt(6)
  v_mfma_f32_32x32x16_bf16 a[0:15], a[232:235], v[72:75], a[0:15]
  ds_read_b64_tr_b16 a[248:249], v243 offset:9216
  v_mfma_f32_32x32x16_bf16 a[16:31], a[232:235], v[76:79], a[16:31]
  ds_read_b64_tr_b16 a[250:251], v243 offset:13312
  s_add_u32 s60, s65, 18432
  v_mfma_f32_32x32x16_bf16 a[32:47], a[232:235], v[80:83], a[32:47]
  buffer_load_dwordx4 v[48:51], v252, s[44:47], s60 offen offset:0 sc1
  s_waitcnt lgkmcnt(6)
  v_mfma_f32_32x32x16_bf16 a[48:63], a[236:239], v[72:75], a[48:63]
  ds_read_b64_tr_b16 a[252:253], v244 offset:9216
  s_add_u32 s59, s58, 98304
  v_mfma_f32_32x32x16_bf16 a[64:79], a[236:239], v[76:79], a[64:79]
  buffer_load_dwordx4 v251, s[8:11], s59 offen offset:3072 lds
  ds_read_b64_tr_b16 a[254:255], v244 offset:13312
  v_mfma_f32_32x32x16_bf16 a[80:95], a[236:239], v[80:83], a[80:95]
  buffer_load_dwordx4 v[52:55], v252, s[44:47], s60 offen offset:1024 sc1
  s_waitcnt vmcnt(33) lgkmcnt(6)
  v_mfma_f32_32x32x16_bf16 v[120:135], a[240:243], v[84:87], v[120:135]
  s_waitcnt vmcnt(32)
  v_mfma_f32_32x32x16_bf16 v[136:151], a[240:243], v[88:91], v[136:151]
  s_waitcnt vmcnt(30)
  v_mfma_f32_32x32x16_bf16 v[152:167], a[240:243], v[92:95], v[152:167]
  buffer_load_dwordx4 v[56:59], v252, s[44:47], s60 offen offset:2048 sc1
  ds_read_b64_tr_b16 a[224:225], v243 offset:32896
  s_waitcnt lgkmcnt(5)
  v_mfma_f32_32x32x16_bf16 v[168:183], a[244:247], v[84:87], v[168:183]
  ds_read_b64_tr_b16 a[226:227], v243 offset:36992
  v_mfma_f32_32x32x16_bf16 v[184:199], a[244:247], v[88:91], v[184:199]
  s_add_u32 s60, s65, 21504
  v_mfma_f32_32x32x16_bf16 v[200:215], a[244:247], v[92:95], v[200:215]
  buffer_load_dwordx4 v[60:63], v252, s[44:47], s60 offen offset:0 sc1
  ds_read_b64_tr_b16 a[228:229], v244 offset:32896
  s_waitcnt lgkmcnt(5)
  v_mfma_f32_32x32x16_bf16 a[0:15], a[248:251], v[84:87], a[0:15]
  ds_read_b64_tr_b16 a[230:231], v244 offset:36992
  v_mfma_f32_32x32x16_bf16 a[16:31], a[248:251], v[88:91], a[16:31]
  v_mfma_f32_32x32x16_bf16 a[32:47], a[248:251], v[92:95], a[32:47]
  buffer_load_dwordx4 v[64:67], v252, s[44:47], s60 offen offset:1024 sc1
  ds_read_b64_tr_b16 a[232:233], v243 offset:33920
  s_waitcnt lgkmcnt(5)
  v_mfma_f32_32x32x16_bf16 a[48:63], a[252:255], v[84:87], a[48:63]
  ds_read_b64_tr_b16 a[234:235], v243 offset:38016
  v_mfma_f32_32x32x16_bf16 a[64:79], a[252:255], v[88:91], a[64:79]
  v_mfma_f32_32x32x16_bf16 a[80:95], a[252:255], v[92:95], a[80:95]
  buffer_load_dwordx4 v[68:71], v252, s[44:47], s60 offen offset:2048 sc1
  ds_read_b64_tr_b16 a[236:237], v244 offset:33920
  ds_read_b64_tr_b16 a[238:239], v244 offset:38016
  s_waitcnt vmcnt(33) lgkmcnt(6)
  v_mfma_f32_32x32x16_bf16 v[120:135], a[224:227], v[96:99], v[120:135]
  ds_read_b64_tr_b16 a[240:241], v243 offset:41088
  s_waitcnt vmcnt(31)
  v_mfma_f32_32x32x16_bf16 v[136:151], a[224:227], v[100:103], v[136:151]
  ds_read_b64_tr_b16 a[242:243], v243 offset:45184
  s_add_u32 s60, s70, 18432
  s_waitcnt vmcnt(30)
  v_mfma_f32_32x32x16_bf16 v[152:167], a[224:227], v[104:107], v[152:167]
  buffer_load_dwordx4 v[72:75], v252, s[44:47], s60 offen offset:0 sc1
  s_waitcnt lgkmcnt(6)
  v_mfma_f32_32x32x16_bf16 v[168:183], a[228:231], v[96:99], v[168:183]
  ds_read_b64_tr_b16 a[244:245], v244 offset:41088
  v_mfma_f32_32x32x16_bf16 v[184:199], a[228:231], v[100:103], v[184:199]
  ds_read_b64_tr_b16 a[246:247], v244 offset:45184
  v_mfma_f32_32x32x16_bf16 v[200:215], a[228:231], v[104:107], v[200:215]
  buffer_load_dwordx4 v[76:79], v252, s[44:47], s60 offen offset:1024 sc1
  s_waitcnt lgkmcnt(6)
  v_mfma_f32_32x32x16_bf16 a[0:15], a[232:235], v[96:99], a[0:15]
  ds_read_b64_tr_b16 a[248:249], v243 offset:42112
  v_mfma_f32_32x32x16_bf16 a[16:31], a[232:235], v[100:103], a[16:31]
  ds_read_b64_tr_b16 a[250:251], v243 offset:46208
  v_mfma_f32_32x32x16_bf16 a[32:47], a[232:235], v[104:107], a[32:47]
  buffer_load_dwordx4 v[80:83], v252, s[44:47], s60 offen offset:2048 sc1
  s_waitcnt lgkmcnt(6)
  v_mfma_f32_32x32x16_bf16 a[48:63], a[236:239], v[96:99], a[48:63]
  ds_read_b64_tr_b16 a[252:253], v244 offset:42112
  v_mfma_f32_32x32x16_bf16 a[64:79], a[236:239], v[100:103], a[64:79]
  ds_read_b64_tr_b16 a[254:255], v244 offset:46208
  s_add_u32 s60, s70, 21504
  v_mfma_f32_32x32x16_bf16 a[80:95], a[236:239], v[104:107], a[80:95]
  buffer_load_dwordx4 v[84:87], v252, s[44:47], s60 offen offset:0 sc1
  s_waitcnt vmcnt(32) lgkmcnt(6)
  v_mfma_f32_32x32x16_bf16 v[120:135], a[240:243], v[108:111], v[120:135]
  s_waitcnt vmcnt(31)
  v_mfma_f32_32x32x16_bf16 v[136:151], a[240:243], v[112:115], v[136:151]
  s_waitcnt lgkmcnt(0)
  s_barrier
  s_waitcnt vmcnt(29)
  v_mfma_f32_32x32x16_bf16 v[152:167], a[240:243], v[116:119], v[152:167]
  buffer_load_dwordx4 v[88:91], v252, s[44:47], s60 offen offset:1024 sc1
  ds_read_b64_tr_b16 a[224:225], v253 offset:16512
  v_mfma_f32_32x32x16_bf16 v[168:183], a[244:247], v[108:111], v[168:183]
  ds_read_b64_tr_b16 a[226:227], v253 offset:20608
  v_mfma_f32_32x32x16_bf16 v[184:199], a[244:247], v[112:115], v[184:199]
  v_mfma_f32_32x32x16_bf16 v[200:215], a[244:247], v[116:119], v[200:215]
  buffer_load_dwordx4 v[92:95], v252, s[44:47], s60 offen offset:2048 sc1
  ds_read_b64_tr_b16 a[228:229], v240 offset:16512
  v_mfma_f32_32x32x16_bf16 a[0:15], a[248:251], v[108:111], a[0:15]
  ds_read_b64_tr_b16 a[230:231], v240 offset:20608
  s_mul_i32 s66, s3, 12288
  v_mfma_f32_32x32x16_bf16 a[16:31], a[248:251], v[112:115], a[16:31]
  s_add_u32 s66, s66, 65792
  v_mfma_f32_32x32x16_bf16 a[32:47], a[248:251], v[116:119], a[32:47]
  ds_read_b64_tr_b16 a[232:233], v253 offset:17536
  v_add_u32 v247, s66, v252
  v_mfma_f32_32x32x16_bf16 a[48:63], a[252:255], v[108:111], a[48:63]
  ds_read_b64_tr_b16 a[234:235], v253 offset:21632
  s_mul_i32 s66, s3, 12288
  v_mfma_f32_32x32x16_bf16 a[64:79], a[252:255], v[112:115], a[64:79]
  s_add_u32 s66, s66, 0xffffe080
  v_mfma_f32_32x32x16_bf16 a[80:95], a[252:255], v[116:119], a[80:95]
  ds_read_b64_tr_b16 a[236:237], v240 offset:17536
  ds_read_b64_tr_b16 a[238:239], v240 offset:21632
  s_cmp_eq_u32 s3, 0
  s_cselect_b32 s66, 114944, s66
  s_waitcnt vmcnt(30) lgkmcnt(6)
  v_mfma_f32_32x32x16_bf16 v[120:135], a[224:227], v[0:3], v[120:135]
  ds_read_b64_tr_b16 a[240:241], v253 offset:24704
  s_cmp_eq_u32 s3, 1
  s_cselect_b32 s66, 148096, s66
  s_waitcnt vmcnt(28)
  v_mfma_f32_32x32x16_bf16 v[136:151], a[224:227], v[4:7], v[136:151]
  ds_read_b64_tr_b16 a[242:243], v253 offset:28800
  v_add_u32 v248, s66, v252
  s_waitcnt vmcnt(27)
  v_mfma_f32_32x32x16_bf16 v[152:167], a[224:227], v[8:11], v[152:167]
  s_xor_b32 s67, s3, 2
  s_waitcnt lgkmcnt(6)
  v_mfma_f32_32x32x16_bf16 v[168:183], a[228:231], v[0:3], v[168:183]
  ds_read_b64_tr_b16 a[244:245], v240 offset:24704
  s_mul_i32 s66, s67, 12288
  v_mfma_f32_32x32x16_bf16 v[184:199], a[228:231], v[4:7], v[184:199]
  ds_read_b64_tr_b16 a[246:247], v240 offset:28800
  s_add_u32 s66, s66, 65792
  v_mfma_f32_32x32x16_bf16 v[200:215], a[228:231], v[8:11], v[200:215]
  v_add_u32 v249, s66, v252
  s_waitcnt lgkmcnt(6)
  v_mfma_f32_32x32x16_bf16 a[0:15], a[232:235], v[0:3], a[0:15]
  ds_read_b64_tr_b16 a[248:249], v253 offset:25728
  s_mul_i32 s66, s67, 12288
  v_mfma_f32_32x32x16_bf16 a[16:31], a[232:235], v[4:7], a[16:31]
  ds_read_b64_tr_b16 a[250:251], v253 offset:29824
  s_add_u32 s66, s66, 0xffffe080
  v_mfma_f32_32x32x16_bf16 a[32:47], a[232:235], v[8:11], a[32:47]
  s_cmp_eq_u32 s67, 0
  s_cselect_b32 s66, 114944, s66
  s_waitcnt lgkmcnt(6)
  v_mfma_f32_32x32x16_bf16 a[48:63], a[236:239], v[0:3], a[48:63]
  ds_read_b64_tr_b16 a[252:253], v240 offset:25728
  s_cmp_eq_u32 s67, 1
  s_cselect_b32 s66, 148096, s66
  v_mfma_f32_32x32x16_bf16 a[64:79], a[236:239], v[4:7], a[64:79]
  ds_read_b64_tr_b16 a[254:255], v240 offset:29824
  v_add_u32 v250, s66, v252
  v_mfma_f32_32x32x16_bf16 a[80:95], a[236:239], v[8:11], a[80:95]
  s_add_u32 s28, s18, 67108864
  s_addc_u32 s29, s19, 0
  s_waitcnt vmcnt(25) lgkmcnt(6)
  v_mfma_f32_32x32x16_bf16 v[120:135], a[240:243], v[12:15], v[120:135]
  s_and_b32 s29, s29, 0xffff
  s_waitcnt vmcnt(24)
  v_mfma_f32_32x32x16_bf16 v[136:151], a[240:243], v[16:19], v[136:151]
  s_waitcnt lgkmcnt(0)
  s_waitcnt vmcnt(11)
  s_barrier
  s_mov_b32 s30, 12582912
  v_mfma_f32_32x32x16_bf16 v[152:167], a[240:243], v[20:23], v[152:167]
  ds_read_b64_tr_b16 a[224:225], v245 offset:1024
  s_lshr_b32 s66, s49, 2
  v_mfma_f32_32x32x16_bf16 v[168:183], a[244:247], v[12:15], v[168:183]
  ds_read_b64_tr_b16 a[226:227], v245 offset:5120
  s_lshl_b32 s66, s66, 4
  v_mfma_f32_32x32x16_bf16 v[184:199], a[244:247], v[16:19], v[184:199]
  s_add_u32 s66, s66, s48
  v_mfma_f32_32x32x16_bf16 v[200:215], a[244:247], v[20:23], v[200:215]
  ds_read_b64_tr_b16 a[228:229], v245 offset:9216
  s_mul_i32 s66, s66, 6
  v_mfma_f32_32x32x16_bf16 a[0:15], a[248:251], v[12:15], a[0:15]
  ds_read_b64_tr_b16 a[230:231], v245 offset:13312
  s_and_b32 s67, s3, 1
  v_mfma_f32_32x32x16_bf16 a[16:31], a[248:251], v[16:19], a[16:31]
  s_mul_i32 s67, s67, 3
  v_mfma_f32_32x32x16_bf16 a[32:47], a[248:251], v[20:23], a[32:47]
  ds_read_b64_tr_b16 a[232:233], v253 offset:50432
  s_add_u32 s66, s66, s67
  v_mfma_f32_32x32x16_bf16 a[48:63], a[252:255], v[12:15], a[48:63]
  ds_read_b64_tr_b16 a[234:235], v253 offset:54528
  s_lshl_b32 s66, s66, 15
  v_mfma_f32_32x32x16_bf16 a[64:79], a[252:255], v[16:19], a[64:79]
  s_lshl_b32 s67, s71, 13
  v_mfma_f32_32x32x16_bf16 a[80:95], a[252:255], v[20:23], a[80:95]
  ds_read_b64_tr_b16 a[236:237], v253 offset:58624
  ds_read_b64_tr_b16 a[238:239], v253 offset:62720
  s_add_u32 s66, s66, s67
  s_waitcnt lgkmcnt(6)
  v_mfma_f32_32x32x16_bf16 a[0:15], a[224:227], v[24:27], a[0:15]
  ds_read_b64_tr_b16 a[240:241], v253 offset:1024
  s_lshr_b32 s67, s3, 1
  v_mfma_f32_32x32x16_bf16 a[16:31], a[224:227], v[28:31], a[16:31]
  ds_read_b64_tr_b16 a[242:243], v253 offset:5120
  s_lshl_b32 s67, s67, 12
  v_mfma_f32_32x32x16_bf16 a[32:47], a[224:227], v[32:35], a[32:47]
  s_add_u32 s14, s66, s67
  s_waitcnt lgkmcnt(6)
  v_mfma_f32_32x32x16_bf16 a[0:15], a[228:231], v[36:39], a[0:15]
  ds_read_b64_tr_b16 a[244:245], v253 offset:9216
  v_mfma_f32_32x32x16_bf16 a[16:31], a[228:231], v[40:43], a[16:31]
  ds_read_b64_tr_b16 a[246:247], v253 offset:13312
  v_mfma_f32_32x32x16_bf16 a[32:47], a[228:231], v[44:47], a[32:47]
  s_waitcnt lgkmcnt(6)
  v_mfma_f32_32x32x16_bf16 a[0:15], a[232:235], v[48:51], a[0:15]
  ds_read_b64_tr_b16 a[248:249], v246 offset:1024
  s_waitcnt vmcnt(10)
  v_mfma_f32_32x32x16_bf16 a[16:31], a[232:235], v[52:55], a[16:31]
  ds_read_b64_tr_b16 a[250:251], v246 offset:5120
  s_waitcnt vmcnt(9)
  v_mfma_f32_32x32x16_bf16 a[32:47], a[232:235], v[56:59], a[32:47]
  s_waitcnt vmcnt(8) lgkmcnt(6)
  v_mfma_f32_32x32x16_bf16 a[0:15], a[236:239], v[60:63], a[0:15]
  ds_read_b64_tr_b16 a[252:253], v246 offset:9216
  s_waitcnt vmcnt(7)
  v_mfma_f32_32x32x16_bf16 a[16:31], a[236:239], v[64:67], a[16:31]
  ds_read_b64_tr_b16 a[254:255], v246 offset:13312
  s_waitcnt vmcnt(6)
  v_mfma_f32_32x32x16_bf16 a[32:47], a[236:239], v[68:71], a[32:47]
  s_waitcnt vmcnt(5) lgkmcnt(6)
  v_mfma_f32_32x32x16_bf16 a[0:15], a[240:243], v[72:75], a[0:15]
  s_waitcnt vmcnt(4)
  v_mfma_f32_32x32x16_bf16 a[16:31], a[240:243], v[76:79], a[16:31]
  s_waitcnt vmcnt(3)
  v_mfma_f32_32x32x16_bf16 a[32:47], a[240:243], v[80:83], a[32:47]
  ds_read_b64_tr_b16 a[224:225], v240 offset:50432
  s_waitcnt vmcnt(2) lgkmcnt(5)
  v_mfma_f32_32x32x16_bf16 a[0:15], a[244:247], v[84:87], a[0:15]
  ds_read_b64_tr_b16 a[226:227], v240 offset:54528
  s_waitcnt vmcnt(1)
  v_mfma_f32_32x32x16_bf16 a[16:31], a[244:247], v[88:91], a[16:31]
  s_waitcnt vmcnt(0)
  v_mfma_f32_32x32x16_bf16 a[32:47], a[244:247], v[92:95], a[32:47]
  ds_read_b64_tr_b16 a[228:229], v240 offset:58624
  s_waitcnt lgkmcnt(5)
  v_mfma_f32_32x32x16_bf16 a[48:63], a[248:251], v[24:27], a[48:63]
  ds_read_b64_tr_b16 a[230:231], v240 offset:62720
  v_mfma_f32_32x32x16_bf16 a[64:79], a[248:251], v[28:31], a[64:79]
  v_mfma_f32_32x32x16_bf16 a[80:95], a[248:251], v[32:35], a[80:95]
  ds_read_b64_tr_b16 a[232:233], v240 offset:1024
  ds_write_b128 v247, a[0:3] offset:0
  s_waitcnt lgkmcnt(6)
  v_mfma_f32_32x32x16_bf16 a[48:63], a[252:255], v[36:39], a[48:63]
  ds_read_b64_tr_b16 a[234:235], v240 offset:5120
  ds_write_b128 v247, a[4:7] offset:1024
  v_mfma_f32_32x32x16_bf16 a[64:79], a[252:255], v[40:43], a[64:79]
  ds_write_b128 v247, a[8:11] offset:2048
  v_mfma_f32_32x32x16_bf16 a[80:95], a[252:255], v[44:47], a[80:95]
  ds_read_b64_tr_b16 a[236:237], v240 offset:9216
  ds_read_b64_tr_b16 a[238:239], v240 offset:13312
  s_waitcnt lgkmcnt(9)
  v_mfma_f32_32x32x16_bf16 a[48:63], a[224:227], v[48:51], a[48:63]
  ds_read_b64_tr_b16 a[240:241], v245 offset:0
  ds_write_b128 v247, a[12:15] offset:3072
  v_mfma_f32_32x32x16_bf16 a[64:79], a[224:227], v[52:55], a[64:79]
  ds_read_b64_tr_b16 a[242:243], v245 offset:4096
  ds_write_b128 v247, a[16:19] offset:4096
  v_mfma_f32_32x32x16_bf16 a[80:95], a[224:227], v[56:59], a[80:95]
  ds_write_b128 v247, a[20:23] offset:5120
  s_waitcnt lgkmcnt(12)
  v_mfma_f32_32x32x16_bf16 a[48:63], a[228:231], v[60:63], a[48:63]
  ds_read_b64_tr_b16 a[244:245], v245 offset:8192
  v_mfma_f32_32x32x16_bf16 a[64:79], a[228:231], v[64:67], a[64:79]
  ds_read_b64_tr_b16 a[246:247], v245 offset:12288
  ds_write_b128 v247, a[24:27] offset:6144
  v_mfma_f32_32x32x16_bf16 a[80:95], a[228:231], v[68:71], a[80:95]
  ds_write_b128 v247, a[28:31] offset:7168
  s_waitcnt lgkmcnt(13)
  v_mfma_f32_32x32x16_bf16 a[48:63], a[232:235], v[72:75], a[48:63]
  ds_read_b64_tr_b16 a[248:249], v253 offset:49408
  ds_write_b128 v247, a[32:35] offset:8192
  v_mfma_f32_32x32x16_bf16 a[64:79], a[232:235], v[76:79], a[64:79]
  ds_read_b64_tr_b16 a[250:251], v253 offset:53504
  v_mfma_f32_32x32x16_bf16 a[80:95], a[232:235], v[80:83], a[80:95]
  ds_write_b128 v247, a[36:39] offset:9216
  s_waitcnt lgkmcnt(13)
  v_mfma_f32_32x32x16_bf16 a[48:63], a[236:239], v[84:87], a[48:63]
  ds_read_b64_tr_b16 a[252:253], v253 offset:57600
  ds_write_b128 v247, a[40:43] offset:10240
  v_mfma_f32_32x32x16_bf16 a[64:79], a[236:239], v[88:91], a[64:79]
  ds_read_b64_tr_b16 a[254:255], v253 offset:61696
  ds_write_b128 v247, a[44:47] offset:11264
  v_mfma_f32_32x32x16_bf16 a[80:95], a[236:239], v[92:95], a[80:95]
  s_waitcnt lgkmcnt(14)
  v_mfma_f32_32x32x16_bf16 v[120:135], a[240:243], v[24:27], v[120:135]
  v_mfma_f32_32x32x16_bf16 v[136:151], a[240:243], v[28:31], v[136:151]
  s_waitcnt lgkmcnt(0)
  s_barrier
  v_mfma_f32_32x32x16_bf16 v[152:167], a[240:243], v[32:35], v[152:167]
  ds_read_b64_tr_b16 a[224:225], v253 offset:0
  ds_write_b128 v248, a[48:51] offset:0
  v_mfma_f32_32x32x16_bf16 v[120:135], a[244:247], v[36:39], v[120:135]
  ds_read_b64_tr_b16 a[226:227], v253 offset:4096
  ds_write_b128 v248, a[52:55] offset:1024
  ds_read_b128 v[96:99], v249 offset:0
  v_mfma_f32_32x32x16_bf16 v[136:151], a[244:247], v[40:43], v[136:151]
  ds_write_b128 v248, a[56:59] offset:2048
  ds_read_b128 v[100:103], v249 offset:1024
  v_mfma_f32_32x32x16_bf16 v[152:167], a[244:247], v[44:47], v[152:167]
  ds_read_b64_tr_b16 a[228:229], v253 offset:8192
  ds_read_b128 v[104:107], v249 offset:2048
  v_mfma_f32_32x32x16_bf16 v[120:135], a[248:251], v[48:51], v[120:135]
  ds_read_b64_tr_b16 a[230:231], v253 offset:12288
  ds_write_b128 v248, a[60:63] offset:3072
  ds_read_b128 v[108:111], v249 offset:3072
  v_mfma_f32_32x32x16_bf16 v[136:151], a[248:251], v[52:55], v[136:151]
  ds_write_b128 v248, a[64:67] offset:4096
  ds_read_b128 v[112:115], v249 offset:4096
  v_mfma_f32_32x32x16_bf16 v[152:167], a[248:251], v[56:59], v[152:167]
  ds_read_b64_tr_b16 a[232:233], v246 offset:0
  ds_write_b128 v248, a[68:71] offset:5120
  ds_read_b128 v[116:119], v249 offset:5120
  v_mfma_f32_32x32x16_bf16 v[120:135], a[252:255], v[60:63], v[120:135]
  ds_read_b64_tr_b16 a[234:235], v246 offset:4096
  ds_read_b128 v[0:3], v249 offset:6144
  v_mfma_f32_32x32x16_bf16 v[136:151], a[252:255], v[64:67], v[136:151]
  ds_write_b128 v248, a[72:75] offset:6144
  ds_read_b128 v[4:7], v249 offset:7168
  v_mfma_f32_32x32x16_bf16 v[152:167], a[252:255], v[68:71], v[152:167]
  ds_read_b64_tr_b16 a[236:237], v246 offset:8192
  ds_read_b64_tr_b16 a[238:239], v246 offset:12288
  ds_write_b128 v248, a[76:79] offset:7168
  ds_read_b128 v[8:11], v249 offset:8192
  s_waitcnt lgkmcnt(15)
  v_mfma_f32_32x32x16_bf16 v[120:135], a[224:227], v[72:75], v[120:135]
  ds_read_b64_tr_b16 a[240:241], v240 offset:49408
  ds_write_b128 v248, a[80:83] offset:8192
  ds_read_b128 v[12:15], v249 offset:9216
  v_mfma_f32_32x32x16_bf16 v[136:151], a[224:227], v[76:79], v[136:151]
  ds_read_b64_tr_b16 a[242:243], v240 offset:53504
  ds_read_b128 v[16:19], v249 offset:10240
  v_mfma_f32_32x32x16_bf16 v[152:167], a[224:227], v[80:83], v[152:167]
  ds_write_b128 v248, a[84:87] offset:9216
  ds_read_b128 v[20:23], v249 offset:11264
  v_mfma_f32_32x32x16_bf16 v[120:135], a[228:231], v[84:87], v[120:135]
  ds_read_b64_tr_b16 a[244:245], v240 offset:57600
  ds_write_b128 v248, a[88:91] offset:10240
  v_mfma_f32_32x32x16_bf16 v[136:151], a[228:231], v[88:91], v[136:151]
  ds_read_b64_tr_b16 a[246:247], v240 offset:61696
  ds_write_b128 v248, a[92:95] offset:11264
  v_mfma_f32_32x32x16_bf16 v[152:167], a[228:231], v[92:95], v[152:167]
  s_waitcnt lgkmcnt(15)
  v_mfma_f32_32x32x16_bf16 v[168:183], a[232:235], v[24:27], v[168:183]
  ds_read_b64_tr_b16 a[248:249], v240 offset:0
  v_mfma_f32_32x32x16_bf16 v[184:199], a[232:235], v[28:31], v[184:199]
  ds_read_b64_tr_b16 a[250:251], v240 offset:4096
  s_waitcnt lgkmcnt(0)
  s_barrier
  v_mfma_f32_32x32x16_bf16 v[200:215], a[232:235], v[32:35], v[200:215]
  ds_read_b128 v[216:219], v250 offset:0
  v_add_f32 v120, v120, v96
  v_add_f32 v121, v121, v97
  v_add_f32 v122, v122, v98
  v_add_f32 v123, v123, v99
  v_add_f32 v124, v124, v100
  v_mfma_f32_32x32x16_bf16 v[168:183], a[236:239], v[36:39], v[168:183]
  ds_read_b64_tr_b16 a[252:253], v240 offset:8192
  ds_read_b128 v[220:223], v250 offset:1024
  v_add_f32 v125, v125, v101
  v_add_f32 v126, v126, v102
  v_add_f32 v127, v127, v103
  v_add_f32 v128, v128, v104
  v_mfma_f32_32x32x16_bf16 v[184:199], a[236:239], v[40:43], v[184:199]
  ds_read_b64_tr_b16 a[254:255], v240 offset:12288
  ds_read_b128 v[224:227], v250 offset:2048
  v_add_f32 v129, v129, v105
  v_add_f32 v130, v130, v106
  v_add_f32 v131, v131, v107
  v_add_f32 v132, v132, v108
  v_mfma_f32_32x32x16_bf16 v[200:215], a[236:239], v[44:47], v[200:215]
  ds_read_b128 v[228:231], v250 offset:3072
  v_add_f32 v133, v133, v109
  v_add_f32 v134, v134, v110
  v_add_f32 v135, v135, v111
  v_cvt_pk_bf16_f32 v120, v120, v121
  v_cvt_pk_bf16_f32 v121, v122, v123
  v_mfma_f32_32x32x16_bf16 v[168:183], a[240:243], v[48:51], v[168:183]
  ds_read_b128 v[232:235], v250 offset:4096
  v_cvt_pk_bf16_f32 v122, v124, v125
  v_cvt_pk_bf16_f32 v123, v126, v127
  v_cvt_pk_bf16_f32 v124, v128, v129
  v_cvt_pk_bf16_f32 v125, v130, v131
  v_cvt_pk_bf16_f32 v126, v132, v133
  v_mfma_f32_32x32x16_bf16 v[184:199], a[240:243], v[52:55], v[184:199]
  ds_read_b128 v[236:239], v250 offset:5120
  v_cvt_pk_bf16_f32 v127, v134, v135
  s_add_u32 s67, s14, 0
  buffer_store_dwordx4 v[120:123], v252, s[28:31], s67 offen offset:0 sc1
  v_mfma_f32_32x32x16_bf16 v[200:215], a[240:243], v[56:59], v[200:215]
  ds_read_b128 v[24:27], v250 offset:6144
  buffer_store_dwordx4 v[124:127], v252, s[28:31], s67 offen offset:1024 sc1
  v_add_f32 v136, v136, v112
  v_add_f32 v137, v137, v113
  v_mfma_f32_32x32x16_bf16 v[168:183], a[244:247], v[60:63], v[168:183]
  ds_read_b128 v[28:31], v250 offset:7168
  v_add_f32 v138, v138, v114
  v_add_f32 v139, v139, v115
  v_add_f32 v140, v140, v116
  v_add_f32 v141, v141, v117
  v_add_f32 v142, v142, v118
  v_mfma_f32_32x32x16_bf16 v[184:199], a[244:247], v[64:67], v[184:199]
  ds_read_b128 v[32:35], v250 offset:8192
  v_add_f32 v143, v143, v119
  v_add_f32 v144, v144, v0
  v_add_f32 v145, v145, v1
  v_add_f32 v146, v146, v2
  v_add_f32 v147, v147, v3
  v_mfma_f32_32x32x16_bf16 v[200:215], a[244:247], v[68:71], v[200:215]
  ds_read_b128 v[36:39], v250 offset:9216
  v_add_f32 v148, v148, v4
  v_add_f32 v149, v149, v5
  v_add_f32 v150, v150, v6
  v_add_f32 v151, v151, v7
  v_cvt_pk_bf16_f32 v136, v136, v137
  v_mfma_f32_32x32x16_bf16 v[168:183], a[248:251], v[72:75], v[168:183]
  ds_read_b128 v[40:43], v250 offset:10240
  v_cvt_pk_bf16_f32 v137, v138, v139
  v_cvt_pk_bf16_f32 v138, v140, v141
  v_cvt_pk_bf16_f32 v139, v142, v143
  v_cvt_pk_bf16_f32 v140, v144, v145
  v_cvt_pk_bf16_f32 v141, v146, v147
  v_mfma_f32_32x32x16_bf16 v[184:199], a[248:251], v[76:79], v[184:199]
  ds_read_b128 v[44:47], v250 offset:11264
  v_cvt_pk_bf16_f32 v142, v148, v149
  v_cvt_pk_bf16_f32 v143, v150, v151
  s_add_u32 s67, s14, 32768
  v_mfma_f32_32x32x16_bf16 v[200:215], a[248:251], v[80:83], v[200:215]
  buffer_store_dwordx4 v[136:139], v252, s[28:31], s67 offen offset:0 sc1
  buffer_store_dwordx4 v[140:143], v252, s[28:31], s67 offen offset:1024 sc1
  s_waitcnt lgkmcnt(10)
  v_mfma_f32_32x32x16_bf16 v[168:183], a[252:255], v[84:87], v[168:183]
  v_add_f32 v152, v152, v8
  v_add_f32 v153, v153, v9
  v_add_f32 v154, v154, v10
  v_add_f32 v155, v155, v11
  v_add_f32 v156, v156, v12
  v_add_f32 v157, v157, v13
  v_mfma_f32_32x32x16_bf16 v[184:199], a[252:255], v[88:91], v[184:199]
  v_add_f32 v158, v158, v14
  v_add_f32 v159, v159, v15
  v_add_f32 v160, v160, v16
  v_add_f32 v161, v161, v17
  v_add_f32 v162, v162, v18
  v_add_f32 v163, v163, v19
  v_mfma_f32_32x32x16_bf16 v[200:215], a[252:255], v[92:95], v[200:215]
  v_add_f32 v164, v164, v20
  v_add_f32 v165, v165, v21
  v_add_f32 v166, v166, v22
  v_add_f32 v167, v167, v23
  v_cvt_pk_bf16_f32 v152, v152, v153
  v_cvt_pk_bf16_f32 v153, v154, v155
  v_cvt_pk_bf16_f32 v154, v156, v157
  v_cvt_pk_bf16_f32 v155, v158, v159
  v_cvt_pk_bf16_f32 v156, v160, v161
  v_cvt_pk_bf16_f32 v157, v162, v163
  v_cvt_pk_bf16_f32 v158, v164, v165
  v_cvt_pk_bf16_f32 v159, v166, v167
  s_add_u32 s67, s14, 65536
  buffer_store_dwordx4 v[152:155], v252, s[28:31], s67 offen offset:0 sc1
  buffer_store_dwordx4 v[156:159], v252, s[28:31], s67 offen offset:1024 sc1
  v_pk_add_f32 v[168:169], v[168:169], v[216:217]
  v_pk_add_f32 v[170:171], v[170:171], v[218:219]
  v_pk_add_f32 v[172:173], v[172:173], v[220:221]
  v_pk_add_f32 v[174:175], v[174:175], v[222:223]
  s_waitcnt lgkmcnt(9)
  v_pk_add_f32 v[176:177], v[176:177], v[224:225]
  v_pk_add_f32 v[178:179], v[178:179], v[226:227]
  s_waitcnt lgkmcnt(8)
  v_pk_add_f32 v[180:181], v[180:181], v[228:229]
  v_pk_add_f32 v[182:183], v[182:183], v[230:231]
  v_cvt_pk_bf16_f32 v168, v168, v169
  v_cvt_pk_bf16_f32 v169, v170, v171
  v_cvt_pk_bf16_f32 v170, v172, v173
  v_cvt_pk_bf16_f32 v171, v174, v175
  v_cvt_pk_bf16_f32 v172, v176, v177
  v_cvt_pk_bf16_f32 v173, v178, v179
  v_cvt_pk_bf16_f32 v174, v180, v181
  v_cvt_pk_bf16_f32 v175, v182, v183
  s_add_u32 s67, s14, 0
  buffer_store_dwordx4 v[168:171], v252, s[28:31], s67 offen offset:2048 sc1
  buffer_store_dwordx4 v[172:175], v252, s[28:31], s67 offen offset:3072 sc1
  s_waitcnt lgkmcnt(7)
  v_pk_add_f32 v[184:185], v[184:185], v[232:233]
  v_pk_add_f32 v[186:187], v[186:187], v[234:235]
  s_waitcnt lgkmcnt(6)
  v_pk_add_f32 v[188:189], v[188:189], v[236:237]
  v_pk_add_f32 v[190:191], v[190:191], v[238:239]
  s_waitcnt lgkmcnt(5)
  v_pk_add_f32 v[192:193], v[192:193], v[24:25]
  v_pk_add_f32 v[194:195], v[194:195], v[26:27]
  s_waitcnt lgkmcnt(4)
  v_pk_add_f32 v[196:197], v[196:197], v[28:29]
  v_pk_add_f32 v[198:199], v[198:199], v[30:31]
  v_cvt_pk_bf16_f32 v184, v184, v185
  v_cvt_pk_bf16_f32 v185, v186, v187
  v_cvt_pk_bf16_f32 v186, v188, v189
  v_cvt_pk_bf16_f32 v187, v190, v191
  v_cvt_pk_bf16_f32 v188, v192, v193
  v_cvt_pk_bf16_f32 v189, v194, v195
  v_cvt_pk_bf16_f32 v190, v196, v197
  v_cvt_pk_bf16_f32 v191, v198, v199
  s_add_u32 s67, s14, 32768
  buffer_store_dwordx4 v[184:187], v252, s[28:31], s67 offen offset:2048 sc1
  buffer_store_dwordx4 v[188:191], v252, s[28:31], s67 offen offset:3072 sc1
  s_waitcnt lgkmcnt(3)
  v_pk_add_f32 v[200:201], v[200:201], v[32:33]
  v_pk_add_f32 v[202:203], v[202:203], v[34:35]
  s_waitcnt lgkmcnt(2)
  v_pk_add_f32 v[204:205], v[204:205], v[36:37]
  v_pk_add_f32 v[206:207], v[206:207], v[38:39]
  s_waitcnt lgkmcnt(1)
  v_pk_add_f32 v[208:209], v[208:209], v[40:41]
  v_pk_add_f32 v[210:211], v[210:211], v[42:43]
  s_waitcnt lgkmcnt(0)
  v_pk_add_f32 v[212:213], v[212:213], v[44:45]
  v_pk_add_f32 v[214:215], v[214:215], v[46:47]
  v_cvt_pk_bf16_f32 v200, v200, v201
  v_cvt_pk_bf16_f32 v201, v202, v203
  v_cvt_pk_bf16_f32 v202, v204, v205
  v_cvt_pk_bf16_f32 v203, v206, v207
  v_cvt_pk_bf16_f32 v204, v208, v209
  v_cvt_pk_bf16_f32 v205, v210, v211
  v_cvt_pk_bf16_f32 v206, v212, v213
  v_cvt_pk_bf16_f32 v207, v214, v215
  s_add_u32 s67, s14, 65536
  buffer_store_dwordx4 v[200:203], v252, s[28:31], s67 offen offset:2048 sc1
  buffer_store_dwordx4 v[204:207], v252, s[28:31], s67 offen offset:3072 sc1
  v_lshrrev_b32 v2, 7, v252
  v_bfe_u32 v3, v252, 4, 3
  v_lshlrev_b32 v4, 9, v2
  v_lshl_add_u32 v4, v3, 4, v4
  v_lshlrev_b32 v5, 4, v2
  v_lshl_add_u32 v5, v3, 10, v5
  s_load_dwordx2 s[20:21], s[0:1], 40
  s_lshr_b32 s66, s49, 2
  s_mul_i32 s66, s66, 12
  s_mul_i32 s67, s3, 3
  s_add_u32 s66, s66, s67
  s_mul_i32 s60, s48, 196608
  s_lshl_b32 s67, s71, 13
  s_add_u32 s61, s60, s67
  s_lshl_b32 s67, s71, 8
  s_add_u32 s60, s60, s67
  s_add_u32 s67, s66, 0
  s_lshr_b32 s68, s67, 3
  s_lshl_b32 s68, s68, 15
  s_bfe_u32 s69, s67, 0x20001
  s_lshl_b32 s59, s69, 7
  s_add_u32 s32, s61, s68
  s_add_u32 s32, s32, s59
  s_and_b32 s59, s67, 1
  s_lshl_b32 s62, s59, 12
  s_add_u32 s32, s32, s62
  s_lshl_b32 s69, s69, 13
  s_add_u32 s36, s60, s68
  s_add_u32 s36, s36, s69
  s_lshl_b32 s59, s59, 7
  s_add_u32 s36, s36, s59
  s_add_u32 s67, s66, 1
  s_lshr_b32 s68, s67, 3
  s_lshl_b32 s68, s68, 15
  s_bfe_u32 s69, s67, 0x20001
  s_lshl_b32 s59, s69, 7
  s_add_u32 s33, s61, s68
  s_add_u32 s33, s33, s59
  s_and_b32 s59, s67, 1
  s_lshl_b32 s62, s59, 12
  s_add_u32 s33, s33, s62
  s_lshl_b32 s69, s69, 13
  s_add_u32 s37, s60, s68
  s_add_u32 s37, s37, s69
  s_lshl_b32 s59, s59, 7
  s_add_u32 s37, s37, s59
  s_add_u32 s67, s66, 2
  s_lshr_b32 s68, s67, 3
  s_lshl_b32 s68, s68, 15
  s_bfe_u32 s69, s67, 0x20001
  s_lshl_b32 s59, s69, 7
  s_add_u32 s34, s61, s68
  s_add_u32 s34, s34, s59
  s_and_b32 s59, s67, 1
  s_lshl_b32 s62, s59, 12
  s_add_u32 s34, s34, s62
  s_lshl_b32 s69, s69, 13
  s_add_u32 s38, s60, s68
  s_add_u32 s38, s38, s69
  s_lshl_b32 s59, s59, 7
  s_add_u32 s38, s38, s59
  s_or_b32 s66, s13, 0xe0
  v_mov_b32 v242, s66
  s_waitcnt vmcnt(0) lgkmcnt(0)
  s_barrier
  buffer_store_dword v242, v255, s[4:7], s52 offen sc1
  buffer_load_dword v241, v254, s[4:7], s53 offen sc1
  s_and_b32 s21, s21, 0xffff
  s_mov_b32 s22, 3145728
  s_mov_b32 s23, 0x00020000
  s_mov_b32 s51, 0
  s_cmp_lg_u32 s3, 0
  s_cbranch_scc1 L1_goc
  L1_pollc:
  s_waitcnt vmcnt(0)
  v_xor_b32 v241, s13, v241
  v_and_b32 v241, 0xffffff9f, v241
  v_cmp_eq_u32 vcc, 128, v241
  s_nop 3
  s_and_b32 s68, vcc_lo, s16
  s_cmp_eq_u32 s68, s16
  s_cbranch_scc1 L1_goc
  s_sleep 1
  buffer_load_dword v241, v254, s[4:7], s53 offen sc1
  s_add_u32 s51, s51, 1
  s_cmp_lt_u32 s51, 0x40000
  s_cbranch_scc1 L1_pollc
  L1_goc:
  s_barrier
  buffer_load_dwordx4 v[8:11], v4, s[28:31], s32 offen sc1
  s_add_u32 s32, s32, 3145728
  buffer_load_dwordx4 v[12:15], v4, s[28:31], s32 offen sc1
  s_add_u32 s32, s32, 3145728
  buffer_load_dwordx4 v[16:19], v4, s[28:31], s32 offen sc1
  s_add_u32 s32, s32, 3145728
  buffer_load_dwordx4 v[20:23], v4, s[28:31], s32 offen sc1
  buffer_load_dwordx4 v[24:27], v4, s[28:31], s33 offen sc1
  s_add_u32 s33, s33, 3145728
  buffer_load_dwordx4 v[28:31], v4, s[28:31], s33 offen sc1
  s_add_u32 s33, s33, 3145728
  buffer_load_dwordx4 v[32:35], v4, s[28:31], s33 offen sc1
  s_add_u32 s33, s33, 3145728
  buffer_load_dwordx4 v[36:39], v4, s[28:31], s33 offen sc1
  buffer_load_dwordx4 v[40:43], v4, s[28:31], s34 offen sc1
  s_add_u32 s34, s34, 3145728
  buffer_load_dwordx4 v[44:47], v4, s[28:31], s34 offen sc1
  s_add_u32 s34, s34, 3145728
  buffer_load_dwordx4 v[48:51], v4, s[28:31], s34 offen sc1
  s_add_u32 s34, s34, 3145728
  buffer_load_dwordx4 v[52:55], v4, s[28:31], s34 offen sc1
  s_waitcnt vmcnt(11)
  v_lshlrev_b32 v64, 16, v8
  v_and_b32 v65, 0xffff0000, v8
  s_waitcnt vmcnt(10)
  v_lshlrev_b32 v66, 16, v12
  v_and_b32 v67, 0xffff0000, v12
  s_waitcnt vmcnt(9)
  v_lshlrev_b32 v68, 16, v16
  v_and_b32 v69, 0xffff0000, v16
  s_waitcnt vmcnt(8)
  v_lshlrev_b32 v70, 16, v20
  v_and_b32 v71, 0xffff0000, v20
  v_pk_add_f32 v[64:65], v[64:65], v[66:67]
  v_pk_add_f32 v[68:69], v[68:69], v[70:71]
  v_pk_add_f32 v[64:65], v[64:65], v[68:69]
  v_cvt_pk_bf16_f32 v72, v64, v65
  v_lshlrev_b32 v64, 16, v9
  v_and_b32 v65, 0xffff0000, v9
  v_lshlrev_b32 v66, 16, v13
  v_and_b32 v67, 0xffff0000, v13
  v_lshlrev_b32 v68, 16, v17
  v_and_b32 v69, 0xffff0000, v17
  v_lshlrev_b32 v70, 16, v21
  v_and_b32 v71, 0xffff0000, v21
  v_pk_add_f32 v[64:65], v[64:65], v[66:67]
  v_pk_add_f32 v[68:69], v[68:69], v[70:71]
  v_pk_add_f32 v[64:65], v[64:65], v[68:69]
  v_cvt_pk_bf16_f32 v73, v64, v65
  v_lshlrev_b32 v64, 16, v10
  v_and_b32 v65, 0xffff0000, v10
  v_lshlrev_b32 v66, 16, v14
  v_and_b32 v67, 0xffff0000, v14
  v_lshlrev_b32 v68, 16, v18
  v_and_b32 v69, 0xffff0000, v18
  v_lshlrev_b32 v70, 16, v22
  v_and_b32 v71, 0xffff0000, v22
  v_pk_add_f32 v[64:65], v[64:65], v[66:67]
  v_pk_add_f32 v[68:69], v[68:69], v[70:71]
  v_pk_add_f32 v[64:65], v[64:65], v[68:69]
  v_cvt_pk_bf16_f32 v74, v64, v65
  v_lshlrev_b32 v64, 16, v11
  v_and_b32 v65, 0xffff0000, v11
  v_lshlrev_b32 v66, 16, v15
  v_and_b32 v67, 0xffff0000, v15
  v_lshlrev_b32 v68, 16, v19
  v_and_b32 v69, 0xffff0000, v19
  v_lshlrev_b32 v70, 16, v23
  v_and_b32 v71, 0xffff0000, v23
  v_pk_add_f32 v[64:65], v[64:65], v[66:67]
  v_pk_add_f32 v[68:69], v[68:69], v[70:71]
  v_pk_add_f32 v[64:65], v[64:65], v[68:69]
  v_cvt_pk_bf16_f32 v75, v64, v65
  buffer_store_dwordx4 v[72:75], v5, s[20:23], s36 offen
  s_waitcnt vmcnt(8)
  v_lshlrev_b32 v64, 16, v24
  v_and_b32 v65, 0xffff0000, v24
  s_waitcnt vmcnt(7)
  v_lshlrev_b32 v66, 16, v28
  v_and_b32 v67, 0xffff0000, v28
  s_waitcnt vmcnt(6)
  v_lshlrev_b32 v68, 16, v32
  v_and_b32 v69, 0xffff0000, v32
  s_waitcnt vmcnt(5)
  v_lshlrev_b32 v70, 16, v36
  v_and_b32 v71, 0xffff0000, v36
  v_pk_add_f32 v[64:65], v[64:65], v[66:67]
  v_pk_add_f32 v[68:69], v[68:69], v[70:71]
  v_pk_add_f32 v[64:65], v[64:65], v[68:69]
  v_cvt_pk_bf16_f32 v76, v64, v65
  v_lshlrev_b32 v64, 16, v25
  v_and_b32 v65, 0xffff0000, v25
  v_lshlrev_b32 v66, 16, v29
  v_and_b32 v67, 0xffff0000, v29
  v_lshlrev_b32 v68, 16, v33
  v_and_b32 v69, 0xffff0000, v33
  v_lshlrev_b32 v70, 16, v37
  v_and_b32 v71, 0xffff0000, v37
  v_pk_add_f32 v[64:65], v[64:65], v[66:67]
  v_pk_add_f32 v[68:69], v[68:69], v[70:71]
  v_pk_add_f32 v[64:65], v[64:65], v[68:69]
  v_cvt_pk_bf16_f32 v77, v64, v65
  v_lshlrev_b32 v64, 16, v26
  v_and_b32 v65, 0xffff0000, v26
  v_lshlrev_b32 v66, 16, v30
  v_and_b32 v67, 0xffff0000, v30
  v_lshlrev_b32 v68, 16, v34
  v_and_b32 v69, 0xffff0000, v34
  v_lshlrev_b32 v70, 16, v38
  v_and_b32 v71, 0xffff0000, v38
  v_pk_add_f32 v[64:65], v[64:65], v[66:67]
  v_pk_add_f32 v[68:69], v[68:69], v[70:71]
  v_pk_add_f32 v[64:65], v[64:65], v[68:69]
  v_cvt_pk_bf16_f32 v78, v64, v65
  v_lshlrev_b32 v64, 16, v27
  v_and_b32 v65, 0xffff0000, v27
  v_lshlrev_b32 v66, 16, v31
  v_and_b32 v67, 0xffff0000, v31
  v_lshlrev_b32 v68, 16, v35
  v_and_b32 v69, 0xffff0000, v35
  v_lshlrev_b32 v70, 16, v39
  v_and_b32 v71, 0xffff0000, v39
  v_pk_add_f32 v[64:65], v[64:65], v[66:67]
  v_pk_add_f32 v[68:69], v[68:69], v[70:71]
  v_pk_add_f32 v[64:65], v[64:65], v[68:69]
  v_cvt_pk_bf16_f32 v79, v64, v65
  buffer_store_dwordx4 v[76:79], v5, s[20:23], s37 offen
  s_waitcnt vmcnt(5)
  v_lshlrev_b32 v64, 16, v40
  v_and_b32 v65, 0xffff0000, v40
  s_waitcnt vmcnt(4)
  v_lshlrev_b32 v66, 16, v44
  v_and_b32 v67, 0xffff0000, v44
  s_waitcnt vmcnt(3)
  v_lshlrev_b32 v68, 16, v48
  v_and_b32 v69, 0xffff0000, v48
  s_waitcnt vmcnt(2)
  v_lshlrev_b32 v70, 16, v52
  v_and_b32 v71, 0xffff0000, v52
  v_pk_add_f32 v[64:65], v[64:65], v[66:67]
  v_pk_add_f32 v[68:69], v[68:69], v[70:71]
  v_pk_add_f32 v[64:65], v[64:65], v[68:69]
  v_cvt_pk_bf16_f32 v80, v64, v65
  v_lshlrev_b32 v64, 16, v41
  v_and_b32 v65, 0xffff0000, v41
  v_lshlrev_b32 v66, 16, v45
  v_and_b32 v67, 0xffff0000, v45
  v_lshlrev_b32 v68, 16, v49
  v_and_b32 v69, 0xffff0000, v49
  v_lshlrev_b32 v70, 16, v53
  v_and_b32 v71, 0xffff0000, v53
  v_pk_add_f32 v[64:65], v[64:65], v[66:67]
  v_pk_add_f32 v[68:69], v[68:69], v[70:71]
  v_pk_add_f32 v[64:65], v[64:65], v[68:69]
  v_cvt_pk_bf16_f32 v81, v64, v65
  v_lshlrev_b32 v64, 16, v42
  v_and_b32 v65, 0xffff0000, v42
  v_lshlrev_b32 v66, 16, v46
  v_and_b32 v67, 0xffff0000, v46
  v_lshlrev_b32 v68, 16, v50
  v_and_b32 v69, 0xffff0000, v50
  v_lshlrev_b32 v70, 16, v54
  v_and_b32 v71, 0xffff0000, v54
  v_pk_add_f32 v[64:65], v[64:65], v[66:67]
  v_pk_add_f32 v[68:69], v[68:69], v[70:71]
  v_pk_add_f32 v[64:65], v[64:65], v[68:69]
  v_cvt_pk_bf16_f32 v82, v64, v65
  v_lshlrev_b32 v64, 16, v43
  v_and_b32 v65, 0xffff0000, v43
  v_lshlrev_b32 v66, 16, v47
  v_and_b32 v67, 0xffff0000, v47
  v_lshlrev_b32 v68, 16, v51
  v_and_b32 v69, 0xffff0000, v51
  v_lshlrev_b32 v70, 16, v55
  v_and_b32 v71, 0xffff0000, v55
  v_pk_add_f32 v[64:65], v[64:65], v[66:67]
  v_pk_add_f32 v[68:69], v[68:69], v[70:71]
  v_pk_add_f32 v[64:65], v[64:65], v[68:69]
  v_cvt_pk_bf16_f32 v83, v64, v65
  buffer_store_dwordx4 v[80:83], v5, s[20:23], s38 offen
L1_end:
  s_endpgm
L1_code_end:
L1_slow:
  s_nop 15
  s_waitcnt vmcnt(0) lgkmcnt(0)
  s_barrier
  v_mbcnt_lo_u32_b32 v120, -1, 0
  v_mbcnt_hi_u32_b32 v120, -1, v120
  v_lshrrev_b32 v121, 3, v120
  v_and_b32 v122, 7, v120
  v_bfe_u32 v123, v120, 4, 1
  v_xor_b32 v124, v122, v123
  v_lshlrev_b32 v124, 4, v124
  v_lshlrev_b32 v125, 2, v123
  v_xor_b32 v125, v122, v125
  v_lshlrev_b32 v125, 4, v125
  v_lshl_add_u32 v124, v121, 8, v124
  v_lshl_add_u32 v125, v121, 8, v125
  s_lshl_b32 s66, s3, 11
  s_add_u32 s67, s66, 128
  s_add_u32 s66, s66, 1024
  v_add_u32 v243, s66, v124
  v_add_u32 v244, s67, v124
  v_add_u32 v245, s66, v125
  v_add_u32 v246, s67, v125
  s_lshr_b32 s66, s3, 1
  s_lshl_b32 s66, s66, 11
  v_bfe_u32 v121, v120, 3, 2
  v_mul_u32_u24 v121, 4128, v121
  v_lshl_add_u32 v121, v122, 7, v121
  v_lshrrev_b32 v123, 5, v120
  v_bfe_u32 v124, v120, 1, 1
  v_xor_b32 v124, v123, v124
  v_lshl_add_u32 v121, v124, 4, v121
  v_add_u32 v240, s66, v121
  v_bfe_u32 v121, v120, 2, 2
  v_lshlrev_b32 v121, 7, v121
  v_lshl_add_u32 v121, v123, 9, v121
  v_bfe_u32 v124, v120, 3, 1
  v_lshl_add_u32 v121, v124, 6, v121
  v_bfe_u32 v124, v120, 4, 1
  v_lshl_add_u32 v121, v124, 5, v121
  v_and_b32 v124, 3, v120
  v_lshl_add_u32 v121, v124, 3, v121
  v_add_u32 v241, s66, v121
  v_xor_b32 v242, 64, v241
  s_mul_i32 s61, s3, 4128
  s_lshl_b32 s62, s3, 12
  v_mov_b32 v112, 0xff800000
  v_mov_b32 v113, 0xff800000
  v_mov_b32 v114, 0xff800000
  s_mov_b32 s60, 0
L1_s1:
  s_add_u32 m0, s61, 0
  s_nop 0
  buffer_load_dwordx4 v243, s[28:31], s60 offen offset:0 nt lds
  buffer_load_dwordx4 v244, s[28:31], s60 offen offset:1024 nt lds
  buffer_load_dwordx4 v243, s[32:35], s60 offen offset:2048 nt lds
  buffer_load_dwordx4 v244, s[32:35], s60 offen offset:3072 nt lds
  s_waitcnt vmcnt(0)
  s_barrier
  ds_read_b128 a[224:227], v240 offset:0
  ds_read_b128 a[228:231], v240 offset:32
  ds_read_b128 a[232:235], v240 offset:64
  ds_read_b128 a[236:239], v240 offset:96
  ds_read_b128 a[240:243], v240 offset:1024
  ds_read_b128 a[244:247], v240 offset:1056
  ds_read_b128 a[248:251], v240 offset:1088
  ds_read_b128 a[252:255], v240 offset:1120
  s_waitcnt lgkmcnt(7)
  v_mfma_f32_32x32x16_bf16 v[64:79], a[224:227], v[192:195], 0
  v_mfma_f32_32x32x16_bf16 v[80:95], a[224:227], v[0:3], 0
  v_mfma_f32_32x32x16_bf16 v[96:111], a[224:227], v[32:35], 0
  s_waitcnt lgkmcnt(6)
  v_mfma_f32_32x32x16_bf16 v[64:79], a[228:231], v[196:199], v[64:79]
  v_mfma_f32_32x32x16_bf16 v[80:95], a[228:231], v[4:7], v[80:95]
  v_mfma_f32_32x32x16_bf16 v[96:111], a[228:231], v[36:39], v[96:111]
  s_waitcnt lgkmcnt(5)
  v_mfma_f32_32x32x16_bf16 v[64:79], a[232:235], v[200:203], v[64:79]
  v_mfma_f32_32x32x16_bf16 v[80:95], a[232:235], v[8:11], v[80:95]
  v_mfma_f32_32x32x16_bf16 v[96:111], a[232:235], v[40:43], v[96:111]
  s_waitcnt lgkmcnt(4)
  v_mfma_f32_32x32x16_bf16 v[64:79], a[236:239], v[204:207], v[64:79]
  v_mfma_f32_32x32x16_bf16 v[80:95], a[236:239], v[12:15], v[80:95]
  v_mfma_f32_32x32x16_bf16 v[96:111], a[236:239], v[44:47], v[96:111]
  s_waitcnt lgkmcnt(3)
  v_mfma_f32_32x32x16_bf16 v[64:79], a[240:243], v[208:211], v[64:79]
  v_mfma_f32_32x32x16_bf16 v[80:95], a[240:243], v[16:19], v[80:95]
  v_mfma_f32_32x32x16_bf16 v[96:111], a[240:243], v[48:51], v[96:111]
  s_waitcnt lgkmcnt(2)
  v_mfma_f32_32x32x16_bf16 v[64:79], a[244:247], v[212:215], v[64:79]
  v_mfma_f32_32x32x16_bf16 v[80:95], a[244:247], v[20:23], v[80:95]
  v_mfma_f32_32x32x16_bf16 v[96:111], a[244:247], v[52:55], v[96:111]
  s_waitcnt lgkmcnt(1)
  v_mfma_f32_32x32x16_bf16 v[64:79], a[248:251], v[216:219], v[64:79]
  v_mfma_f32_32x32x16_bf16 v[80:95], a[248:251], v[24:27], v[80:95]
  v_mfma_f32_32x32x16_bf16 v[96:111], a[248:251], v[56:59], v[96:111]
  s_waitcnt lgkmcnt(0)
  v_mfma_f32_32x32x16_bf16 v[64:79], a[252:255], v[220:223], v[64:79]
  v_mfma_f32_32x32x16_bf16 v[80:95], a[252:255], v[28:31], v[80:95]
  v_mfma_f32_32x32x16_bf16 v[96:111], a[252:255], v[60:63], v[96:111]
  s_nop 9
  v_max3_f32 v112, v112, v64, v65
  v_max3_f32 v112, v112, v66, v67
  v_max3_f32 v112, v112, v68, v69
  v_max3_f32 v112, v112, v70, v71
  v_max3_f32 v112, v112, v72, v73
  v_max3_f32 v112, v112, v74, v75
  v_max3_f32 v112, v112, v76, v77
  v_max3_f32 v112, v112, v78, v79
  v_max3_f32 v113, v113, v80, v81
  v_max3_f32 v113, v113, v82, v83
  v_max3_f32 v113, v113, v84, v85
  v_max3_f32 v113, v113, v86, v87
  v_max3_f32 v113, v113, v88, v89
  v_max3_f32 v113, v113, v90, v91
  v_max3_f32 v113, v113, v92, v93
  v_max3_f32 v113, v113, v94, v95
  v_max3_f32 v114, v114, v96, v97
  v_max3_f32 v114, v114, v98, v99
  v_max3_f32 v114, v114, v100, v101
  v_max3_f32 v114, v114, v102, v103
  v_max3_f32 v114, v114, v104, v105
  v_max3_f32 v114, v114, v106, v107
  v_max3_f32 v114, v114, v108, v109
  v_max3_f32 v114, v114, v110, v111
  s_barrier
  s_add_u32 s60, s60, 8192
  s_cmp_lt_u32 s60, 131072
  s_cbranch_scc1 L1_s1
  v_mov_b32 v115, v112
  v_mov_b32 v116, v113
  v_mov_b32 v117, v114
  v_permlane32_swap_b32 v115, v112
  v_permlane32_swap_b32 v116, v113
  v_permlane32_swap_b32 v117, v114
  v_max_f32 v112, v112, v115
  v_max_f32 v113, v113, v116
  v_max_f32 v114, v114, v117
  v_sub_f32 v224, 0, v112
  v_sub_f32 v225, 0, v112
  v_sub_f32 v226, 0, v112
  v_sub_f32 v227, 0, v112
  v_sub_f32 v228, 0, v112
  v_sub_f32 v229, 0, v112
  v_sub_f32 v230, 0, v112
  v_sub_f32 v231, 0, v112
  v_sub_f32 v232, 0, v112
  v_sub_f32 v233, 0, v112
  v_sub_f32 v234, 0, v112
  v_sub_f32 v235, 0, v112
  v_sub_f32 v236, 0, v112
  v_sub_f32 v237, 0, v112
  v_sub_f32 v238, 0, v112
  v_sub_f32 v239, 0, v112
  v_mov_b32 v247, 0
  v_sub_f32 v160, 0, v113
  v_sub_f32 v161, 0, v113
  v_sub_f32 v162, 0, v113
  v_sub_f32 v163, 0, v113
  v_sub_f32 v164, 0, v113
  v_sub_f32 v165, 0, v113
  v_sub_f32 v166, 0, v113
  v_sub_f32 v167, 0, v113
  v_sub_f32 v168, 0, v113
  v_sub_f32 v169, 0, v113
  v_sub_f32 v170, 0, v113
  v_sub_f32 v171, 0, v113
  v_sub_f32 v172, 0, v113
  v_sub_f32 v173, 0, v113
  v_sub_f32 v174, 0, v113
  v_sub_f32 v175, 0, v113
  v_mov_b32 v248, 0
  v_sub_f32 v176, 0, v114
  v_sub_f32 v177, 0, v114
  v_sub_f32 v178, 0, v114
  v_sub_f32 v179, 0, v114
  v_sub_f32 v180, 0, v114
  v_sub_f32 v181, 0, v114
  v_sub_f32 v182, 0, v114
  v_sub_f32 v183, 0, v114
  v_sub_f32 v184, 0, v114
  v_sub_f32 v185, 0, v114
  v_sub_f32 v186, 0, v114
  v_sub_f32 v187, 0, v114
  v_sub_f32 v188, 0, v114
  v_sub_f32 v189, 0, v114
  v_sub_f32 v190, 0, v114
  v_sub_f32 v191, 0, v114
  v_mov_b32 v249, 0
  v_accvgpr_write_b32 a0, 0
  v_accvgpr_write_b32 a1, 0
  v_accvgpr_write_b32 a2, 0
  v_accvgpr_write_b32 a3, 0
  v_accvgpr_write_b32 a4, 0
  v_accvgpr_write_b32 a5, 0
  v_accvgpr_write_b32 a6, 0
  v_accvgpr_write_b32 a7, 0
  v_accvgpr_write_b32 a8, 0
  v_accvgpr_write_b32 a9, 0
  v_accvgpr_write_b32 a10, 0
  v_accvgpr_write_b32 a11, 0
  v_accvgpr_write_b32 a12, 0
  v_accvgpr_write_b32 a13, 0
  v_accvgpr_write_b32 a14, 0
  v_accvgpr_write_b32 a15, 0
  v_accvgpr_write_b32 a16, 0
  v_accvgpr_write_b32 a17, 0
  v_accvgpr_write_b32 a18, 0
  v_accvgpr_write_b32 a19, 0
  v_accvgpr_write_b32 a20, 0
  v_accvgpr_write_b32 a21, 0
  v_accvgpr_write_b32 a22, 0
  v_accvgpr_write_b32 a23, 0
  v_accvgpr_write_b32 a24, 0
  v_accvgpr_write_b32 a25, 0
  v_accvgpr_write_b32 a26, 0
  v_accvgpr_write_b32 a27, 0
  v_accvgpr_write_b32 a28, 0
  v_accvgpr_write_b32 a29, 0
  v_accvgpr_write_b32 a30, 0
  v_accvgpr_write_b32 a31, 0
  v_accvgpr_write_b32 a32, 0
  v_accvgpr_write_b32 a33, 0
  v_accvgpr_write_b32 a34, 0
  v_accvgpr_write_b32 a35, 0
  v_accvgpr_write_b32 a36, 0
  v_accvgpr_write_b32 a37, 0
  v_accvgpr_write_b32 a38, 0
  v_accvgpr_write_b32 a39, 0
  v_accvgpr_write_b32 a40, 0
  v_accvgpr_write_b32 a41, 0
  v_accvgpr_write_b32 a42, 0
  v_accvgpr_write_b32 a43, 0
  v_accvgpr_write_b32 a44, 0
  v_accvgpr_write_b32 a45, 0
  v_accvgpr_write_b32 a46, 0
  v_accvgpr_write_b32 a47, 0
  v_accvgpr_write_b32 a48, 0
  v_accvgpr_write_b32 a49, 0
  v_accvgpr_write_b32 a50, 0
  v_accvgpr_write_b32 a51, 0
  v_accvgpr_write_b32 a52, 0
  v_accvgpr_write_b32 a53, 0
  v_accvgpr_write_b32 a54, 0
  v_accvgpr_write_b32 a55, 0
  v_accvgpr_write_b32 a56, 0
  v_accvgpr_write_b32 a57, 0
  v_accvgpr_write_b32 a58, 0
  v_accvgpr_write_b32 a59, 0
  v_accvgpr_write_b32 a60, 0
  v_accvgpr_write_b32 a61, 0
  v_accvgpr_write_b32 a62, 0
  v_accvgpr_write_b32 a63, 0
  v_accvgpr_write_b32 a64, 0
  v_accvgpr_write_b32 a65, 0
  v_accvgpr_write_b32 a66, 0
  v_accvgpr_write_b32 a67, 0
  v_accvgpr_write_b32 a68, 0
  v_accvgpr_write_b32 a69, 0
  v_accvgpr_write_b32 a70, 0
  v_accvgpr_write_b32 a71, 0
  v_accvgpr_write_b32 a72, 0
  v_accvgpr_write_b32 a73, 0
  v_accvgpr_write_b32 a74, 0
  v_accvgpr_write_b32 a75, 0
  v_accvgpr_write_b32 a76, 0
  v_accvgpr_write_b32 a77, 0
  v_accvgpr_write_b32 a78, 0
  v_accvgpr_write_b32 a79, 0
  v_accvgpr_write_b32 a80, 0
  v_accvgpr_write_b32 a81, 0
  v_accvgpr_write_b32 a82, 0
  v_accvgpr_write_b32 a83, 0
  v_accvgpr_write_b32 a84, 0
  v_accvgpr_write_b32 a85, 0
  v_accvgpr_write_b32 a86, 0
  v_accvgpr_write_b32 a87, 0
  v_accvgpr_write_b32 a88, 0
  v_accvgpr_write_b32 a89, 0
  v_accvgpr_write_b32 a90, 0
  v_accvgpr_write_b32 a91, 0
  v_accvgpr_write_b32 a92, 0
  v_accvgpr_write_b32 a93, 0
  v_accvgpr_write_b32 a94, 0
  v_accvgpr_write_b32 a95, 0
  v_accvgpr_write_b32 a96, 0
  v_accvgpr_write_b32 a97, 0
  v_accvgpr_write_b32 a98, 0
  v_accvgpr_write_b32 a99, 0
  v_accvgpr_write_b32 a100, 0
  v_accvgpr_write_b32 a101, 0
  v_accvgpr_write_b32 a102, 0
  v_accvgpr_write_b32 a103, 0
  v_accvgpr_write_b32 a104, 0
  v_accvgpr_write_b32 a105, 0
  v_accvgpr_write_b32 a106, 0
  v_accvgpr_write_b32 a107, 0
  v_accvgpr_write_b32 a108, 0
  v_accvgpr_write_b32 a109, 0
  v_accvgpr_write_b32 a110, 0
  v_accvgpr_write_b32 a111, 0
  v_accvgpr_write_b32 a112, 0
  v_accvgpr_write_b32 a113, 0
  v_accvgpr_write_b32 a114, 0
  v_accvgpr_write_b32 a115, 0
  v_accvgpr_write_b32 a116, 0
  v_accvgpr_write_b32 a117, 0
  v_accvgpr_write_b32 a118, 0
  v_accvgpr_write_b32 a119, 0
  v_accvgpr_write_b32 a120, 0
  v_accvgpr_write_b32 a121, 0
  v_accvgpr_write_b32 a122, 0
  v_accvgpr_write_b32 a123, 0
  v_accvgpr_write_b32 a124, 0
  v_accvgpr_write_b32 a125, 0
  v_accvgpr_write_b32 a126, 0
  v_accvgpr_write_b32 a127, 0
  v_accvgpr_write_b32 a128, 0
  v_accvgpr_write_b32 a129, 0
  v_accvgpr_write_b32 a130, 0
  v_accvgpr_write_b32 a131, 0
  v_accvgpr_write_b32 a132, 0
  v_accvgpr_write_b32 a133, 0
  v_accvgpr_write_b32 a134, 0
  v_accvgpr_write_b32 a135, 0
  v_accvgpr_write_b32 a136, 0
  v_accvgpr_write_b32 a137, 0
  v_accvgpr_write_b32 a138, 0
  v_accvgpr_write_b32 a139, 0
  v_accvgpr_write_b32 a140, 0
  v_accvgpr_write_b32 a141, 0
  v_accvgpr_write_b32 a142, 0
  v_accvgpr_write_b32 a143, 0
  v_accvgpr_write_b32 a144, 0
  v_accvgpr_write_b32 a145, 0
  v_accvgpr_write_b32 a146, 0
  v_accvgpr_write_b32 a147, 0
  v_accvgpr_write_b32 a148, 0
  v_accvgpr_write_b32 a149, 0
  v_accvgpr_write_b32 a150, 0
  v_accvgpr_write_b32 a151, 0
  v_accvgpr_write_b32 a152, 0
  v_accvgpr_write_b32 a153, 0
  v_accvgpr_write_b32 a154, 0
  v_accvgpr_write_b32 a155, 0
  v_accvgpr_write_b32 a156, 0
  v_accvgpr_write_b32 a157, 0
  v_accvgpr_write_b32 a158, 0
  v_accvgpr_write_b32 a159, 0
  v_accvgpr_write_b32 a160, 0
  v_accvgpr_write_b32 a161, 0
  v_accvgpr_write_b32 a162, 0
  v_accvgpr_write_b32 a163, 0
  v_accvgpr_write_b32 a164, 0
  v_accvgpr_write_b32 a165, 0
  v_accvgpr_write_b32 a166, 0
  v_accvgpr_write_b32 a167, 0
  v_accvgpr_write_b32 a168, 0
  v_accvgpr_write_b32 a169, 0
  v_accvgpr_write_b32 a170, 0
  v_accvgpr_write_b32 a171, 0
  v_accvgpr_write_b32 a172, 0
  v_accvgpr_write_b32 a173, 0
  v_accvgpr_write_b32 a174, 0
  v_accvgpr_write_b32 a175, 0
  v_accvgpr_write_b32 a176, 0
  v_accvgpr_write_b32 a177, 0
  v_accvgpr_write_b32 a178, 0
  v_accvgpr_write_b32 a179, 0
  v_accvgpr_write_b32 a180, 0
  v_accvgpr_write_b32 a181, 0
  v_accvgpr_write_b32 a182, 0
  v_accvgpr_write_b32 a183, 0
  v_accvgpr_write_b32 a184, 0
  v_accvgpr_write_b32 a185, 0
  v_accvgpr_write_b32 a186, 0
  v_accvgpr_write_b32 a187, 0
  v_accvgpr_write_b32 a188, 0
  v_accvgpr_write_b32 a189, 0
  v_accvgpr_write_b32 a190, 0
  v_accvgpr_write_b32 a191, 0
  s_mov_b32 s60, 0
L1_s2:
  s_add_u32 m0, s61, 0
  s_nop 0
  buffer_load_dwordx4 v243, s[28:31], s60 offen offset:0 nt lds
  buffer_load_dwordx4 v244, s[28:31], s60 offen offset:1024 nt lds
  buffer_load_dwordx4 v243, s[32:35], s60 offen offset:2048 nt lds
  buffer_load_dwordx4 v244, s[32:35], s60 offen offset:3072 nt lds
  s_add_u32 m0, s62, 16512
  s_nop 0
  buffer_load_dwordx4 v245, s[36:39], s60 offen offset:0 nt lds
  buffer_load_dwordx4 v246, s[36:39], s60 offen offset:1024 nt lds
  buffer_load_dwordx4 v245, s[40:43], s60 offen offset:2048 nt lds
  buffer_load_dwordx4 v246, s[40:43], s60 offen offset:3072 nt lds
  s_waitcnt vmcnt(0)
  s_barrier
  ds_read_b128 a[224:227], v240 offset:0
  ds_read_b128 a[228:231], v240 offset:32
  ds_read_b128 a[232:235], v240 offset:64
  ds_read_b128 a[236:239], v240 offset:96
  ds_read_b128 a[240:243], v240 offset:1024
  ds_read_b128 a[244:247], v240 offset:1056
  ds_read_b128 a[248:251], v240 offset:1088
  ds_read_b128 a[252:255], v240 offset:1120
  s_waitcnt lgkmcnt(7)
  v_mfma_f32_32x32x16_bf16 v[64:79], a[224:227], v[192:195], v[224:239]
  v_mfma_f32_32x32x16_bf16 v[80:95], a[224:227], v[0:3], v[160:175]
  v_mfma_f32_32x32x16_bf16 v[96:111], a[224:227], v[32:35], v[176:191]
  s_waitcnt lgkmcnt(6)
  v_mfma_f32_32x32x16_bf16 v[64:79], a[228:231], v[196:199], v[64:79]
  v_mfma_f32_32x32x16_bf16 v[80:95], a[228:231], v[4:7], v[80:95]
  v_mfma_f32_32x32x16_bf16 v[96:111], a[228:231], v[36:39], v[96:111]
  s_waitcnt lgkmcnt(5)
  v_mfma_f32_32x32x16_bf16 v[64:79], a[232:235], v[200:203], v[64:79]
  v_mfma_f32_32x32x16_bf16 v[80:95], a[232:235], v[8:11], v[80:95]
  v_mfma_f32_32x32x16_bf16 v[96:111], a[232:235], v[40:43], v[96:111]
  s_waitcnt lgkmcnt(4)
  v_mfma_f32_32x32x16_bf16 v[64:79], a[236:239], v[204:207], v[64:79]
  v_mfma_f32_32x32x16_bf16 v[80:95], a[236:239], v[12:15], v[80:95]
  v_mfma_f32_32x32x16_bf16 v[96:111], a[236:239], v[44:47], v[96:111]
  s_waitcnt lgkmcnt(3)
  v_mfma_f32_32x32x16_bf16 v[64:79], a[240:243], v[208:211], v[64:79]
  v_mfma_f32_32x32x16_bf16 v[80:95], a[240:243], v[16:19], v[80:95]
  v_mfma_f32_32x32x16_bf16 v[96:111], a[240:243], v[48:51], v[96:111]
  s_waitcnt lgkmcnt(2)
  v_mfma_f32_32x32x16_bf16 v[64:79], a[244:247], v[212:215], v[64:79]
  v_mfma_f32_32x32x16_bf16 v[80:95], a[244:247], v[20:23], v[80:95]
  v_mfma_f32_32x32x16_bf16 v[96:111], a[244:247], v[52:55], v[96:111]
  s_waitcnt lgkmcnt(1)
  v_mfma_f32_32x32x16_bf16 v[64:79], a[248:251], v[216:219], v[64:79]
  v_mfma_f32_32x32x16_bf16 v[80:95], a[248:251], v[24:27], v[80:95]
  v_mfma_f32_32x32x16_bf16 v[96:111], a[248:251], v[56:59], v[96:111]
  s_waitcnt lgkmcnt(0)
  v_mfma_f32_32x32x16_bf16 v[64:79], a[252:255], v[220:223], v[64:79]
  v_mfma_f32_32x32x16_bf16 v[80:95], a[252:255], v[28:31], v[80:95]
  v_mfma_f32_32x32x16_bf16 v[96:111], a[252:255], v[60:63], v[96:111]
  ds_read_b64_tr_b16 a[224:225], v241 offset:16512
  ds_read_b64_tr_b16 a[226:227], v241 offset:20608
  ds_read_b64_tr_b16 a[228:229], v242 offset:16512
  ds_read_b64_tr_b16 a[230:231], v242 offset:20608
  ds_read_b64_tr_b16 a[232:233], v241 offset:17536
  ds_read_b64_tr_b16 a[234:235], v241 offset:21632
  ds_read_b64_tr_b16 a[236:237], v242 offset:17536
  ds_read_b64_tr_b16 a[238:239], v242 offset:21632
  ds_read_b64_tr_b16 a[240:241], v241 offset:24704
  ds_read_b64_tr_b16 a[242:243], v241 offset:28800
  ds_read_b64_tr_b16 a[244:245], v242 offset:24704
  ds_read_b64_tr_b16 a[246:247], v242 offset:28800
  ds_read_b64_tr_b16 a[248:249], v241 offset:25728
  ds_read_b64_tr_b16 a[250:251], v241 offset:29824
  ds_read_b64_tr_b16 a[252:253], v242 offset:25728
  ds_read_b64_tr_b16 a[254:255], v242 offset:29824
  v_exp_f32 v64, v64
  v_exp_f32 v65, v65
  v_add_f32 v247, v247, v64
  v_exp_f32 v66, v66
  v_add_f32 v247, v247, v65
  v_cvt_pk_bf16_f32 v64, v64, v65
  v_exp_f32 v67, v67
  v_add_f32 v247, v247, v66
  v_exp_f32 v68, v68
  v_add_f32 v247, v247, v67
  v_cvt_pk_bf16_f32 v65, v66, v67
  v_exp_f32 v69, v69
  v_add_f32 v247, v247, v68
  v_exp_f32 v70, v70
  v_add_f32 v247, v247, v69
  v_cvt_pk_bf16_f32 v66, v68, v69
  v_exp_f32 v71, v71
  v_add_f32 v247, v247, v70
  v_exp_f32 v80, v80
  v_add_f32 v247, v247, v71
  v_cvt_pk_bf16_f32 v67, v70, v71
  v_exp_f32 v81, v81
  v_add_f32 v248, v248, v80
  v_exp_f32 v82, v82
  v_add_f32 v248, v248, v81
  v_cvt_pk_bf16_f32 v80, v80, v81
  v_exp_f32 v83, v83
  v_add_f32 v248, v248, v82
  v_exp_f32 v84, v84
  v_add_f32 v248, v248, v83
  v_cvt_pk_bf16_f32 v81, v82, v83
  v_exp_f32 v85, v85
  v_add_f32 v248, v248, v84
  v_exp_f32 v86, v86
  v_add_f32 v248, v248, v85
  v_cvt_pk_bf16_f32 v82, v84, v85
  v_exp_f32 v87, v87
  v_add_f32 v248, v248, v86
  v_exp_f32 v96, v96
  v_add_f32 v248, v248, v87
  v_cvt_pk_bf16_f32 v83, v86, v87
  v_exp_f32 v97, v97
  v_add_f32 v249, v249, v96
  v_exp_f32 v98, v98
  v_add_f32 v249, v249, v97
  v_cvt_pk_bf16_f32 v96, v96, v97
  v_exp_f32 v99, v99
  v_add_f32 v249, v249, v98
  v_exp_f32 v100, v100
  v_add_f32 v249, v249, v99
  v_cvt_pk_bf16_f32 v97, v98, v99
  v_exp_f32 v101, v101
  v_add_f32 v249, v249, v100
  v_exp_f32 v102, v102
  v_add_f32 v249, v249, v101
  v_cvt_pk_bf16_f32 v98, v100, v101
  v_exp_f32 v103, v103
  v_add_f32 v249, v249, v102
  v_exp_f32 v72, v72
  v_add_f32 v249, v249, v103
  v_cvt_pk_bf16_f32 v99, v102, v103
  v_exp_f32 v73, v73
  v_add_f32 v247, v247, v72
  v_exp_f32 v74, v74
  v_add_f32 v247, v247, v73
  v_cvt_pk_bf16_f32 v72, v72, v73
  v_exp_f32 v75, v75
  v_add_f32 v247, v247, v74
  v_exp_f32 v76, v76
  v_add_f32 v247, v247, v75
  v_cvt_pk_bf16_f32 v73, v74, v75
  v_exp_f32 v77, v77
  v_add_f32 v247, v247, v76
  v_exp_f32 v78, v78
  v_add_f32 v247, v247, v77
  v_cvt_pk_bf16_f32 v74, v76, v77
  v_exp_f32 v79, v79
  v_add_f32 v247, v247, v78
  v_exp_f32 v88, v88
  v_add_f32 v247, v247, v79
  v_cvt_pk_bf16_f32 v75, v78, v79
  v_exp_f32 v89, v89
  v_add_f32 v248, v248, v88
  v_exp_f32 v90, v90
  v_add_f32 v248, v248, v89
  v_cvt_pk_bf16_f32 v88, v88, v89
  v_exp_f32 v91, v91
  v_add_f32 v248, v248, v90
  v_exp_f32 v92, v92
  v_add_f32 v248, v248, v91
  v_cvt_pk_bf16_f32 v89, v90, v91
  v_exp_f32 v93, v93
  v_add_f32 v248, v248, v92
  v_exp_f32 v94, v94
  v_add_f32 v248, v248, v93
  v_cvt_pk_bf16_f32 v90, v92, v93
  v_exp_f32 v95, v95
  v_add_f32 v248, v248, v94
  v_exp_f32 v104, v104
  v_add_f32 v248, v248, v95
  v_cvt_pk_bf16_f32 v91, v94, v95
  v_exp_f32 v105, v105
  v_add_f32 v249, v249, v104
  v_exp_f32 v106, v106
  v_add_f32 v249, v249, v105
  v_cvt_pk_bf16_f32 v104, v104, v105
  v_exp_f32 v107, v107
  v_add_f32 v249, v249, v106
  v_exp_f32 v108, v108
  v_add_f32 v249, v249, v107
  v_cvt_pk_bf16_f32 v105, v106, v107
  v_exp_f32 v109, v109
  v_add_f32 v249, v249, v108
  v_exp_f32 v110, v110
  v_add_f32 v249, v249, v109
  v_cvt_pk_bf16_f32 v106, v108, v109
  v_exp_f32 v111, v111
  v_add_f32 v249, v249, v110
  v_add_f32 v249, v249, v111
  v_cvt_pk_bf16_f32 v107, v110, v111
  s_waitcnt lgkmcnt(14)
  v_mfma_f32_32x32x16_bf16 a[0:15], a[224:227], v[64:67], a[0:15]
  v_mfma_f32_32x32x16_bf16 a[16:31], a[224:227], v[80:83], a[16:31]
  v_mfma_f32_32x32x16_bf16 a[32:47], a[224:227], v[96:99], a[32:47]
  s_waitcnt lgkmcnt(12)
  v_mfma_f32_32x32x16_bf16 a[48:63], a[228:231], v[64:67], a[48:63]
  v_mfma_f32_32x32x16_bf16 a[64:79], a[228:231], v[80:83], a[64:79]
  v_mfma_f32_32x32x16_bf16 a[80:95], a[228:231], v[96:99], a[80:95]
  s_waitcnt lgkmcnt(10)
  v_mfma_f32_32x32x16_bf16 a[96:111], a[232:235], v[64:67], a[96:111]
  v_mfma_f32_32x32x16_bf16 a[112:127], a[232:235], v[80:83], a[112:127]
  v_mfma_f32_32x32x16_bf16 a[128:143], a[232:235], v[96:99], a[128:143]
  s_waitcnt lgkmcnt(8)
  v_mfma_f32_32x32x16_bf16 a[144:159], a[236:239], v[64:67], a[144:159]
  v_mfma_f32_32x32x16_bf16 a[160:175], a[236:239], v[80:83], a[160:175]
  v_mfma_f32_32x32x16_bf16 a[176:191], a[236:239], v[96:99], a[176:191]
  s_waitcnt lgkmcnt(6)
  v_mfma_f32_32x32x16_bf16 a[0:15], a[240:243], v[72:75], a[0:15]
  v_mfma_f32_32x32x16_bf16 a[16:31], a[240:243], v[88:91], a[16:31]
  v_mfma_f32_32x32x16_bf16 a[32:47], a[240:243], v[104:107], a[32:47]
  s_waitcnt lgkmcnt(4)
  v_mfma_f32_32x32x16_bf16 a[48:63], a[244:247], v[72:75], a[48:63]
  v_mfma_f32_32x32x16_bf16 a[64:79], a[244:247], v[88:91], a[64:79]
  v_mfma_f32_32x32x16_bf16 a[80:95], a[244:247], v[104:107], a[80:95]
  s_waitcnt lgkmcnt(2)
  v_mfma_f32_32x32x16_bf16 a[96:111], a[248:251], v[72:75], a[96:111]
  v_mfma_f32_32x32x16_bf16 a[112:127], a[248:251], v[88:91], a[112:127]
  v_mfma_f32_32x32x16_bf16 a[128:143], a[248:251], v[104:107], a[128:143]
  s_waitcnt lgkmcnt(0)
  v_mfma_f32_32x32x16_bf16 a[144:159], a[252:255], v[72:75], a[144:159]
  v_mfma_f32_32x32x16_bf16 a[160:175], a[252:255], v[88:91], a[160:175]
  v_mfma_f32_32x32x16_bf16 a[176:191], a[252:255], v[104:107], a[176:191]
  s_barrier
  s_add_u32 s60, s60, 8192
  s_cmp_lt_u32 s60, 131072
  s_cbranch_scc1 L1_s2
  v_mov_b32 v232, v247
  v_mov_b32 v233, v248
  v_mov_b32 v234, v249
  v_permlane32_swap_b32 v232, v247
  v_permlane32_swap_b32 v233, v248
  v_permlane32_swap_b32 v234, v249
  v_add_f32 v247, v247, v232
  v_add_f32 v248, v248, v233
  v_add_f32 v249, v249, v234
  v_rcp_f32 v224, v247
  v_rcp_f32 v226, v248
  v_rcp_f32 v228, v249
  v_mov_b32 v225, v224
  v_mov_b32 v227, v226
  v_mov_b32 v229, v228
  s_add_u32 m0, s62, 32896
  s_add_u32 s59, s50, 1024
  buffer_load_dwordx4 v250, s[8:11], s59 offen offset:0 lds
  s_add_u32 s59, s50, 128
  buffer_load_dwordx4 v250, s[8:11], s59 offen offset:1024 lds
  s_add_u32 s59, s50, 1152
  buffer_load_dwordx4 v251, s[8:11], s59 offen offset:2048 lds
  s_add_u32 s59, s50, 0
  buffer_load_dwordx4 v251, s[8:11], s59 offen offset:3072 lds
  s_add_u32 m0, s62, 65792
  s_add_u32 s59, s50, 33792
  buffer_load_dwordx4 v250, s[8:11], s59 offen offset:0 lds
  s_add_u32 s59, s50, 32896
  buffer_load_dwordx4 v250, s[8:11], s59 offen offset:1024 lds
  s_add_u32 s59, s50, 33920
  buffer_load_dwordx4 v251, s[8:11], s59 offen offset:2048 lds
  s_add_u32 s59, s50, 32768
  buffer_load_dwordx4 v251, s[8:11], s59 offen offset:3072 lds
  s_add_u32 m0, s62, 98688
  s_add_u32 s59, s50, 66560
  buffer_load_dwordx4 v250, s[8:11], s59 offen offset:0 lds
  s_add_u32 s59, s50, 65664
  buffer_load_dwordx4 v250, s[8:11], s59 offen offset:1024 lds
  s_add_u32 s59, s50, 66688
  buffer_load_dwordx4 v251, s[8:11], s59 offen offset:2048 lds
  s_add_u32 s59, s50, 65536
  buffer_load_dwordx4 v251, s[8:11], s59 offen offset:3072 lds
  s_add_u32 m0, s62, 16512
  s_add_u32 s59, s50, 99328
  buffer_load_dwordx4 v250, s[8:11], s59 offen offset:0 lds
  s_add_u32 s59, s50, 98432
  buffer_load_dwordx4 v250, s[8:11], s59 offen offset:1024 lds
  s_add_u32 s59, s50, 99456
  buffer_load_dwordx4 v251, s[8:11], s59 offen offset:2048 lds
  s_add_u32 s59, s50, 98304
  buffer_load_dwordx4 v251, s[8:11], s59 offen offset:3072 lds
  s_add_u32 m0, s62, 131584
  s_add_u32 s59, s56, 1024
  buffer_load_dwordx4 v250, s[8:11], s59 offen offset:0 lds
  s_add_u32 s59, s56, 128
  buffer_load_dwordx4 v250, s[8:11], s59 offen offset:1024 lds
  s_add_u32 s59, s56, 1152
  buffer_load_dwordx4 v251, s[8:11], s59 offen offset:2048 lds
  s_add_u32 s59, s56, 0
  buffer_load_dwordx4 v251, s[8:11], s59 offen offset:3072 lds
  s_add_u32 m0, s62, 49408
  s_add_u32 s59, s57, 1024
  buffer_load_dwordx4 v250, s[8:11], s59 offen offset:0 lds
  s_add_u32 s59, s57, 128
  buffer_load_dwordx4 v250, s[8:11], s59 offen offset:1024 lds
  s_add_u32 s59, s57, 1152
  buffer_load_dwordx4 v251, s[8:11], s59 offen offset:2048 lds
  s_add_u32 s59, s57, 0
  buffer_load_dwordx4 v251, s[8:11], s59 offen offset:3072 lds
  v_xor_b32 v240, 64, v253
  v_add_u32 v243, 65792, v253
  v_add_u32 v244, 65792, v240
  v_add_u32 v245, 131584, v253
  v_add_u32 v246, 131584, v240
  v_accvgpr_read_b32 v64, a0
  v_accvgpr_read_b32 v65, a1
  v_accvgpr_read_b32 v66, a2
  v_accvgpr_read_b32 v67, a3
  v_accvgpr_read_b32 v68, a4
  v_accvgpr_read_b32 v69, a5
  v_accvgpr_read_b32 v70, a6
  v_accvgpr_read_b32 v71, a7
  v_pk_mul_f32 v[64:65], v[64:65], v[224:225]
  v_pk_mul_f32 v[66:67], v[66:67], v[224:225]
  v_pk_mul_f32 v[68:69], v[68:69], v[224:225]
  v_pk_mul_f32 v[70:71], v[70:71], v[224:225]
  v_cvt_pk_bf16_f32 v72, v64, v65
  v_cvt_pk_bf16_f32 v73, v66, v67
  v_cvt_pk_bf16_f32 v74, v68, v69
  v_cvt_pk_bf16_f32 v75, v70, v71
  s_add_u32 s67, s63, 0
  buffer_store_dwordx4 v[72:75], v252, s[44:47], s67 offen offset:0 sc1
  v_accvgpr_read_b32 v96, a8
  v_accvgpr_read_b32 v97, a9
  v_accvgpr_read_b32 v98, a10
  v_accvgpr_read_b32 v99, a11
  v_accvgpr_read_b32 v100, a12
  v_accvgpr_read_b32 v101, a13
  v_accvgpr_read_b32 v102, a14
  v_accvgpr_read_b32 v103, a15
  v_pk_mul_f32 v[96:97], v[96:97], v[224:225]
  v_pk_mul_f32 v[98:99], v[98:99], v[224:225]
  v_pk_mul_f32 v[100:101], v[100:101], v[224:225]
  v_pk_mul_f32 v[102:103], v[102:103], v[224:225]
  v_cvt_pk_bf16_f32 v84, v96, v97
  v_cvt_pk_bf16_f32 v85, v98, v99
  v_cvt_pk_bf16_f32 v86, v100, v101
  v_cvt_pk_bf16_f32 v87, v102, v103
  s_add_u32 s67, s63, 3072
  buffer_store_dwordx4 v[84:87], v252, s[44:47], s67 offen offset:0 sc1
  v_accvgpr_read_b32 v64, a16
  v_accvgpr_read_b32 v65, a17
  v_accvgpr_read_b32 v66, a18
  v_accvgpr_read_b32 v67, a19
  v_accvgpr_read_b32 v68, a20
  v_accvgpr_read_b32 v69, a21
  v_accvgpr_read_b32 v70, a22
  v_accvgpr_read_b32 v71, a23
  v_pk_mul_f32 v[64:65], v[64:65], v[226:227]
  v_pk_mul_f32 v[66:67], v[66:67], v[226:227]
  v_pk_mul_f32 v[68:69], v[68:69], v[226:227]
  v_pk_mul_f32 v[70:71], v[70:71], v[226:227]
  v_cvt_pk_bf16_f32 v76, v64, v65
  v_cvt_pk_bf16_f32 v77, v66, v67
  v_cvt_pk_bf16_f32 v78, v68, v69
  v_cvt_pk_bf16_f32 v79, v70, v71
  s_add_u32 s67, s63, 0
  buffer_store_dwordx4 v[76:79], v252, s[44:47], s67 offen offset:1024 sc1
  v_accvgpr_read_b32 v96, a24
  v_accvgpr_read_b32 v97, a25
  v_accvgpr_read_b32 v98, a26
  v_accvgpr_read_b32 v99, a27
  v_accvgpr_read_b32 v100, a28
  v_accvgpr_read_b32 v101, a29
  v_accvgpr_read_b32 v102, a30
  v_accvgpr_read_b32 v103, a31
  v_pk_mul_f32 v[96:97], v[96:97], v[226:227]
  v_pk_mul_f32 v[98:99], v[98:99], v[226:227]
  v_pk_mul_f32 v[100:101], v[100:101], v[226:227]
  v_pk_mul_f32 v[102:103], v[102:103], v[226:227]
  v_cvt_pk_bf16_f32 v88, v96, v97
  v_cvt_pk_bf16_f32 v89, v98, v99
  v_cvt_pk_bf16_f32 v90, v100, v101
  v_cvt_pk_bf16_f32 v91, v102, v103
  s_add_u32 s67, s63, 3072
  buffer_store_dwordx4 v[88:91], v252, s[44:47], s67 offen offset:1024 sc1
  v_accvgpr_read_b32 v64, a32
  v_accvgpr_read_b32 v65, a33
  v_accvgpr_read_b32 v66, a34
  v_accvgpr_read_b32 v67, a35
  v_accvgpr_read_b32 v68, a36
  v_accvgpr_read_b32 v69, a37
  v_accvgpr_read_b32 v70, a38
  v_accvgpr_read_b32 v71, a39
  v_pk_mul_f32 v[64:65], v[64:65], v[228:229]
  v_pk_mul_f32 v[66:67], v[66:67], v[228:229]
  v_pk_mul_f32 v[68:69], v[68:69], v[228:229]
  v_pk_mul_f32 v[70:71], v[70:71], v[228:229]
  v_cvt_pk_bf16_f32 v80, v64, v65
  v_cvt_pk_bf16_f32 v81, v66, v67
  v_cvt_pk_bf16_f32 v82, v68, v69
  v_cvt_pk_bf16_f32 v83, v70, v71
  s_add_u32 s67, s63, 0
  buffer_store_dwordx4 v[80:83], v252, s[44:47], s67 offen offset:2048 sc1
  v_accvgpr_read_b32 v96, a40
  v_accvgpr_read_b32 v97, a41
  v_accvgpr_read_b32 v98, a42
  v_accvgpr_read_b32 v99, a43
  v_accvgpr_read_b32 v100, a44
  v_accvgpr_read_b32 v101, a45
  v_accvgpr_read_b32 v102, a46
  v_accvgpr_read_b32 v103, a47
  v_pk_mul_f32 v[96:97], v[96:97], v[228:229]
  v_pk_mul_f32 v[98:99], v[98:99], v[228:229]
  v_pk_mul_f32 v[100:101], v[100:101], v[228:229]
  v_pk_mul_f32 v[102:103], v[102:103], v[228:229]
  v_cvt_pk_bf16_f32 v92, v96, v97
  v_cvt_pk_bf16_f32 v93, v98, v99
  v_cvt_pk_bf16_f32 v94, v100, v101
  v_cvt_pk_bf16_f32 v95, v102, v103
  s_add_u32 s67, s63, 3072
  buffer_store_dwordx4 v[92:95], v252, s[44:47], s67 offen offset:2048 sc1
  s_waitcnt vmcnt(0)
  s_barrier
  ds_read_b64_tr_b16 a[224:225], v253 offset:32896
  ds_read_b64_tr_b16 a[226:227], v253 offset:36992
  ds_read_b64_tr_b16 a[228:229], v240 offset:32896
  ds_read_b64_tr_b16 a[230:231], v240 offset:36992
  ds_read_b64_tr_b16 a[232:233], v253 offset:33920
  ds_read_b64_tr_b16 a[234:235], v253 offset:38016
  ds_read_b64_tr_b16 a[236:237], v253 offset:41088
  ds_read_b64_tr_b16 a[238:239], v253 offset:45184
  s_waitcnt lgkmcnt(0)
  s_nop 15
  s_branch L1_norm

.section .rodata,"a"
.p2align 6
.amdhsa_kernel standalone__mha_block_cached__near_ridge_kernel
  .amdhsa_next_free_vgpr 512
  .amdhsa_next_free_sgpr 102
  .amdhsa_accum_offset 256
  .amdhsa_group_segment_fixed_size 0
  .amdhsa_kernarg_size 64
  .amdhsa_user_sgpr_count 2
  .amdhsa_user_sgpr_kernarg_segment_ptr 1
  .amdhsa_system_sgpr_workgroup_id_x 1
  .amdhsa_float_denorm_mode_32 3
.end_amdhsa_kernel
```
